```python
import torch

def _softmax(x, axis=-1):
    return torch.softmax(x, dim=axis)

def _gelu(x):
    return torch.nn.functional.gelu(x, approximate='tanh')

def _silu(x):
    return torch.nn.functional.silu(x)

def _sigmoid(x):
    return torch.sigmoid(x)

def _layernorm(x, axis=-1, eps=1e-05):
    m = x.mean(dim=axis, keepdim=True)
    v = x.var(dim=axis, keepdim=True, unbiased=False)
    return (x - m) / torch.sqrt(v + eps)

def _scatter_add(tgt, idx, src, axis=0):
    return tgt.clone().index_add_(axis, idx, src)

def _segment_sum(src, seg, n):
    out = torch.zeros((n,) + src.shape[1:], dtype=src.dtype)
    return out.index_add_(0, seg, src)

def _pad(x, pw):
    flat = tuple((v for pair in reversed(pw) for v in pair))
    return torch.nn.functional.pad(x, flat)
kernel_name = 'recurrent_scan__ssm_conv_s4d__mixer_gmlp__prompt'

def setup_inputs():

    _w = lambda a: (lambda t: t.to(torch.bfloat16) if t.is_floating_point() else t)(torch.as_tensor(a))

    def _A_setup():
        Bsz, L, D, N = (1, 2048, 576, 128)
        return {'u': _w((lambda *s: torch.randn(*s, dtype=torch.bfloat16) * 0.05)(Bsz, L, D)), 'log_A_real': _w((lambda *s: torch.randn(*s, dtype=torch.bfloat16) * 6.4)(D, N) * 0.5), 'A_imag': _w((lambda *s: torch.randn(*s, dtype=torch.bfloat16) * 0.05)(D, N) * 3.14), 'C_real': _w((lambda *s: torch.randn(*s, dtype=torch.bfloat16) * 0.05)(D, N) / N ** 0.5), 'C_imag': _w((lambda *s: torch.randn(*s, dtype=torch.bfloat16) * 0.05)(D, N) / N ** 0.5), 'log_dt': _w((lambda *s: torch.randn(*s, dtype=torch.bfloat16) * 0.05)(D) * 0.5 - 4.0), 'D_skip': _w((lambda *s: torch.randn(*s, dtype=torch.bfloat16) * 0.05)(D))}
    _A_in = _A_setup()

    def _B_setup():
        B, S, D, F = (1, 2048, 576, 4608)
        Fh = F // 2
        return {'x': _w((lambda *s: torch.randn(*s, dtype=torch.bfloat16) * 0.05)(B, S, D)), 'w_in': _w((lambda *s: torch.randn(*s, dtype=torch.bfloat16) * 0.4)(D, 2 * Fh)), 'w_sp': _w(0.01 * (lambda *s: torch.randn(*s, dtype=torch.bfloat16) * 0.4)(S, S)), 'b_sp': _w(1.0 + 0.01 * (lambda *s: torch.randn(*s, dtype=torch.bfloat16) * 0.05)(S)), 'w_out': _w((lambda *s: torch.randn(*s, dtype=torch.bfloat16) * 0.05)(Fh, D))}
    _B_in = _B_setup()
    return {'A_u': _A_in['u'], 'A_log_A_real': _A_in['log_A_real'], 'A_A_imag': _A_in['A_imag'], 'A_C_real': _A_in['C_real'], 'A_C_imag': _A_in['C_imag'], 'A_log_dt': _A_in['log_dt'], 'A_D_skip': _A_in['D_skip'], 'B_x': _B_in['x'], 'B_w_in': _B_in['w_in'], 'B_w_sp': _B_in['w_sp'], 'B_b_sp': _B_in['b_sp'], 'B_w_out': _B_in['w_out']}

def reference(A_u, A_log_A_real, A_A_imag, A_C_real, A_C_imag, A_log_dt, A_D_skip, B_x, B_w_in, B_w_sp, B_b_sp, B_w_out):

    def _A_ref(u, log_A_real, A_imag, C_real, C_imag, log_dt, D_skip):
        L = u.shape[1]
        dt = torch.exp(log_dt)
        A = -torch.exp(log_A_real) + 1j * A_imag
        C = (C_real + 1j * C_imag) * dt[:, None]
        pos = (lambda x, dt: x.to(dt))(torch.arange(L), log_dt.dtype)
        P = torch.exp((A * dt[:, None])[:, :, None] * pos[None, None, :])
        K = 2.0 * torch.einsum('dn,dnl->dl', C, P).real
        L2 = 2 * L
        u_t = (lambda x, *d: x.permute(*d))(u, 0, 2, 1)
        Kf = (lambda x, *a, **k: torch.fft.rfft(x.float(), *a, **k))(K, L2)
        Uf = (lambda x, *a, **k: torch.fft.rfft(x.float(), *a, **k))(u_t, L2)
        y = (lambda x, *a, **k: torch.fft.irfft(x, *a, **k).to(torch.bfloat16))(Uf * Kf[None, :, :], L2)[:, :, :L]
        y = (lambda x, *d: x.permute(*d))(y, 0, 2, 1)
        return y + u * D_skip[None, None, :]

    def _B_ref(x, w_in, w_sp, b_sp, w_out):
        B, S, D = x.shape
        F = w_in.shape[-1]
        Fh = F // 2
        z = _gelu(torch.einsum('bsd,df->bsf', x, w_in))
        z1 = z[..., :Fh].clone()
        z2 = _layernorm(z[..., Fh:], axis=-1)
        g = torch.einsum('ts,bsf->btf', w_sp, z2) + b_sp[None, :, None]
        return torch.einsum('bsf,fd->bsd', z1 * g, w_out)
    x = A_u
    xn = _layernorm(x, axis=-1)
    s = _A_ref(xn, A_log_A_real, A_A_imag, A_C_real, A_C_imag, A_log_dt, A_D_skip)
    g = _silu(_B_ref(xn, B_w_in, B_w_sp, B_b_sp, B_w_out))
    return x + s * g
```

```asm
; @launch kernel=l0_kernel grid=(968,1,1) block=(256,1,1) lds=36864
; @launch kernel=m_kernel grid=(256,1,1) block=(256,1,1) lds=163840
.amdgcn_target "amdgcn-amd-amdhsa--gfx950"
.text
.globl l0_kernel
.p2align 8
.type l0_kernel,@function
l0_kernel:
    s_cmp_ge_u32 s2, 968
    s_cbranch_scc1 l0_kernel_end
    s_load_dwordx4 s[28:31], s[0:1], 0
    s_load_dwordx8 s[56:63], s[0:1], 8
    s_load_dwordx2 s[64:65], s[0:1], 40
    s_load_dwordx4 s[88:91], s[0:1], 64
    s_load_dwordx2 s[92:93], s[0:1], 88
    s_load_dwordx2 s[32:33], s[0:1], 112

    v_lshrrev_b32 v1, 6, v0
    v_and_b32 v15, 63, v0
    s_nop 0
    v_readfirstlane_b32 s36, v1
    s_waitcnt lgkmcnt(0)
    s_cmp_ge_u32 s2, 128
    s_cbranch_scc1 l0_kernel_r1

    s_and_b32 s44, s2, 7
    s_lshl_b32 s44, s44, 4
    s_lshr_b32 s45, s2, 3
    s_add_u32 s66, s44, s45
    s_mov_b32 s4, s28
    s_and_b32 s5, s29, 0xffff
    s_mov_b32 s6, 2359296
    s_mov_b32 s7, 0x00020000
    s_add_u32 s8, s32, 0
    s_addc_u32 s9, s33, 0
    s_and_b32 s9, s9, 0xffff
    s_mov_b32 s10, 2359296
    s_mov_b32 s11, 0x00020000
    s_add_u32 s12, s32, 4194304
    s_addc_u32 s13, s33, 0
    s_and_b32 s13, s13, 0xffff
    s_mov_b32 s14, 2359296
    s_mov_b32 s15, 0x00020000
    s_lshl_b32 s44, s66, 4
    s_lshl_b32 s45, s36, 2
    s_add_u32 s44, s44, s45
    v_lshrrev_b32 v1, 4, v15
    v_add_u32 v2, s44, v1
    v_mul_u32_u24 v2, 1152, v2
    v_and_b32 v3, 15, v15
    v_lshlrev_b32 v4, 4, v3
    v_add_u32 v2, v2, v4

    buffer_load_dwordx4 v[16:19], v2, s[4:7], 0 offen offset:0
    buffer_load_dwordx4 v[20:23], v2, s[4:7], 0 offen offset:256
    buffer_load_dwordx4 v[24:27], v2, s[4:7], 0 offen offset:512
    buffer_load_dwordx4 v[28:31], v2, s[4:7], 0 offen offset:768
    s_mov_b32 s50, 0x00ff00ff
    s_mov_b32 s51, 0x00ff00ff
    v_mov_b32 v32, 0
    v_mov_b32 v33, 0
    v_mov_b32 v34, 0
    v_mov_b32 v35, 0
    s_mov_b64 exec, s[50:51]
    buffer_load_dwordx4 v[32:35], v2, s[4:7], 0 offen offset:1024
    s_mov_b64 exec, -1
    v_add_u32 v5, s45, v1
    v_mul_u32_u24 v5, 1168, v5
    v_add_u32 v5, v5, v4
    s_waitcnt vmcnt(0)

    v_lshlrev_b32 v40, 16, v16
    v_and_b32 v41, 0xffff0000, v16
    v_lshlrev_b32 v42, 16, v17
    v_and_b32 v43, 0xffff0000, v17
    v_lshlrev_b32 v44, 16, v18
    v_and_b32 v45, 0xffff0000, v18
    v_lshlrev_b32 v46, 16, v19
    v_and_b32 v47, 0xffff0000, v19
    v_lshlrev_b32 v48, 16, v20
    v_and_b32 v49, 0xffff0000, v20
    v_lshlrev_b32 v50, 16, v21
    v_and_b32 v51, 0xffff0000, v21
    v_lshlrev_b32 v52, 16, v22
    v_and_b32 v53, 0xffff0000, v22
    v_lshlrev_b32 v54, 16, v23
    v_and_b32 v55, 0xffff0000, v23
    v_lshlrev_b32 v56, 16, v24
    v_and_b32 v57, 0xffff0000, v24
    v_lshlrev_b32 v58, 16, v25
    v_and_b32 v59, 0xffff0000, v25
    v_lshlrev_b32 v60, 16, v26
    v_and_b32 v61, 0xffff0000, v26
    v_lshlrev_b32 v62, 16, v27
    v_and_b32 v63, 0xffff0000, v27
    v_lshlrev_b32 v64, 16, v28
    v_and_b32 v65, 0xffff0000, v28
    v_lshlrev_b32 v66, 16, v29
    v_and_b32 v67, 0xffff0000, v29
    v_lshlrev_b32 v68, 16, v30
    v_and_b32 v69, 0xffff0000, v30
    v_lshlrev_b32 v70, 16, v31
    v_and_b32 v71, 0xffff0000, v31
    v_lshlrev_b32 v72, 16, v32
    v_and_b32 v73, 0xffff0000, v32
    v_lshlrev_b32 v74, 16, v33
    v_and_b32 v75, 0xffff0000, v33
    v_lshlrev_b32 v76, 16, v34
    v_and_b32 v77, 0xffff0000, v34
    v_lshlrev_b32 v78, 16, v35
    v_and_b32 v79, 0xffff0000, v35
    v_add_f32 v6, v40, v41
    v_add_f32 v6, v6, v42
    v_add_f32 v6, v6, v43
    v_add_f32 v6, v6, v44
    v_add_f32 v6, v6, v45
    v_add_f32 v6, v6, v46
    v_add_f32 v6, v6, v47
    v_add_f32 v6, v6, v48
    v_add_f32 v6, v6, v49
    v_add_f32 v6, v6, v50
    v_add_f32 v6, v6, v51
    v_add_f32 v6, v6, v52
    v_add_f32 v6, v6, v53
    v_add_f32 v6, v6, v54
    v_add_f32 v6, v6, v55
    v_add_f32 v6, v6, v56
    v_add_f32 v6, v6, v57
    v_add_f32 v6, v6, v58
    v_add_f32 v6, v6, v59
    v_add_f32 v6, v6, v60
    v_add_f32 v6, v6, v61
    v_add_f32 v6, v6, v62
    v_add_f32 v6, v6, v63
    v_add_f32 v6, v6, v64
    v_add_f32 v6, v6, v65
    v_add_f32 v6, v6, v66
    v_add_f32 v6, v6, v67
    v_add_f32 v6, v6, v68
    v_add_f32 v6, v6, v69
    v_add_f32 v6, v6, v70
    v_add_f32 v6, v6, v71
    v_add_f32 v6, v6, v72
    v_add_f32 v6, v6, v73
    v_add_f32 v6, v6, v74
    v_add_f32 v6, v6, v75
    v_add_f32 v6, v6, v76
    v_add_f32 v6, v6, v77
    v_add_f32 v6, v6, v78
    v_add_f32 v6, v6, v79
    s_nop 1
    v_add_f32_dpp v6, v6, v6 row_ror:8 row_mask:0xf bank_mask:0xf
    s_nop 1
    v_add_f32_dpp v6, v6, v6 row_ror:4 row_mask:0xf bank_mask:0xf
    s_nop 1
    v_add_f32_dpp v6, v6, v6 row_ror:2 row_mask:0xf bank_mask:0xf
    s_nop 1
    v_add_f32_dpp v6, v6, v6 row_ror:1 row_mask:0xf bank_mask:0xf
    v_mul_f32 v6, 0x3ae38e39, v6
    v_mov_b32 v7, 0
    v_sub_f32 v8, v40, v6
    v_fmac_f32 v7, v8, v8
    v_sub_f32 v8, v41, v6
    v_fmac_f32 v7, v8, v8
    v_sub_f32 v8, v42, v6
    v_fmac_f32 v7, v8, v8
    v_sub_f32 v8, v43, v6
    v_fmac_f32 v7, v8, v8
    v_sub_f32 v8, v44, v6
    v_fmac_f32 v7, v8, v8
    v_sub_f32 v8, v45, v6
    v_fmac_f32 v7, v8, v8
    v_sub_f32 v8, v46, v6
    v_fmac_f32 v7, v8, v8
    v_sub_f32 v8, v47, v6
    v_fmac_f32 v7, v8, v8
    v_sub_f32 v8, v48, v6
    v_fmac_f32 v7, v8, v8
    v_sub_f32 v8, v49, v6
    v_fmac_f32 v7, v8, v8
    v_sub_f32 v8, v50, v6
    v_fmac_f32 v7, v8, v8
    v_sub_f32 v8, v51, v6
    v_fmac_f32 v7, v8, v8
    v_sub_f32 v8, v52, v6
    v_fmac_f32 v7, v8, v8
    v_sub_f32 v8, v53, v6
    v_fmac_f32 v7, v8, v8
    v_sub_f32 v8, v54, v6
    v_fmac_f32 v7, v8, v8
    v_sub_f32 v8, v55, v6
    v_fmac_f32 v7, v8, v8
    v_sub_f32 v8, v56, v6
    v_fmac_f32 v7, v8, v8
    v_sub_f32 v8, v57, v6
    v_fmac_f32 v7, v8, v8
    v_sub_f32 v8, v58, v6
    v_fmac_f32 v7, v8, v8
    v_sub_f32 v8, v59, v6
    v_fmac_f32 v7, v8, v8
    v_sub_f32 v8, v60, v6
    v_fmac_f32 v7, v8, v8
    v_sub_f32 v8, v61, v6
    v_fmac_f32 v7, v8, v8
    v_sub_f32 v8, v62, v6
    v_fmac_f32 v7, v8, v8
    v_sub_f32 v8, v63, v6
    v_fmac_f32 v7, v8, v8
    v_sub_f32 v8, v64, v6
    v_fmac_f32 v7, v8, v8
    v_sub_f32 v8, v65, v6
    v_fmac_f32 v7, v8, v8
    v_sub_f32 v8, v66, v6
    v_fmac_f32 v7, v8, v8
    v_sub_f32 v8, v67, v6
    v_fmac_f32 v7, v8, v8
    v_sub_f32 v8, v68, v6
    v_fmac_f32 v7, v8, v8
    v_sub_f32 v8, v69, v6
    v_fmac_f32 v7, v8, v8
    v_sub_f32 v8, v70, v6
    v_fmac_f32 v7, v8, v8
    v_sub_f32 v8, v71, v6
    v_fmac_f32 v7, v8, v8
    s_mov_b64 exec, s[50:51]
    v_sub_f32 v8, v72, v6
    v_fmac_f32 v7, v8, v8
    v_sub_f32 v8, v73, v6
    v_fmac_f32 v7, v8, v8
    v_sub_f32 v8, v74, v6
    v_fmac_f32 v7, v8, v8
    v_sub_f32 v8, v75, v6
    v_fmac_f32 v7, v8, v8
    v_sub_f32 v8, v76, v6
    v_fmac_f32 v7, v8, v8
    v_sub_f32 v8, v77, v6
    v_fmac_f32 v7, v8, v8
    v_sub_f32 v8, v78, v6
    v_fmac_f32 v7, v8, v8
    v_sub_f32 v8, v79, v6
    v_fmac_f32 v7, v8, v8
    s_mov_b64 exec, -1
    s_nop 1
    v_add_f32_dpp v7, v7, v7 row_ror:8 row_mask:0xf bank_mask:0xf
    s_nop 1
    v_add_f32_dpp v7, v7, v7 row_ror:4 row_mask:0xf bank_mask:0xf
    s_nop 1
    v_add_f32_dpp v7, v7, v7 row_ror:2 row_mask:0xf bank_mask:0xf
    s_nop 1
    v_add_f32_dpp v7, v7, v7 row_ror:1 row_mask:0xf bank_mask:0xf
    v_mul_f32 v7, 0x3ae38e39, v7
    v_cvt_pk_bf16_f32 v7, v7, v7
    v_and_b32 v7, 0xffff0000, v7
    v_add_f32 v7, 0x3727c5ac, v7
    v_cvt_pk_bf16_f32 v7, v7, v7
    v_and_b32 v7, 0xffff0000, v7
    v_sqrt_f32 v7, v7
    s_nop 0
    v_cvt_pk_bf16_f32 v7, v7, v7
    v_and_b32 v7, 0xffff0000, v7
    v_rcp_f32 v7, v7
    v_cvt_pk_bf16_f32 v6, v6, v6
    v_and_b32 v6, 0xffff0000, v6
    v_sub_f32 v40, v40, v6
    v_sub_f32 v41, v41, v6
    v_cvt_pk_bf16_f32 v8, v40, v41
    v_lshlrev_b32 v40, 16, v8
    v_and_b32 v41, 0xffff0000, v8
    v_mul_f32 v40, v40, v7
    v_mul_f32 v41, v41, v7
    v_cvt_pk_bf16_f32 v16, v40, v41
    v_sub_f32 v42, v42, v6
    v_sub_f32 v43, v43, v6
    v_cvt_pk_bf16_f32 v8, v42, v43
    v_lshlrev_b32 v42, 16, v8
    v_and_b32 v43, 0xffff0000, v8
    v_mul_f32 v42, v42, v7
    v_mul_f32 v43, v43, v7
    v_cvt_pk_bf16_f32 v17, v42, v43
    v_sub_f32 v44, v44, v6
    v_sub_f32 v45, v45, v6
    v_cvt_pk_bf16_f32 v8, v44, v45
    v_lshlrev_b32 v44, 16, v8
    v_and_b32 v45, 0xffff0000, v8
    v_mul_f32 v44, v44, v7
    v_mul_f32 v45, v45, v7
    v_cvt_pk_bf16_f32 v18, v44, v45
    v_sub_f32 v46, v46, v6
    v_sub_f32 v47, v47, v6
    v_cvt_pk_bf16_f32 v8, v46, v47
    v_lshlrev_b32 v46, 16, v8
    v_and_b32 v47, 0xffff0000, v8
    v_mul_f32 v46, v46, v7
    v_mul_f32 v47, v47, v7
    v_cvt_pk_bf16_f32 v19, v46, v47
    v_sub_f32 v48, v48, v6
    v_sub_f32 v49, v49, v6
    v_cvt_pk_bf16_f32 v8, v48, v49
    v_lshlrev_b32 v48, 16, v8
    v_and_b32 v49, 0xffff0000, v8
    v_mul_f32 v48, v48, v7
    v_mul_f32 v49, v49, v7
    v_cvt_pk_bf16_f32 v20, v48, v49
    v_sub_f32 v50, v50, v6
    v_sub_f32 v51, v51, v6
    v_cvt_pk_bf16_f32 v8, v50, v51
    v_lshlrev_b32 v50, 16, v8
    v_and_b32 v51, 0xffff0000, v8
    v_mul_f32 v50, v50, v7
    v_mul_f32 v51, v51, v7
    v_cvt_pk_bf16_f32 v21, v50, v51
    v_sub_f32 v52, v52, v6
    v_sub_f32 v53, v53, v6
    v_cvt_pk_bf16_f32 v8, v52, v53
    v_lshlrev_b32 v52, 16, v8
    v_and_b32 v53, 0xffff0000, v8
    v_mul_f32 v52, v52, v7
    v_mul_f32 v53, v53, v7
    v_cvt_pk_bf16_f32 v22, v52, v53
    v_sub_f32 v54, v54, v6
    v_sub_f32 v55, v55, v6
    v_cvt_pk_bf16_f32 v8, v54, v55
    v_lshlrev_b32 v54, 16, v8
    v_and_b32 v55, 0xffff0000, v8
    v_mul_f32 v54, v54, v7
    v_mul_f32 v55, v55, v7
    v_cvt_pk_bf16_f32 v23, v54, v55
    v_sub_f32 v56, v56, v6
    v_sub_f32 v57, v57, v6
    v_cvt_pk_bf16_f32 v8, v56, v57
    v_lshlrev_b32 v56, 16, v8
    v_and_b32 v57, 0xffff0000, v8
    v_mul_f32 v56, v56, v7
    v_mul_f32 v57, v57, v7
    v_cvt_pk_bf16_f32 v24, v56, v57
    v_sub_f32 v58, v58, v6
    v_sub_f32 v59, v59, v6
    v_cvt_pk_bf16_f32 v8, v58, v59
    v_lshlrev_b32 v58, 16, v8
    v_and_b32 v59, 0xffff0000, v8
    v_mul_f32 v58, v58, v7
    v_mul_f32 v59, v59, v7
    v_cvt_pk_bf16_f32 v25, v58, v59
    v_sub_f32 v60, v60, v6
    v_sub_f32 v61, v61, v6
    v_cvt_pk_bf16_f32 v8, v60, v61
    v_lshlrev_b32 v60, 16, v8
    v_and_b32 v61, 0xffff0000, v8
    v_mul_f32 v60, v60, v7
    v_mul_f32 v61, v61, v7
    v_cvt_pk_bf16_f32 v26, v60, v61
    v_sub_f32 v62, v62, v6
    v_sub_f32 v63, v63, v6
    v_cvt_pk_bf16_f32 v8, v62, v63
    v_lshlrev_b32 v62, 16, v8
    v_and_b32 v63, 0xffff0000, v8
    v_mul_f32 v62, v62, v7
    v_mul_f32 v63, v63, v7
    v_cvt_pk_bf16_f32 v27, v62, v63
    v_sub_f32 v64, v64, v6
    v_sub_f32 v65, v65, v6
    v_cvt_pk_bf16_f32 v8, v64, v65
    v_lshlrev_b32 v64, 16, v8
    v_and_b32 v65, 0xffff0000, v8
    v_mul_f32 v64, v64, v7
    v_mul_f32 v65, v65, v7
    v_cvt_pk_bf16_f32 v28, v64, v65
    v_sub_f32 v66, v66, v6
    v_sub_f32 v67, v67, v6
    v_cvt_pk_bf16_f32 v8, v66, v67
    v_lshlrev_b32 v66, 16, v8
    v_and_b32 v67, 0xffff0000, v8
    v_mul_f32 v66, v66, v7
    v_mul_f32 v67, v67, v7
    v_cvt_pk_bf16_f32 v29, v66, v67
    v_sub_f32 v68, v68, v6
    v_sub_f32 v69, v69, v6
    v_cvt_pk_bf16_f32 v8, v68, v69
    v_lshlrev_b32 v68, 16, v8
    v_and_b32 v69, 0xffff0000, v8
    v_mul_f32 v68, v68, v7
    v_mul_f32 v69, v69, v7
    v_cvt_pk_bf16_f32 v30, v68, v69
    v_sub_f32 v70, v70, v6
    v_sub_f32 v71, v71, v6
    v_cvt_pk_bf16_f32 v8, v70, v71
    v_lshlrev_b32 v70, 16, v8
    v_and_b32 v71, 0xffff0000, v8
    v_mul_f32 v70, v70, v7
    v_mul_f32 v71, v71, v7
    v_cvt_pk_bf16_f32 v31, v70, v71
    v_sub_f32 v72, v72, v6
    v_sub_f32 v73, v73, v6
    v_cvt_pk_bf16_f32 v8, v72, v73
    v_lshlrev_b32 v72, 16, v8
    v_and_b32 v73, 0xffff0000, v8
    v_mul_f32 v72, v72, v7
    v_mul_f32 v73, v73, v7
    v_cvt_pk_bf16_f32 v32, v72, v73
    v_sub_f32 v74, v74, v6
    v_sub_f32 v75, v75, v6
    v_cvt_pk_bf16_f32 v8, v74, v75
    v_lshlrev_b32 v74, 16, v8
    v_and_b32 v75, 0xffff0000, v8
    v_mul_f32 v74, v74, v7
    v_mul_f32 v75, v75, v7
    v_cvt_pk_bf16_f32 v33, v74, v75
    v_sub_f32 v76, v76, v6
    v_sub_f32 v77, v77, v6
    v_cvt_pk_bf16_f32 v8, v76, v77
    v_lshlrev_b32 v76, 16, v8
    v_and_b32 v77, 0xffff0000, v8
    v_mul_f32 v76, v76, v7
    v_mul_f32 v77, v77, v7
    v_cvt_pk_bf16_f32 v34, v76, v77
    v_sub_f32 v78, v78, v6
    v_sub_f32 v79, v79, v6
    v_cvt_pk_bf16_f32 v8, v78, v79
    v_lshlrev_b32 v78, 16, v8
    v_and_b32 v79, 0xffff0000, v8
    v_mul_f32 v78, v78, v7
    v_mul_f32 v79, v79, v7
    v_cvt_pk_bf16_f32 v35, v78, v79
    ds_write_b128 v5, v[16:19] offset:0
    ds_write_b128 v5, v[20:23] offset:256
    ds_write_b128 v5, v[24:27] offset:512
    ds_write_b128 v5, v[28:31] offset:768
    s_mov_b64 exec, s[50:51]
    ds_write_b128 v5, v[32:35] offset:1024
    s_mov_b64 exec, -1
    s_waitcnt lgkmcnt(0)
    s_barrier
    v_and_b32 v1, 15, v15
    v_mul_u32_u24 v1, 1168, v1
    v_lshrrev_b32 v2, 4, v15
    v_lshlrev_b32 v2, 4, v2
    v_add_u32 v1, v1, v2
    s_lshl_b32 s45, s36, 6
    v_add_u32 v1, s45, v1
    v_lshlrev_b32 v3, 4, v15
    s_mul_i32 s44, s66, 18
    s_add_u32 s44, s44, s36
    s_lshl_b32 s44, s44, 10

    ds_read_b128 v[16:19], v1 offset:0
    ds_read_b128 v[20:23], v1 offset:256
    ds_read_b128 v[24:27], v1 offset:512
    ds_read_b128 v[28:31], v1 offset:768
    s_cmp_lt_u32 s36, 2
    s_cbranch_scc0 l0_kernel_ln_1
    ds_read_b128 v[32:35], v1 offset:1024
    s_waitcnt lgkmcnt(0)
    s_add_u32 s45, s44, 16384
    buffer_store_dwordx4 v[32:35], v3, s[8:11], s45 offen sc1
l0_kernel_ln_1:
    s_waitcnt lgkmcnt(0)
    s_add_u32 s45, s44, 0
    buffer_store_dwordx4 v[16:19], v3, s[8:11], s45 offen sc1
    s_add_u32 s45, s44, 4096
    buffer_store_dwordx4 v[20:23], v3, s[8:11], s45 offen sc1
    s_add_u32 s45, s44, 8192
    buffer_store_dwordx4 v[24:27], v3, s[8:11], s45 offen sc1
    s_add_u32 s45, s44, 12288
    buffer_store_dwordx4 v[28:31], v3, s[8:11], s45 offen sc1
    v_lshrrev_b32 v1, 2, v15
    v_mul_u32_u24 v1, 1168, v1
    v_and_b32 v2, 3, v15
    v_lshlrev_b32 v2, 3, v2
    v_add_u32 v1, v1, v2
    s_mul_i32 s45, s36, 288
    v_add_u32 v1, s45, v1
    v_and_b32 v2, 15, v15
    v_lshlrev_b32 v2, 12, v2
    v_lshrrev_b32 v3, 4, v15
    v_lshlrev_b32 v3, 3, v3
    v_add_u32 v2, v2, v3
    s_lshl_b32 s44, s66, 5
    s_mul_i32 s45, s36, 589824
    s_add_u32 s44, s44, s45

    ds_read_b64_tr_b16 v[40:41], v1 offset:0
    ds_read_b64_tr_b16 v[42:43], v1 offset:32
    ds_read_b64_tr_b16 v[44:45], v1 offset:64
    ds_read_b64_tr_b16 v[46:47], v1 offset:96
    ds_read_b64_tr_b16 v[48:49], v1 offset:128
    ds_read_b64_tr_b16 v[50:51], v1 offset:160
    ds_read_b64_tr_b16 v[52:53], v1 offset:192
    ds_read_b64_tr_b16 v[54:55], v1 offset:224
    ds_read_b64_tr_b16 v[56:57], v1 offset:256
    s_waitcnt lgkmcnt(0)
    s_add_u32 s45, s44, 0
    buffer_store_dwordx2 v[40:41], v2, s[12:15], s45 offen
    s_add_u32 s45, s44, 65536
    buffer_store_dwordx2 v[42:43], v2, s[12:15], s45 offen
    s_add_u32 s45, s44, 131072
    buffer_store_dwordx2 v[44:45], v2, s[12:15], s45 offen
    s_add_u32 s45, s44, 196608
    buffer_store_dwordx2 v[46:47], v2, s[12:15], s45 offen
    s_add_u32 s45, s44, 262144
    buffer_store_dwordx2 v[48:49], v2, s[12:15], s45 offen
    s_add_u32 s45, s44, 327680
    buffer_store_dwordx2 v[50:51], v2, s[12:15], s45 offen
    s_add_u32 s45, s44, 393216
    buffer_store_dwordx2 v[52:53], v2, s[12:15], s45 offen
    s_add_u32 s45, s44, 458752
    buffer_store_dwordx2 v[54:55], v2, s[12:15], s45 offen
    s_add_u32 s45, s44, 524288
    buffer_store_dwordx2 v[56:57], v2, s[12:15], s45 offen
    s_add_u32 s16, s32, 48234496
    s_addc_u32 s17, s33, 0
    s_and_b32 s17, s17, 0xffff
    s_mov_b32 s18, 262144
    s_mov_b32 s19, 0x00020000
    s_cmp_eq_u32 s36, 0
    s_cbranch_scc0 l0_kernel_rs_2
    v_lshrrev_b32 v1, 2, v15
    v_lshlrev_b32 v1, 10, v1
    v_and_b32 v2, 3, v15
    v_lshlrev_b32 v2, 5, v2
    v_add_u32 v1, v1, v2
    s_lshr_b32 s44, s66, 3
    s_lshl_b32 s44, s44, 14
    s_and_b32 s45, s66, 7
    s_lshl_b32 s45, s45, 7
    s_add_u32 s44, s44, s45
    v_mov_b32 v16, -1
    v_mov_b32 v17, -1
    v_mov_b32 v18, -1
    v_mov_b32 v19, -1
    buffer_store_dwordx4 v[16:19], v1, s[16:19], s44 offen sc1
    buffer_store_dwordx4 v[16:19], v1, s[16:19], s44 offen offset:16 sc1

l0_kernel_rs_2:
    s_add_u32 s16, s32, 49283072
    s_addc_u32 s17, s33, 0
    s_and_b32 s17, s17, 0xffff
    s_mov_b32 s18, 524288
    s_mov_b32 s19, 0x00020000
    s_cmp_eq_u32 s36, 1
    s_cbranch_scc0 l0_kernel_fz_3
    s_lshl_b32 s44, s66, 12
    v_lshlrev_b32 v1, 7, v15
    v_mov_b32 v16, 0
    s_mov_b32 exec_hi, 0
    buffer_store_dword v16, v1, s[16:19], s44 offen sc1
    s_mov_b64 exec, -1
l0_kernel_fz_3:
    s_endpgm
l0_kernel_r1:
    s_cmp_ge_u32 s2, 704
    s_cbranch_scc1 l0_kernel_r2
    s_sub_u32 s47, s2, 128
    s_mov_b32 s4, s56
    s_and_b32 s5, s57, 0xffff
    s_mov_b32 s6, 147456
    s_mov_b32 s7, 0x00020000
    s_mov_b32 s8, s58
    s_and_b32 s9, s59, 0xffff
    s_mov_b32 s10, 147456
    s_mov_b32 s11, 0x00020000
    s_mov_b32 s12, s60
    s_and_b32 s13, s61, 0xffff
    s_mov_b32 s14, 147456
    s_mov_b32 s15, 0x00020000
    s_mov_b32 s16, s62
    s_and_b32 s17, s63, 0xffff
    s_mov_b32 s18, 147456
    s_mov_b32 s19, 0x00020000
    s_mov_b32 s20, s64
    s_and_b32 s21, s65, 0xffff
    s_mov_b32 s22, 1152
    s_mov_b32 s23, 0x00020000
    s_mov_b32 s39, 0
    s_lshl_b32 s44, s47, 1
    v_mov_b32 v1, s44
    buffer_load_ushort v121, v1, s[20:23], 0 offen
    v_lshrrev_b32 v122, 4, v15
    v_lshlrev_b32 v122, 3, v122
    s_lshl_b32 s44, s47, 8
    s_lshl_b32 s45, s36, 6
    s_add_u32 s44, s44, s45
    v_add_u32 v122, s44, v122

    buffer_load_dwordx2 v[16:17], v122, s[4:7], 0 offen offset:0
    buffer_load_dwordx2 v[18:19], v122, s[8:11], 0 offen offset:0
    buffer_load_dwordx2 v[20:21], v122, s[12:15], 0 offen offset:0
    buffer_load_dwordx2 v[22:23], v122, s[16:19], 0 offen offset:0
    buffer_load_dwordx2 v[24:25], v122, s[4:7], 0 offen offset:32
    buffer_load_dwordx2 v[26:27], v122, s[8:11], 0 offen offset:32
    buffer_load_dwordx2 v[28:29], v122, s[12:15], 0 offen offset:32
    buffer_load_dwordx2 v[30:31], v122, s[16:19], 0 offen offset:32
    v_and_b32 v1, 15, v15
    v_cvt_f32_u32 v120, v1
    v_mov_b32 v48, 0
    v_mov_b32 v49, 0
    v_mov_b32 v50, 0
    v_mov_b32 v51, 0
    v_mov_b32 v52, 0
    v_mov_b32 v53, 0
    v_mov_b32 v54, 0
    v_mov_b32 v55, 0
    v_mov_b32 v56, 0
    v_mov_b32 v57, 0
    v_mov_b32 v58, 0
    v_mov_b32 v59, 0
    v_mov_b32 v60, 0
    v_mov_b32 v61, 0
    v_mov_b32 v62, 0
    v_mov_b32 v63, 0
    v_lshlrev_b32 v1, 3, v15
    v_add_u32 v1, s39, v1
    v_mov_b32 v8, 0
    v_mov_b32 v9, 0
    ds_write_b64 v1, v[8:9] offset:20736
    s_waitcnt vmcnt(0)
    v_lshlrev_b32 v121, 16, v121
    v_mul_f32 v121, 0x3fb8aa3b, v121
    v_exp_f32 v121, v121
    s_nop 0
    v_cvt_pk_bf16_f32 v121, v121, v121
    v_and_b32 v121, 0xffff0000, v121
    v_add_f32 v5, v121, v121
    v_mul_f32 v6, 0xbfb8aa3b, v121
    v_mul_f32 v7, 0x3e22f983, v121
    s_mov_b32 s52, 0
l0_kernel_kl_4:
    v_lshlrev_b32 v80, 16, v16
    v_lshlrev_b32 v81, 16, v18
    v_lshlrev_b32 v72, 16, v20
    v_lshlrev_b32 v73, 16, v22
    v_and_b32 v82, 0xffff0000, v16
    v_and_b32 v83, 0xffff0000, v18
    v_and_b32 v74, 0xffff0000, v20
    v_and_b32 v75, 0xffff0000, v22
    v_lshlrev_b32 v84, 16, v17
    v_lshlrev_b32 v85, 16, v19
    v_lshlrev_b32 v76, 16, v21
    v_lshlrev_b32 v77, 16, v23
    v_and_b32 v86, 0xffff0000, v17
    v_and_b32 v87, 0xffff0000, v19
    v_and_b32 v78, 0xffff0000, v21
    v_and_b32 v79, 0xffff0000, v23
    v_mul_f32 v80, 0x3fb8aa3b, v80
    v_mul_f32 v82, 0x3fb8aa3b, v82
    v_mul_f32 v84, 0x3fb8aa3b, v84
    v_mul_f32 v86, 0x3fb8aa3b, v86
    v_exp_f32 v80, v80
    v_exp_f32 v82, v82
    v_exp_f32 v84, v84
    v_exp_f32 v86, v86
    v_mul_f32 v81, v81, v7
    v_mul_f32 v83, v83, v7
    v_mul_f32 v85, v85, v7
    v_mul_f32 v87, v87, v7
    v_cvt_pk_bf16_f32 v80, v80, v80
    v_cvt_pk_bf16_f32 v82, v82, v82
    v_cvt_pk_bf16_f32 v84, v84, v84
    v_cvt_pk_bf16_f32 v86, v86, v86
    v_and_b32 v80, 0xffff0000, v80
    v_and_b32 v82, 0xffff0000, v82
    v_and_b32 v84, 0xffff0000, v84
    v_and_b32 v86, 0xffff0000, v86
    v_mul_f32 v72, v72, v5
    v_mul_f32 v74, v74, v5
    v_mul_f32 v76, v76, v5
    v_mul_f32 v78, v78, v5
    v_mul_f32 v73, v73, v5
    v_mul_f32 v75, v75, v5
    v_mul_f32 v77, v77, v5
    v_mul_f32 v79, v79, v5
    v_mul_f32 v80, v80, v6
    v_mul_f32 v82, v82, v6
    v_mul_f32 v84, v84, v6
    v_mul_f32 v86, v86, v6
    v_mul_f32 v80, v80, v120
    v_mul_f32 v82, v82, v120
    v_mul_f32 v84, v84, v120
    v_mul_f32 v86, v86, v120
    v_mul_f32 v81, v81, v120
    v_mul_f32 v83, v83, v120
    v_mul_f32 v85, v85, v120
    v_mul_f32 v87, v87, v120
    v_exp_f32 v80, v80
    v_exp_f32 v82, v82
    v_exp_f32 v84, v84
    v_exp_f32 v86, v86
    v_fract_f32 v81, v81
    v_fract_f32 v83, v83
    v_fract_f32 v85, v85
    v_fract_f32 v87, v87
    v_cos_f32 v64, v81
    v_cos_f32 v66, v83
    v_cos_f32 v68, v85
    v_cos_f32 v70, v87
    v_sin_f32 v65, v81
    v_sin_f32 v67, v83
    v_sin_f32 v69, v85
    v_sin_f32 v71, v87
    v_mul_f32 v64, v64, v80
    v_mul_f32 v66, v66, v82
    v_mul_f32 v68, v68, v84
    v_mul_f32 v70, v70, v86
    v_mul_f32 v65, v65, v80
    v_mul_f32 v67, v67, v82
    v_mul_f32 v69, v69, v84
    v_mul_f32 v71, v71, v86
    v_cvt_pk_bf16_f32 v96, v64, -v65
    v_cvt_pk_bf16_f32 v97, v66, -v67
    v_cvt_pk_bf16_f32 v98, v68, -v69
    v_cvt_pk_bf16_f32 v99, v70, -v71
    v_pk_mul_f32 v[88:89], v[64:65], v[64:65] op_sel:[1,1] op_sel_hi:[0,1]
    v_pk_mul_f32 v[90:91], v[66:67], v[66:67] op_sel:[1,1] op_sel_hi:[0,1]
    v_pk_mul_f32 v[92:93], v[68:69], v[68:69] op_sel:[1,1] op_sel_hi:[0,1]
    v_pk_mul_f32 v[94:95], v[70:71], v[70:71] op_sel:[1,1] op_sel_hi:[0,1]
    v_pk_fma_f32 v[64:65], v[64:65], v[64:65], v[88:89] op_sel:[0,0,0] op_sel_hi:[0,1,1] neg_lo:[0,0,1]
    v_pk_fma_f32 v[66:67], v[66:67], v[66:67], v[90:91] op_sel:[0,0,0] op_sel_hi:[0,1,1] neg_lo:[0,0,1]
    v_pk_fma_f32 v[68:69], v[68:69], v[68:69], v[92:93] op_sel:[0,0,0] op_sel_hi:[0,1,1] neg_lo:[0,0,1]
    v_pk_fma_f32 v[70:71], v[70:71], v[70:71], v[94:95] op_sel:[0,0,0] op_sel_hi:[0,1,1] neg_lo:[0,0,1]
    v_cvt_pk_bf16_f32 v100, v64, -v65
    v_cvt_pk_bf16_f32 v101, v66, -v67
    v_cvt_pk_bf16_f32 v102, v68, -v69
    v_cvt_pk_bf16_f32 v103, v70, -v71
    v_pk_mul_f32 v[88:89], v[64:65], v[64:65] op_sel:[1,1] op_sel_hi:[0,1]
    v_pk_mul_f32 v[90:91], v[66:67], v[66:67] op_sel:[1,1] op_sel_hi:[0,1]
    v_pk_mul_f32 v[92:93], v[68:69], v[68:69] op_sel:[1,1] op_sel_hi:[0,1]
    v_pk_mul_f32 v[94:95], v[70:71], v[70:71] op_sel:[1,1] op_sel_hi:[0,1]
    v_pk_fma_f32 v[64:65], v[64:65], v[64:65], v[88:89] op_sel:[0,0,0] op_sel_hi:[0,1,1] neg_lo:[0,0,1]
    v_pk_fma_f32 v[66:67], v[66:67], v[66:67], v[90:91] op_sel:[0,0,0] op_sel_hi:[0,1,1] neg_lo:[0,0,1]
    v_pk_fma_f32 v[68:69], v[68:69], v[68:69], v[92:93] op_sel:[0,0,0] op_sel_hi:[0,1,1] neg_lo:[0,0,1]
    v_pk_fma_f32 v[70:71], v[70:71], v[70:71], v[94:95] op_sel:[0,0,0] op_sel_hi:[0,1,1] neg_lo:[0,0,1]
    v_cvt_pk_bf16_f32 v104, v64, -v65
    v_cvt_pk_bf16_f32 v105, v66, -v67
    v_cvt_pk_bf16_f32 v106, v68, -v69
    v_cvt_pk_bf16_f32 v107, v70, -v71
    v_pk_mul_f32 v[88:89], v[64:65], v[64:65] op_sel:[1,1] op_sel_hi:[0,1]
    v_pk_mul_f32 v[90:91], v[66:67], v[66:67] op_sel:[1,1] op_sel_hi:[0,1]
    v_pk_mul_f32 v[92:93], v[68:69], v[68:69] op_sel:[1,1] op_sel_hi:[0,1]
    v_pk_mul_f32 v[94:95], v[70:71], v[70:71] op_sel:[1,1] op_sel_hi:[0,1]
    v_pk_fma_f32 v[64:65], v[64:65], v[64:65], v[88:89] op_sel:[0,0,0] op_sel_hi:[0,1,1] neg_lo:[0,0,1]
    v_pk_fma_f32 v[66:67], v[66:67], v[66:67], v[90:91] op_sel:[0,0,0] op_sel_hi:[0,1,1] neg_lo:[0,0,1]
    v_pk_fma_f32 v[68:69], v[68:69], v[68:69], v[92:93] op_sel:[0,0,0] op_sel_hi:[0,1,1] neg_lo:[0,0,1]
    v_pk_fma_f32 v[70:71], v[70:71], v[70:71], v[94:95] op_sel:[0,0,0] op_sel_hi:[0,1,1] neg_lo:[0,0,1]
    v_cvt_pk_bf16_f32 v108, v64, -v65
    v_cvt_pk_bf16_f32 v109, v66, -v67
    v_cvt_pk_bf16_f32 v110, v68, -v69
    v_cvt_pk_bf16_f32 v111, v70, -v71
    v_pk_mul_f32 v[88:89], v[64:65], v[64:65] op_sel:[1,1] op_sel_hi:[0,1]
    v_pk_mul_f32 v[90:91], v[66:67], v[66:67] op_sel:[1,1] op_sel_hi:[0,1]
    v_pk_mul_f32 v[92:93], v[68:69], v[68:69] op_sel:[1,1] op_sel_hi:[0,1]
    v_pk_mul_f32 v[94:95], v[70:71], v[70:71] op_sel:[1,1] op_sel_hi:[0,1]
    v_pk_fma_f32 v[64:65], v[64:65], v[64:65], v[88:89] op_sel:[0,0,0] op_sel_hi:[0,1,1] neg_lo:[0,0,1]
    v_pk_fma_f32 v[66:67], v[66:67], v[66:67], v[90:91] op_sel:[0,0,0] op_sel_hi:[0,1,1] neg_lo:[0,0,1]
    v_pk_fma_f32 v[68:69], v[68:69], v[68:69], v[92:93] op_sel:[0,0,0] op_sel_hi:[0,1,1] neg_lo:[0,0,1]
    v_pk_fma_f32 v[70:71], v[70:71], v[70:71], v[94:95] op_sel:[0,0,0] op_sel_hi:[0,1,1] neg_lo:[0,0,1]
    v_pk_mul_f32 v[88:89], v[72:73], v[64:65] op_sel:[1,1] op_sel_hi:[1,0]
    v_pk_mul_f32 v[90:91], v[74:75], v[66:67] op_sel:[1,1] op_sel_hi:[1,0]
    v_pk_mul_f32 v[92:93], v[76:77], v[68:69] op_sel:[1,1] op_sel_hi:[1,0]
    v_pk_mul_f32 v[94:95], v[78:79], v[70:71] op_sel:[1,1] op_sel_hi:[1,0]
    v_pk_fma_f32 v[80:81], v[72:73], v[64:65], v[88:89] op_sel:[0,0,0] op_sel_hi:[0,1,1] neg_lo:[0,0,1]
    v_pk_fma_f32 v[82:83], v[74:75], v[66:67], v[90:91] op_sel:[0,0,0] op_sel_hi:[0,1,1] neg_lo:[0,0,1]
    v_pk_fma_f32 v[84:85], v[76:77], v[68:69], v[92:93] op_sel:[0,0,0] op_sel_hi:[0,1,1] neg_lo:[0,0,1]
    v_pk_fma_f32 v[86:87], v[78:79], v[70:71], v[94:95] op_sel:[0,0,0] op_sel_hi:[0,1,1] neg_lo:[0,0,1]
    v_cvt_pk_bf16_f32 v112, v80, v81
    v_cvt_pk_bf16_f32 v113, v82, v83
    v_cvt_pk_bf16_f32 v114, v84, v85
    v_cvt_pk_bf16_f32 v115, v86, v87
    v_pk_mul_f32 v[88:89], v[64:65], v[64:65] op_sel:[1,1] op_sel_hi:[0,1]
    v_pk_mul_f32 v[90:91], v[66:67], v[66:67] op_sel:[1,1] op_sel_hi:[0,1]
    v_pk_mul_f32 v[92:93], v[68:69], v[68:69] op_sel:[1,1] op_sel_hi:[0,1]
    v_pk_mul_f32 v[94:95], v[70:71], v[70:71] op_sel:[1,1] op_sel_hi:[0,1]
    v_pk_fma_f32 v[64:65], v[64:65], v[64:65], v[88:89] op_sel:[0,0,0] op_sel_hi:[0,1,1] neg_lo:[0,0,1]
    v_pk_fma_f32 v[66:67], v[66:67], v[66:67], v[90:91] op_sel:[0,0,0] op_sel_hi:[0,1,1] neg_lo:[0,0,1]
    v_pk_fma_f32 v[68:69], v[68:69], v[68:69], v[92:93] op_sel:[0,0,0] op_sel_hi:[0,1,1] neg_lo:[0,0,1]
    v_pk_fma_f32 v[70:71], v[70:71], v[70:71], v[94:95] op_sel:[0,0,0] op_sel_hi:[0,1,1] neg_lo:[0,0,1]
    v_mfma_f32_16x16x32_bf16 v[48:51], v[112:115], v[96:99], v[48:51]
    v_pk_mul_f32 v[88:89], v[72:73], v[64:65] op_sel:[1,1] op_sel_hi:[1,0]
    v_pk_mul_f32 v[90:91], v[74:75], v[66:67] op_sel:[1,1] op_sel_hi:[1,0]
    v_pk_mul_f32 v[92:93], v[76:77], v[68:69] op_sel:[1,1] op_sel_hi:[1,0]
    v_pk_mul_f32 v[94:95], v[78:79], v[70:71] op_sel:[1,1] op_sel_hi:[1,0]
    v_pk_fma_f32 v[80:81], v[72:73], v[64:65], v[88:89] op_sel:[0,0,0] op_sel_hi:[0,1,1] neg_lo:[0,0,1]
    v_pk_fma_f32 v[82:83], v[74:75], v[66:67], v[90:91] op_sel:[0,0,0] op_sel_hi:[0,1,1] neg_lo:[0,0,1]
    v_pk_fma_f32 v[84:85], v[76:77], v[68:69], v[92:93] op_sel:[0,0,0] op_sel_hi:[0,1,1] neg_lo:[0,0,1]
    v_pk_fma_f32 v[86:87], v[78:79], v[70:71], v[94:95] op_sel:[0,0,0] op_sel_hi:[0,1,1] neg_lo:[0,0,1]
    v_cvt_pk_bf16_f32 v116, v80, v81
    v_cvt_pk_bf16_f32 v117, v82, v83
    v_cvt_pk_bf16_f32 v118, v84, v85
    v_cvt_pk_bf16_f32 v119, v86, v87
    v_pk_mul_f32 v[88:89], v[64:65], v[64:65] op_sel:[1,1] op_sel_hi:[0,1]
    v_pk_mul_f32 v[90:91], v[66:67], v[66:67] op_sel:[1,1] op_sel_hi:[0,1]
    v_pk_mul_f32 v[92:93], v[68:69], v[68:69] op_sel:[1,1] op_sel_hi:[0,1]
    v_pk_mul_f32 v[94:95], v[70:71], v[70:71] op_sel:[1,1] op_sel_hi:[0,1]
    v_pk_fma_f32 v[64:65], v[64:65], v[64:65], v[88:89] op_sel:[0,0,0] op_sel_hi:[0,1,1] neg_lo:[0,0,1]
    v_pk_fma_f32 v[66:67], v[66:67], v[66:67], v[90:91] op_sel:[0,0,0] op_sel_hi:[0,1,1] neg_lo:[0,0,1]
    v_pk_fma_f32 v[68:69], v[68:69], v[68:69], v[92:93] op_sel:[0,0,0] op_sel_hi:[0,1,1] neg_lo:[0,0,1]
    v_pk_fma_f32 v[70:71], v[70:71], v[70:71], v[94:95] op_sel:[0,0,0] op_sel_hi:[0,1,1] neg_lo:[0,0,1]
    v_mfma_f32_16x16x32_bf16 v[52:55], v[116:119], v[100:103], v[52:55]
    v_pk_mul_f32 v[88:89], v[72:73], v[64:65] op_sel:[1,1] op_sel_hi:[1,0]
    v_pk_mul_f32 v[90:91], v[74:75], v[66:67] op_sel:[1,1] op_sel_hi:[1,0]
    v_pk_mul_f32 v[92:93], v[76:77], v[68:69] op_sel:[1,1] op_sel_hi:[1,0]
    v_pk_mul_f32 v[94:95], v[78:79], v[70:71] op_sel:[1,1] op_sel_hi:[1,0]
    v_pk_fma_f32 v[80:81], v[72:73], v[64:65], v[88:89] op_sel:[0,0,0] op_sel_hi:[0,1,1] neg_lo:[0,0,1]
    v_pk_fma_f32 v[82:83], v[74:75], v[66:67], v[90:91] op_sel:[0,0,0] op_sel_hi:[0,1,1] neg_lo:[0,0,1]
    v_pk_fma_f32 v[84:85], v[76:77], v[68:69], v[92:93] op_sel:[0,0,0] op_sel_hi:[0,1,1] neg_lo:[0,0,1]
    v_pk_fma_f32 v[86:87], v[78:79], v[70:71], v[94:95] op_sel:[0,0,0] op_sel_hi:[0,1,1] neg_lo:[0,0,1]
    v_cvt_pk_bf16_f32 v112, v80, v81
    v_cvt_pk_bf16_f32 v113, v82, v83
    v_cvt_pk_bf16_f32 v114, v84, v85
    v_cvt_pk_bf16_f32 v115, v86, v87
    v_pk_mul_f32 v[88:89], v[64:65], v[64:65] op_sel:[1,1] op_sel_hi:[0,1]
    v_pk_mul_f32 v[90:91], v[66:67], v[66:67] op_sel:[1,1] op_sel_hi:[0,1]
    v_pk_mul_f32 v[92:93], v[68:69], v[68:69] op_sel:[1,1] op_sel_hi:[0,1]
    v_pk_mul_f32 v[94:95], v[70:71], v[70:71] op_sel:[1,1] op_sel_hi:[0,1]
    v_pk_fma_f32 v[64:65], v[64:65], v[64:65], v[88:89] op_sel:[0,0,0] op_sel_hi:[0,1,1] neg_lo:[0,0,1]
    v_pk_fma_f32 v[66:67], v[66:67], v[66:67], v[90:91] op_sel:[0,0,0] op_sel_hi:[0,1,1] neg_lo:[0,0,1]
    v_pk_fma_f32 v[68:69], v[68:69], v[68:69], v[92:93] op_sel:[0,0,0] op_sel_hi:[0,1,1] neg_lo:[0,0,1]
    v_pk_fma_f32 v[70:71], v[70:71], v[70:71], v[94:95] op_sel:[0,0,0] op_sel_hi:[0,1,1] neg_lo:[0,0,1]
    v_mfma_f32_16x16x32_bf16 v[56:59], v[112:115], v[104:107], v[56:59]
    v_mov_b32_dpp v80, v64 row_newbcast:1 row_mask:0xf bank_mask:0xf
    v_mov_b32_dpp v81, v65 row_newbcast:1 row_mask:0xf bank_mask:0xf
    v_mov_b32_dpp v82, v66 row_newbcast:1 row_mask:0xf bank_mask:0xf
    v_mov_b32_dpp v83, v67 row_newbcast:1 row_mask:0xf bank_mask:0xf
    v_mov_b32_dpp v84, v68 row_newbcast:1 row_mask:0xf bank_mask:0xf
    v_mov_b32_dpp v85, v69 row_newbcast:1 row_mask:0xf bank_mask:0xf
    v_mov_b32_dpp v86, v70 row_newbcast:1 row_mask:0xf bank_mask:0xf
    v_mov_b32_dpp v87, v71 row_newbcast:1 row_mask:0xf bank_mask:0xf
    v_pk_mul_f32 v[88:89], v[72:73], v[80:81] op_sel:[1,1] op_sel_hi:[1,0]
    v_pk_mul_f32 v[90:91], v[74:75], v[82:83] op_sel:[1,1] op_sel_hi:[1,0]
    v_pk_mul_f32 v[92:93], v[76:77], v[84:85] op_sel:[1,1] op_sel_hi:[1,0]
    v_pk_mul_f32 v[94:95], v[78:79], v[86:87] op_sel:[1,1] op_sel_hi:[1,0]
    v_pk_fma_f32 v[72:73], v[72:73], v[80:81], v[88:89] op_sel:[0,0,0] op_sel_hi:[0,1,1] neg_lo:[0,0,1]
    v_pk_fma_f32 v[74:75], v[74:75], v[82:83], v[90:91] op_sel:[0,0,0] op_sel_hi:[0,1,1] neg_lo:[0,0,1]
    v_pk_fma_f32 v[76:77], v[76:77], v[84:85], v[92:93] op_sel:[0,0,0] op_sel_hi:[0,1,1] neg_lo:[0,0,1]
    v_pk_fma_f32 v[78:79], v[78:79], v[86:87], v[94:95] op_sel:[0,0,0] op_sel_hi:[0,1,1] neg_lo:[0,0,1]
    v_pk_mul_f32 v[88:89], v[72:73], v[64:65] op_sel:[1,1] op_sel_hi:[1,0]
    v_pk_mul_f32 v[90:91], v[74:75], v[66:67] op_sel:[1,1] op_sel_hi:[1,0]
    v_pk_mul_f32 v[92:93], v[76:77], v[68:69] op_sel:[1,1] op_sel_hi:[1,0]
    v_pk_mul_f32 v[94:95], v[78:79], v[70:71] op_sel:[1,1] op_sel_hi:[1,0]
    v_pk_fma_f32 v[80:81], v[72:73], v[64:65], v[88:89] op_sel:[0,0,0] op_sel_hi:[0,1,1] neg_lo:[0,0,1]
    v_pk_fma_f32 v[82:83], v[74:75], v[66:67], v[90:91] op_sel:[0,0,0] op_sel_hi:[0,1,1] neg_lo:[0,0,1]
    v_pk_fma_f32 v[84:85], v[76:77], v[68:69], v[92:93] op_sel:[0,0,0] op_sel_hi:[0,1,1] neg_lo:[0,0,1]
    v_pk_fma_f32 v[86:87], v[78:79], v[70:71], v[94:95] op_sel:[0,0,0] op_sel_hi:[0,1,1] neg_lo:[0,0,1]
    v_cvt_pk_bf16_f32 v116, v80, v81
    v_cvt_pk_bf16_f32 v117, v82, v83
    v_cvt_pk_bf16_f32 v118, v84, v85
    v_cvt_pk_bf16_f32 v119, v86, v87
    s_nop 1
    v_mfma_f32_16x16x32_bf16 v[60:63], v[116:119], v[108:111], v[60:63]
    v_mov_b32 v16, v24
    v_mov_b32 v17, v25
    v_mov_b32 v18, v26
    v_mov_b32 v19, v27
    v_mov_b32 v20, v28
    v_mov_b32 v21, v29
    v_mov_b32 v22, v30
    v_mov_b32 v23, v31
    s_add_u32 s52, s52, 1
    s_cmp_lt_u32 s52, 2
    s_cbranch_scc1 l0_kernel_kl_4
    s_nop 7
    v_lshlrev_b32 v1, 4, v15
    s_lshl_b32 s44, s36, 12
    s_add_u32 s44, s44, s39
    v_add_u32 v8, s44, v1
    ds_write_b128 v8, v[48:51] offset:0
    ds_write_b128 v8, v[52:55] offset:1024
    ds_write_b128 v8, v[56:59] offset:2048
    ds_write_b128 v8, v[60:63] offset:3072
    s_waitcnt lgkmcnt(0)
    s_barrier
    s_lshl_b32 s44, s36, 10
    s_add_u32 s44, s44, s39
    v_add_u32 v8, s44, v1
    ds_read_b128 v[96:99], v8 offset:0
    ds_read_b128 v[100:103], v8 offset:4096
    ds_read_b128 v[104:107], v8 offset:8192
    ds_read_b128 v[108:111], v8 offset:12288
    v_lshrrev_b32 v1, 4, v15
    v_lshlrev_b32 v1, 6, v1
    v_and_b32 v8, 15, v15
    v_add_u32 v1, v1, v8
    s_waitcnt lgkmcnt(0)

    v_pk_add_f32 v[96:97], v[96:97], v[100:101]
    v_pk_add_f32 v[98:99], v[98:99], v[102:103]
    v_pk_add_f32 v[96:97], v[96:97], v[104:105]
    v_pk_add_f32 v[98:99], v[98:99], v[106:107]
    v_pk_add_f32 v[96:97], v[96:97], v[108:109]
    v_pk_add_f32 v[98:99], v[98:99], v[110:111]
    v_cvt_pk_bf16_f32 v48, v96, v96
    v_cvt_pk_bf16_f32 v49, v97, v97
    v_cvt_pk_bf16_f32 v50, v98, v98
    v_cvt_pk_bf16_f32 v51, v99, v99
    v_cvt_pk_bf16_f32 v52, v96, v96
    v_cvt_pk_bf16_f32 v53, v97, v97
    v_cvt_pk_bf16_f32 v54, v98, v98
    v_cvt_pk_bf16_f32 v55, v99, v99
    v_cvt_pk_bf16_f32 v56, v96, v96
    v_cvt_pk_bf16_f32 v57, v97, v97
    v_cvt_pk_bf16_f32 v58, v98, v98
    v_cvt_pk_bf16_f32 v59, v99, v99
    v_cvt_pk_bf16_f32 v60, v96, v96
    v_cvt_pk_bf16_f32 v61, v97, v97
    v_cvt_pk_bf16_f32 v62, v98, v98
    v_cvt_pk_bf16_f32 v63, v99, v99
    s_cmp_eq_u32 s36, 1
    s_cbranch_scc1 l0_kernel_ks_7
    s_cmp_eq_u32 s36, 2
    s_cbranch_scc1 l0_kernel_ks_8
    s_cmp_eq_u32 s36, 3
    s_cbranch_scc1 l0_kernel_ks_9
l0_kernel_ks_6:
    v_lshlrev_b32 v8, 1, v1
    v_sub_u32 v8, 20736, v8
    v_add_u32 v8, s39, v8
    v_subrev_u32 v9, 1, v8
    s_mov_b32 exec_lo, 0xffffffff
    s_mov_b32 exec_hi, 0xffffffff
    ds_write_b16 v9, v48 offset:1
    s_mov_b64 exec, -1
    v_subrev_u32 v9, 33, v8
    s_mov_b32 exec_lo, 0xffffffff
    s_mov_b32 exec_hi, 0xffffffff
    ds_write_b16 v9, v49 offset:1
    s_mov_b64 exec, -1
    v_subrev_u32 v9, 65, v8
    s_mov_b32 exec_lo, 0xffffffff
    s_mov_b32 exec_hi, 0xffffffff
    ds_write_b16 v9, v50 offset:1
    s_mov_b64 exec, -1
    v_subrev_u32 v9, 97, v8
    s_mov_b32 exec_lo, 0xffffffff
    s_mov_b32 exec_hi, 0xffffffff
    ds_write_b16 v9, v51 offset:1
    s_mov_b64 exec, -1
    s_branch l0_kernel_kd_5
l0_kernel_ks_7:
    v_lshlrev_b32 v8, 2, v1
    v_sub_u32 v8, 20736, v8
    v_add_u32 v8, s39, v8
    v_subrev_u32 v9, 2, v8
    s_mov_b32 exec_lo, 0x0
    s_mov_b32 exec_hi, 0x55555555
    ds_write_b16 v9, v52 offset:0
    s_mov_b32 exec_lo, 0x0
    s_mov_b32 exec_hi, 0xffffffff
    ds_write_b16 v9, v52 offset:2
    s_mov_b32 exec_lo, 0x0
    s_mov_b32 exec_hi, 0x55555554
    ds_write_b16 v9, v52 offset:4
    s_mov_b64 exec, -1
    v_subrev_u32 v9, 66, v8
    s_mov_b32 exec_lo, 0x0
    s_mov_b32 exec_hi, 0x55555555
    ds_write_b16 v9, v53 offset:0
    s_mov_b32 exec_lo, 0x0
    s_mov_b32 exec_hi, 0xffffffff
    ds_write_b16 v9, v53 offset:2
    s_mov_b32 exec_lo, 0x0
    s_mov_b32 exec_hi, 0x55555555
    ds_write_b16 v9, v53 offset:4
    s_mov_b64 exec, -1
    v_subrev_u32 v9, 130, v8
    s_mov_b32 exec_lo, 0x0
    s_mov_b32 exec_hi, 0x55555555
    ds_write_b16 v9, v54 offset:0
    s_mov_b32 exec_lo, 0x0
    s_mov_b32 exec_hi, 0xffffffff
    ds_write_b16 v9, v54 offset:2
    s_mov_b32 exec_lo, 0x0
    s_mov_b32 exec_hi, 0x55555555
    ds_write_b16 v9, v54 offset:4
    s_mov_b64 exec, -1
    v_subrev_u32 v9, 194, v8
    s_mov_b32 exec_lo, 0x0
    s_mov_b32 exec_hi, 0x55555555
    ds_write_b16 v9, v55 offset:0
    s_mov_b32 exec_lo, 0x0
    s_mov_b32 exec_hi, 0xffffffff
    ds_write_b16 v9, v55 offset:2
    s_mov_b32 exec_lo, 0x0
    s_mov_b32 exec_hi, 0x55555555
    ds_write_b16 v9, v55 offset:4
    s_mov_b64 exec, -1
    s_branch l0_kernel_kd_5
l0_kernel_ks_8:
    v_lshlrev_b32 v8, 3, v1
    v_sub_u32 v8, 20736, v8
    v_add_u32 v8, s39, v8
    v_subrev_u32 v9, 4, v8
    s_mov_b32 exec_lo, 0x0
    s_mov_b32 exec_hi, 0x55555555
    ds_write_b16 v9, v56 offset:0
    s_mov_b32 exec_lo, 0x0
    s_mov_b32 exec_hi, 0xffffffff
    ds_write_b16 v9, v56 offset:2
    s_mov_b32 exec_lo, 0x0
    s_mov_b32 exec_hi, 0xffffffff
    ds_write_b16 v9, v56 offset:4
    s_mov_b32 exec_lo, 0x0
    s_mov_b32 exec_hi, 0xffffffff
    ds_write_b16 v9, v56 offset:6
    s_mov_b32 exec_lo, 0x0
    s_mov_b32 exec_hi, 0x55555554
    ds_write_b16 v9, v56 offset:8
    s_mov_b64 exec, -1
    v_subrev_u32 v9, 132, v8
    s_mov_b32 exec_lo, 0x0
    s_mov_b32 exec_hi, 0x55555555
    ds_write_b16 v9, v57 offset:0
    s_mov_b32 exec_lo, 0x0
    s_mov_b32 exec_hi, 0xffffffff
    ds_write_b16 v9, v57 offset:2
    s_mov_b32 exec_lo, 0x0
    s_mov_b32 exec_hi, 0xffffffff
    ds_write_b16 v9, v57 offset:4
    s_mov_b32 exec_lo, 0x0
    s_mov_b32 exec_hi, 0xffffffff
    ds_write_b16 v9, v57 offset:6
    s_mov_b32 exec_lo, 0x0
    s_mov_b32 exec_hi, 0x55555555
    ds_write_b16 v9, v57 offset:8
    s_mov_b64 exec, -1
    v_subrev_u32 v9, 260, v8
    s_mov_b32 exec_lo, 0x0
    s_mov_b32 exec_hi, 0x55555555
    ds_write_b16 v9, v58 offset:0
    s_mov_b32 exec_lo, 0x0
    s_mov_b32 exec_hi, 0xffffffff
    ds_write_b16 v9, v58 offset:2
    s_mov_b32 exec_lo, 0x0
    s_mov_b32 exec_hi, 0xffffffff
    ds_write_b16 v9, v58 offset:4
    s_mov_b32 exec_lo, 0x0
    s_mov_b32 exec_hi, 0xffffffff
    ds_write_b16 v9, v58 offset:6
    s_mov_b32 exec_lo, 0x0
    s_mov_b32 exec_hi, 0x55555555
    ds_write_b16 v9, v58 offset:8
    s_mov_b64 exec, -1
    v_subrev_u32 v9, 388, v8
    s_mov_b32 exec_lo, 0x0
    s_mov_b32 exec_hi, 0x55555555
    ds_write_b16 v9, v59 offset:0
    s_mov_b32 exec_lo, 0x0
    s_mov_b32 exec_hi, 0xffffffff
    ds_write_b16 v9, v59 offset:2
    s_mov_b32 exec_lo, 0x0
    s_mov_b32 exec_hi, 0xffffffff
    ds_write_b16 v9, v59 offset:4
    s_mov_b32 exec_lo, 0x0
    s_mov_b32 exec_hi, 0xffffffff
    ds_write_b16 v9, v59 offset:6
    s_mov_b32 exec_lo, 0x0
    s_mov_b32 exec_hi, 0x55555555
    ds_write_b16 v9, v59 offset:8
    s_mov_b64 exec, -1
    s_branch l0_kernel_kd_5
l0_kernel_ks_9:
    v_lshlrev_b32 v8, 4, v1
    v_sub_u32 v8, 20736, v8
    v_add_u32 v8, s39, v8
    v_subrev_u32 v9, 264, v8
    s_mov_b32 exec_lo, 0x0
    s_mov_b32 exec_hi, 0x55555555
    ds_write_b16 v9, v60 offset:0
    s_mov_b32 exec_lo, 0x0
    s_mov_b32 exec_hi, 0xffffffff
    ds_write_b16 v9, v60 offset:2
    s_mov_b32 exec_lo, 0x0
    s_mov_b32 exec_hi, 0xffffffff
    ds_write_b16 v9, v60 offset:4
    s_mov_b32 exec_lo, 0x0
    s_mov_b32 exec_hi, 0xffffffff
    ds_write_b16 v9, v60 offset:6
    s_mov_b32 exec_lo, 0x0
    s_mov_b32 exec_hi, 0xffffffff
    ds_write_b16 v9, v60 offset:8
    s_mov_b32 exec_lo, 0x0
    s_mov_b32 exec_hi, 0xffffffff
    ds_write_b16 v9, v60 offset:10
    s_mov_b32 exec_lo, 0x0
    s_mov_b32 exec_hi, 0xffffffff
    ds_write_b16 v9, v60 offset:12
    s_mov_b32 exec_lo, 0x0
    s_mov_b32 exec_hi, 0xffffffff
    ds_write_b16 v9, v60 offset:14
    s_mov_b32 exec_lo, 0x0
    s_mov_b32 exec_hi, 0x55555555
    ds_write_b16 v9, v60 offset:16
    s_mov_b64 exec, -1
    v_subrev_u32 v9, 520, v8
    s_mov_b32 exec_lo, 0x0
    s_mov_b32 exec_hi, 0x55555555
    ds_write_b16 v9, v61 offset:0
    s_mov_b32 exec_lo, 0x0
    s_mov_b32 exec_hi, 0xffffffff
    ds_write_b16 v9, v61 offset:2
    s_mov_b32 exec_lo, 0x0
    s_mov_b32 exec_hi, 0xffffffff
    ds_write_b16 v9, v61 offset:4
    s_mov_b32 exec_lo, 0x0
    s_mov_b32 exec_hi, 0xffffffff
    ds_write_b16 v9, v61 offset:6
    s_mov_b32 exec_lo, 0x0
    s_mov_b32 exec_hi, 0xffffffff
    ds_write_b16 v9, v61 offset:8
    s_mov_b32 exec_lo, 0x0
    s_mov_b32 exec_hi, 0xffffffff
    ds_write_b16 v9, v61 offset:10
    s_mov_b32 exec_lo, 0x0
    s_mov_b32 exec_hi, 0xffffffff
    ds_write_b16 v9, v61 offset:12
    s_mov_b32 exec_lo, 0x0
    s_mov_b32 exec_hi, 0xffffffff
    ds_write_b16 v9, v61 offset:14
    s_mov_b32 exec_lo, 0x0
    s_mov_b32 exec_hi, 0x55555555
    ds_write_b16 v9, v61 offset:16
    s_mov_b64 exec, -1
    v_subrev_u32 v9, 776, v8
    s_mov_b32 exec_lo, 0x0
    s_mov_b32 exec_hi, 0x55555555
    ds_write_b16 v9, v62 offset:0
    s_mov_b32 exec_lo, 0x0
    s_mov_b32 exec_hi, 0xffffffff
    ds_write_b16 v9, v62 offset:2
    s_mov_b32 exec_lo, 0x0
    s_mov_b32 exec_hi, 0xffffffff
    ds_write_b16 v9, v62 offset:4
    s_mov_b32 exec_lo, 0x0
    s_mov_b32 exec_hi, 0xffffffff
    ds_write_b16 v9, v62 offset:6
    s_mov_b32 exec_lo, 0x0
    s_mov_b32 exec_hi, 0xffffffff
    ds_write_b16 v9, v62 offset:8
    s_mov_b32 exec_lo, 0x0
    s_mov_b32 exec_hi, 0xffffffff
    ds_write_b16 v9, v62 offset:10
    s_mov_b32 exec_lo, 0x0
    s_mov_b32 exec_hi, 0xffffffff
    ds_write_b16 v9, v62 offset:12
    s_mov_b32 exec_lo, 0x0
    s_mov_b32 exec_hi, 0xffffffff
    ds_write_b16 v9, v62 offset:14
    s_mov_b32 exec_lo, 0x0
    s_mov_b32 exec_hi, 0x55555555
    ds_write_b16 v9, v62 offset:16
    s_mov_b64 exec, -1
    v_subrev_u32 v9, 1032, v8
    s_mov_b32 exec_lo, 0x55550000
    s_mov_b32 exec_hi, 0x55555555
    ds_write_b16 v9, v63 offset:0
    s_mov_b32 exec_lo, 0xffff0000
    s_mov_b32 exec_hi, 0xffffffff
    ds_write_b16 v9, v63 offset:2
    s_mov_b32 exec_lo, 0xffff0000
    s_mov_b32 exec_hi, 0xffffffff
    ds_write_b16 v9, v63 offset:4
    s_mov_b32 exec_lo, 0xffff0000
    s_mov_b32 exec_hi, 0xffffffff
    ds_write_b16 v9, v63 offset:6
    s_mov_b32 exec_lo, 0xffff0000
    s_mov_b32 exec_hi, 0xffffffff
    ds_write_b16 v9, v63 offset:8
    s_mov_b32 exec_lo, 0xffff0000
    s_mov_b32 exec_hi, 0xffffffff
    ds_write_b16 v9, v63 offset:10
    s_mov_b32 exec_lo, 0xffff0000
    s_mov_b32 exec_hi, 0xffffffff
    ds_write_b16 v9, v63 offset:12
    s_mov_b32 exec_lo, 0xfffe0000
    s_mov_b32 exec_hi, 0xffffffff
    ds_write_b16 v9, v63 offset:14
    s_mov_b32 exec_lo, 0x55540000
    s_mov_b32 exec_hi, 0x55555555
    ds_write_b16 v9, v63 offset:16
    s_mov_b64 exec, -1
l0_kernel_kd_5:
    s_waitcnt lgkmcnt(0)
    s_barrier
    s_add_u32 s24, s32, 39845888
    s_addc_u32 s25, s33, 0
    s_and_b32 s25, s25, 0xffff
    s_mov_b32 s26, 6193152
    s_mov_b32 s27, 0x00020000
    v_lshlrev_b32 v1, 4, v15
    s_lshl_b32 s44, s36, 10
    v_add_u32 v1, s44, v1
    v_add_u32 v2, s39, v1
    s_mul_i32 s45, s47, 10752

    ds_read_b128 v[16:19], v2 offset:16640
    ds_read_b32 v20, v2 offset:16656
    s_waitcnt lgkmcnt(0)
    s_add_u32 s46, s45, 0
    buffer_store_dwordx4 v[16:19], v1, s[24:27], s46 offen sc1
    s_cmp_eq_u32 s36, 0
    s_cbranch_scc0 l0_kernel_k5_10
    s_mov_b32 exec_lo, 0x1ffff
    s_mov_b32 exec_hi, 0
    ds_read_b128 v[40:43], v2 offset:20736
    ds_read_b32 v44, v2 offset:20752
    s_waitcnt lgkmcnt(0)
    s_add_u32 s46, s45, 4096
    buffer_store_dwordx4 v[40:43], v1, s[24:27], s46 offen sc1
    s_mov_b64 exec, -1
l0_kernel_k5_10:
    s_endpgm
l0_kernel_r2:
    s_cmp_ge_u32 s2, 776
    s_cbranch_scc1 l0_kernel_r3
    s_sub_u32 s47, s2, 704
    s_mov_b32 s30, s92
    s_mov_b32 s31, s93
    s_mov_b32 s4, s30
    s_and_b32 s5, s31, 0xffff
    s_mov_b32 s6, 2654208
    s_mov_b32 s7, 0x00020000
    s_add_u32 s8, s32, 69206016
    s_addc_u32 s9, s33, 0
    s_and_b32 s9, s9, 0xffff
    s_mov_b32 s10, 2654208
    s_mov_b32 s11, 0x00020000
    s_mov_b32 s48, s47
    s_mul_i32 s44, s48, 36864
    s_mul_i32 s45, s36, 9216
    s_add_u32 s44, s44, s45
    s_mul_i32 s46, s36, 9216
    v_add_u32 v1, 0, v15
    v_mul_u32_u24 v2, 911, v1
    v_lshrrev_b32 v2, 16, v2
    v_mul_u32_u24 v3, 72, v2
    v_sub_u32 v3, v1, v3
    v_mul_u32_u24 v2, 1152, v2
    v_lshl_add_u32 v16, v3, 4, v2

    v_add_u32 v1, 64, v15
    v_mul_u32_u24 v2, 911, v1
    v_lshrrev_b32 v2, 16, v2
    v_mul_u32_u24 v3, 72, v2
    v_sub_u32 v3, v1, v3
    v_mul_u32_u24 v2, 1152, v2
    v_lshl_add_u32 v17, v3, 4, v2

    v_add_u32 v1, 128, v15
    v_mul_u32_u24 v2, 911, v1
    v_lshrrev_b32 v2, 16, v2
    v_mul_u32_u24 v3, 72, v2
    v_sub_u32 v3, v1, v3
    v_mul_u32_u24 v2, 1152, v2
    v_lshl_add_u32 v18, v3, 4, v2

    v_add_u32 v1, 192, v15
    v_mul_u32_u24 v2, 911, v1
    v_lshrrev_b32 v2, 16, v2
    v_mul_u32_u24 v3, 72, v2
    v_sub_u32 v3, v1, v3
    v_mul_u32_u24 v2, 1152, v2
    v_lshl_add_u32 v19, v3, 4, v2

    v_add_u32 v1, 256, v15
    v_mul_u32_u24 v2, 911, v1
    v_lshrrev_b32 v2, 16, v2
    v_mul_u32_u24 v3, 72, v2
    v_sub_u32 v3, v1, v3
    v_mul_u32_u24 v2, 1152, v2
    v_lshl_add_u32 v20, v3, 4, v2

    v_add_u32 v1, 320, v15
    v_mul_u32_u24 v2, 911, v1
    v_lshrrev_b32 v2, 16, v2
    v_mul_u32_u24 v3, 72, v2
    v_sub_u32 v3, v1, v3
    v_mul_u32_u24 v2, 1152, v2
    v_lshl_add_u32 v21, v3, 4, v2

    v_add_u32 v1, 384, v15
    v_mul_u32_u24 v2, 911, v1
    v_lshrrev_b32 v2, 16, v2
    v_mul_u32_u24 v3, 72, v2
    v_sub_u32 v3, v1, v3
    v_mul_u32_u24 v2, 1152, v2
    v_lshl_add_u32 v22, v3, 4, v2

    v_add_u32 v1, 448, v15
    v_mul_u32_u24 v2, 911, v1
    v_lshrrev_b32 v2, 16, v2
    v_mul_u32_u24 v3, 72, v2
    v_sub_u32 v3, v1, v3
    v_mul_u32_u24 v2, 1152, v2
    v_lshl_add_u32 v23, v3, 4, v2

    v_add_u32 v1, 512, v15
    v_mul_u32_u24 v2, 911, v1
    v_lshrrev_b32 v2, 16, v2
    v_mul_u32_u24 v3, 72, v2
    v_sub_u32 v3, v1, v3
    v_mul_u32_u24 v2, 1152, v2
    v_lshl_add_u32 v24, v3, 4, v2

    s_add_u32 m0, s46, 0
    s_nop 0
    buffer_load_dwordx4 v16, s[4:7], s44 offen lds
    s_add_u32 m0, s46, 1024
    s_nop 0
    buffer_load_dwordx4 v17, s[4:7], s44 offen lds
    s_add_u32 m0, s46, 2048
    s_nop 0
    buffer_load_dwordx4 v18, s[4:7], s44 offen lds
    s_add_u32 m0, s46, 3072
    s_nop 0
    buffer_load_dwordx4 v19, s[4:7], s44 offen lds
    s_add_u32 m0, s46, 4096
    s_nop 0
    buffer_load_dwordx4 v20, s[4:7], s44 offen lds
    s_add_u32 m0, s46, 5120
    s_nop 0
    buffer_load_dwordx4 v21, s[4:7], s44 offen lds
    s_add_u32 m0, s46, 6144
    s_nop 0
    buffer_load_dwordx4 v22, s[4:7], s44 offen lds
    s_add_u32 m0, s46, 7168
    s_nop 0
    buffer_load_dwordx4 v23, s[4:7], s44 offen lds
    s_add_u32 m0, s46, 8192
    s_nop 0
    buffer_load_dwordx4 v24, s[4:7], s44 offen lds
    v_lshlrev_b32 v3, 4, v15
    s_waitcnt vmcnt(0)
    s_barrier
    s_mul_i32 s50, s48, 57
    s_lshr_b32 s50, s50, 9
    s_mul_i32 s50, s50, 9
    s_sub_u32 s50, s48, s50
    s_cmp_eq_u32 s50, 4
    s_cbranch_scc1 l0_kernel_nat_11
    v_lshrrev_b32 v1, 2, v15
    v_mul_u32_u24 v1, 1152, v1
    v_and_b32 v2, 3, v15
    v_lshlrev_b32 v2, 3, v2
    v_add_u32 v1, v1, v2
    s_mul_i32 s45, s36, 288
    v_add_u32 v1, s45, v1

    ds_read_b64_tr_b16 v[32:33], v1 offset:0
    ds_read_b64_tr_b16 v[34:35], v1 offset:18432
    ds_read_b64_tr_b16 v[36:37], v1 offset:32
    ds_read_b64_tr_b16 v[38:39], v1 offset:18464
    ds_read_b64_tr_b16 v[40:41], v1 offset:64
    ds_read_b64_tr_b16 v[42:43], v1 offset:18496
    ds_read_b64_tr_b16 v[44:45], v1 offset:96
    ds_read_b64_tr_b16 v[46:47], v1 offset:18528
    ds_read_b64_tr_b16 v[48:49], v1 offset:128
    ds_read_b64_tr_b16 v[50:51], v1 offset:18560
    ds_read_b64_tr_b16 v[52:53], v1 offset:160
    ds_read_b64_tr_b16 v[54:55], v1 offset:18592
    ds_read_b64_tr_b16 v[56:57], v1 offset:192
    ds_read_b64_tr_b16 v[58:59], v1 offset:18624
    ds_read_b64_tr_b16 v[60:61], v1 offset:224
    ds_read_b64_tr_b16 v[62:63], v1 offset:18656
    ds_read_b64_tr_b16 v[64:65], v1 offset:256
    ds_read_b64_tr_b16 v[66:67], v1 offset:18688
    s_branch l0_kernel_nd_12
l0_kernel_nat_11:
    v_lshrrev_b32 v1, 4, v15
    v_lshlrev_b32 v1, 3, v1
    v_bfe_u32 v2, v15, 2, 2
    v_add_u32 v1, v1, v2
    v_mul_u32_u24 v1, 1152, v1
    v_and_b32 v2, 3, v15
    v_lshlrev_b32 v2, 3, v2
    v_add_u32 v1, v1, v2
    s_mul_i32 s45, s36, 288
    v_add_u32 v1, s45, v1

    ds_read_b64_tr_b16 v[32:33], v1 offset:0
    ds_read_b64_tr_b16 v[34:35], v1 offset:4608
    ds_read_b64_tr_b16 v[36:37], v1 offset:32
    ds_read_b64_tr_b16 v[38:39], v1 offset:4640
    ds_read_b64_tr_b16 v[40:41], v1 offset:64
    ds_read_b64_tr_b16 v[42:43], v1 offset:4672
    ds_read_b64_tr_b16 v[44:45], v1 offset:96
    ds_read_b64_tr_b16 v[46:47], v1 offset:4704
    ds_read_b64_tr_b16 v[48:49], v1 offset:128
    ds_read_b64_tr_b16 v[50:51], v1 offset:4736
    ds_read_b64_tr_b16 v[52:53], v1 offset:160
    ds_read_b64_tr_b16 v[54:55], v1 offset:4768
    ds_read_b64_tr_b16 v[56:57], v1 offset:192
    ds_read_b64_tr_b16 v[58:59], v1 offset:4800
    ds_read_b64_tr_b16 v[60:61], v1 offset:224
    ds_read_b64_tr_b16 v[62:63], v1 offset:4832
    ds_read_b64_tr_b16 v[64:65], v1 offset:256
    ds_read_b64_tr_b16 v[66:67], v1 offset:4864
l0_kernel_nd_12:
    s_waitcnt lgkmcnt(0)
    s_mul_i32 s45, s36, 9
    s_add_u32 s45, s45, 0
    s_mul_i32 s50, s45, 43
    s_lshr_b32 s50, s50, 8
    s_mul_i32 s51, s50, 6
    s_sub_u32 s45, s45, s51
    s_mul_i32 s50, s50, 72
    s_add_u32 s50, s50, s48
    s_mul_i32 s50, s50, 6
    s_add_u32 s45, s45, s50
    s_lshl_b32 s45, s45, 10
    buffer_store_dwordx4 v[32:35], v3, s[8:11], s45 offen sc1
    s_mul_i32 s45, s36, 9
    s_add_u32 s45, s45, 1
    s_mul_i32 s50, s45, 43
    s_lshr_b32 s50, s50, 8
    s_mul_i32 s51, s50, 6
    s_sub_u32 s45, s45, s51
    s_mul_i32 s50, s50, 72
    s_add_u32 s50, s50, s48
    s_mul_i32 s50, s50, 6
    s_add_u32 s45, s45, s50
    s_lshl_b32 s45, s45, 10
    buffer_store_dwordx4 v[36:39], v3, s[8:11], s45 offen sc1
    s_mul_i32 s45, s36, 9
    s_add_u32 s45, s45, 2
    s_mul_i32 s50, s45, 43
    s_lshr_b32 s50, s50, 8
    s_mul_i32 s51, s50, 6
    s_sub_u32 s45, s45, s51
    s_mul_i32 s50, s50, 72
    s_add_u32 s50, s50, s48
    s_mul_i32 s50, s50, 6
    s_add_u32 s45, s45, s50
    s_lshl_b32 s45, s45, 10
    buffer_store_dwordx4 v[40:43], v3, s[8:11], s45 offen sc1
    s_mul_i32 s45, s36, 9
    s_add_u32 s45, s45, 3
    s_mul_i32 s50, s45, 43
    s_lshr_b32 s50, s50, 8
    s_mul_i32 s51, s50, 6
    s_sub_u32 s45, s45, s51
    s_mul_i32 s50, s50, 72
    s_add_u32 s50, s50, s48
    s_mul_i32 s50, s50, 6
    s_add_u32 s45, s45, s50
    s_lshl_b32 s45, s45, 10
    buffer_store_dwordx4 v[44:47], v3, s[8:11], s45 offen sc1
    s_mul_i32 s45, s36, 9
    s_add_u32 s45, s45, 4
    s_mul_i32 s50, s45, 43
    s_lshr_b32 s50, s50, 8
    s_mul_i32 s51, s50, 6
    s_sub_u32 s45, s45, s51
    s_mul_i32 s50, s50, 72
    s_add_u32 s50, s50, s48
    s_mul_i32 s50, s50, 6
    s_add_u32 s45, s45, s50
    s_lshl_b32 s45, s45, 10
    buffer_store_dwordx4 v[48:51], v3, s[8:11], s45 offen sc1
    s_mul_i32 s45, s36, 9
    s_add_u32 s45, s45, 5
    s_mul_i32 s50, s45, 43
    s_lshr_b32 s50, s50, 8
    s_mul_i32 s51, s50, 6
    s_sub_u32 s45, s45, s51
    s_mul_i32 s50, s50, 72
    s_add_u32 s50, s50, s48
    s_mul_i32 s50, s50, 6
    s_add_u32 s45, s45, s50
    s_lshl_b32 s45, s45, 10
    buffer_store_dwordx4 v[52:55], v3, s[8:11], s45 offen sc1
    s_mul_i32 s45, s36, 9
    s_add_u32 s45, s45, 6
    s_mul_i32 s50, s45, 43
    s_lshr_b32 s50, s50, 8
    s_mul_i32 s51, s50, 6
    s_sub_u32 s45, s45, s51
    s_mul_i32 s50, s50, 72
    s_add_u32 s50, s50, s48
    s_mul_i32 s50, s50, 6
    s_add_u32 s45, s45, s50
    s_lshl_b32 s45, s45, 10
    buffer_store_dwordx4 v[56:59], v3, s[8:11], s45 offen sc1
    s_mul_i32 s45, s36, 9
    s_add_u32 s45, s45, 7
    s_mul_i32 s50, s45, 43
    s_lshr_b32 s50, s50, 8
    s_mul_i32 s51, s50, 6
    s_sub_u32 s45, s45, s51
    s_mul_i32 s50, s50, 72
    s_add_u32 s50, s50, s48
    s_mul_i32 s50, s50, 6
    s_add_u32 s45, s45, s50
    s_lshl_b32 s45, s45, 10
    buffer_store_dwordx4 v[60:63], v3, s[8:11], s45 offen sc1
    s_mul_i32 s45, s36, 9
    s_add_u32 s45, s45, 8
    s_mul_i32 s50, s45, 43
    s_lshr_b32 s50, s50, 8
    s_mul_i32 s51, s50, 6
    s_sub_u32 s45, s45, s51
    s_mul_i32 s50, s50, 72
    s_add_u32 s50, s50, s48
    s_mul_i32 s50, s50, 6
    s_add_u32 s45, s45, s50
    s_lshl_b32 s45, s45, 10
    buffer_store_dwordx4 v[64:67], v3, s[8:11], s45 offen sc1
    s_endpgm
l0_kernel_r3:
    s_cmp_ge_u32 s2, 840
    s_cbranch_scc0 l0_kernel_r3b
    s_mov_b32 s4, s90
    s_and_b32 s5, s91, 0xffff
    s_mov_b32 s6, 8388608
    s_mov_b32 s7, 0x00020000
    s_sub_u32 s44, s2, 840
    s_lshl_b32 s44, s44, 2
    s_add_u32 s44, s44, s36
    s_lshl_b32 s44, s44, 14
    v_lshlrev_b32 v1, 4, v15
    s_add_u32 s46, s44, 0
    buffer_load_dwordx4 v[16:19], v1, s[4:7], s46 offen
    s_add_u32 s46, s44, 1024
    buffer_load_dwordx4 v[16:19], v1, s[4:7], s46 offen
    s_add_u32 s46, s44, 2048
    buffer_load_dwordx4 v[16:19], v1, s[4:7], s46 offen
    s_add_u32 s46, s44, 3072
    buffer_load_dwordx4 v[16:19], v1, s[4:7], s46 offen
    s_add_u32 s46, s44, 4096
    buffer_load_dwordx4 v[16:19], v1, s[4:7], s46 offen
    s_add_u32 s46, s44, 5120
    buffer_load_dwordx4 v[16:19], v1, s[4:7], s46 offen
    s_add_u32 s46, s44, 6144
    buffer_load_dwordx4 v[16:19], v1, s[4:7], s46 offen
    s_add_u32 s46, s44, 7168
    buffer_load_dwordx4 v[16:19], v1, s[4:7], s46 offen
    s_add_u32 s46, s44, 8192
    buffer_load_dwordx4 v[16:19], v1, s[4:7], s46 offen
    s_add_u32 s46, s44, 9216
    buffer_load_dwordx4 v[16:19], v1, s[4:7], s46 offen
    s_add_u32 s46, s44, 10240
    buffer_load_dwordx4 v[16:19], v1, s[4:7], s46 offen
    s_add_u32 s46, s44, 11264
    buffer_load_dwordx4 v[16:19], v1, s[4:7], s46 offen
    s_add_u32 s46, s44, 12288
    buffer_load_dwordx4 v[16:19], v1, s[4:7], s46 offen
    s_add_u32 s46, s44, 13312
    buffer_load_dwordx4 v[16:19], v1, s[4:7], s46 offen
    s_add_u32 s46, s44, 14336
    buffer_load_dwordx4 v[16:19], v1, s[4:7], s46 offen
    s_add_u32 s46, s44, 15360
    buffer_load_dwordx4 v[16:19], v1, s[4:7], s46 offen
    s_waitcnt vmcnt(0)
    s_endpgm
l0_kernel_r3b:
    s_mov_b32 s4, s88
    s_and_b32 s5, s89, 0xffff
    s_mov_b32 s6, 5308416
    s_mov_b32 s7, 0x00020000
    s_sub_u32 s44, s2, 776
    s_lshl_b32 s44, s44, 2
    s_add_u32 s44, s44, s36
    s_mul_i32 s44, s44, 20736
    v_lshlrev_b32 v1, 4, v15
    s_add_u32 s46, s44, 0
    buffer_load_dwordx4 v[16:19], v1, s[4:7], s46 offen
    s_add_u32 s46, s44, 1024
    buffer_load_dwordx4 v[16:19], v1, s[4:7], s46 offen
    s_add_u32 s46, s44, 2048
    buffer_load_dwordx4 v[16:19], v1, s[4:7], s46 offen
    s_add_u32 s46, s44, 3072
    buffer_load_dwordx4 v[16:19], v1, s[4:7], s46 offen
    s_add_u32 s46, s44, 4096
    buffer_load_dwordx4 v[16:19], v1, s[4:7], s46 offen
    s_add_u32 s46, s44, 5120
    buffer_load_dwordx4 v[16:19], v1, s[4:7], s46 offen
    s_add_u32 s46, s44, 6144
    buffer_load_dwordx4 v[16:19], v1, s[4:7], s46 offen
    s_add_u32 s46, s44, 7168
    buffer_load_dwordx4 v[16:19], v1, s[4:7], s46 offen
    s_add_u32 s46, s44, 8192
    buffer_load_dwordx4 v[16:19], v1, s[4:7], s46 offen
    s_add_u32 s46, s44, 9216
    buffer_load_dwordx4 v[16:19], v1, s[4:7], s46 offen
    s_add_u32 s46, s44, 10240
    buffer_load_dwordx4 v[16:19], v1, s[4:7], s46 offen
    s_add_u32 s46, s44, 11264
    buffer_load_dwordx4 v[16:19], v1, s[4:7], s46 offen
    s_add_u32 s46, s44, 12288
    buffer_load_dwordx4 v[16:19], v1, s[4:7], s46 offen
    s_add_u32 s46, s44, 13312
    buffer_load_dwordx4 v[16:19], v1, s[4:7], s46 offen
    s_add_u32 s46, s44, 14336
    buffer_load_dwordx4 v[16:19], v1, s[4:7], s46 offen
    s_add_u32 s46, s44, 15360
    buffer_load_dwordx4 v[16:19], v1, s[4:7], s46 offen
    s_add_u32 s46, s44, 16384
    buffer_load_dwordx4 v[16:19], v1, s[4:7], s46 offen
    s_add_u32 s46, s44, 17408
    buffer_load_dwordx4 v[16:19], v1, s[4:7], s46 offen
    s_add_u32 s46, s44, 18432
    buffer_load_dwordx4 v[16:19], v1, s[4:7], s46 offen
    s_add_u32 s46, s44, 19456
    buffer_load_dwordx4 v[16:19], v1, s[4:7], s46 offen
    s_add_u32 s46, s44, 20480
    buffer_load_dwordx4 v[16:19], v1, s[4:7], s46 offen
    s_waitcnt vmcnt(0)
l0_kernel_end:
    s_endpgm
.globl m_kernel
.p2align 8
.type m_kernel,@function
m_kernel:
    s_cmp_ge_u32 s2, 256
    s_cbranch_scc1 m_kernel_end
    s_load_dwordx2 s[76:77], s[0:1], 0
    s_load_dwordx2 s[88:89], s[0:1], 48
    s_load_dwordx2 s[78:79], s[0:1], 64
    s_load_dwordx4 s[80:83], s[0:1], 72
    s_load_dwordx4 s[84:87], s[0:1], 96
    s_load_dwordx2 s[32:33], s[0:1], 112
    s_and_b32 s44, s2, 7
    s_lshr_b32 s45, s2, 3
    s_and_b32 s34, s44, 1
    s_lshl_b32 s34, s34, 3
    s_and_b32 s46, s45, 7
    s_add_u32 s34, s34, s46
    s_lshr_b32 s35, s44, 1
    s_lshl_b32 s35, s35, 2
    s_lshr_b32 s46, s45, 3
    s_add_u32 s35, s35, s46
    v_lshrrev_b32 v1, 6, v0
    v_and_b32 v15, 63, v0
    s_nop 0
    v_readfirstlane_b32 s36, v1

    s_lshl_b32 s70, s2, 1
    s_add_u32 s71, s70, 1
    s_mov_b32 s72, s2
    s_lshl_b32 s44, s36, 6
    s_add_u32 s44, s44, 0
    v_add_u32 v16, s44, v15
    v_mul_u32_u24 v17, 1821, v16
    v_lshrrev_b32 v17, 16, v17
    v_mul_u32_u24 v18, 36, v17
    v_sub_u32 v18, v16, v18
    v_lshrrev_b32 v19, 1, v18
    v_bfe_u32 v20, v17, 3, 1
    v_xor_b32 v19, v19, v20
    v_cmp_le_u32 vcc, 9, v19
    s_nop 1
    v_cndmask_b32 v20, 0, 1, vcc
    v_mul_u32_u24 v21, 9, v20
    v_sub_u32 v19, v19, v21
    v_lshlrev_b32 v20, 5, v20
    v_add_u32 v17, v17, v20
    v_mul_u32_u24 v17, 9216, v17
    v_lshlrev_b32 v19, 5, v19
    v_and_b32 v18, 1, v18
    v_lshlrev_b32 v18, 4, v18
    v_add3_u32 v2, v17, v19, v18

    s_lshl_b32 s44, s36, 6
    s_add_u32 s44, s44, 256
    v_add_u32 v16, s44, v15
    v_mul_u32_u24 v17, 1821, v16
    v_lshrrev_b32 v17, 16, v17
    v_mul_u32_u24 v18, 36, v17
    v_sub_u32 v18, v16, v18
    v_lshrrev_b32 v19, 1, v18
    v_bfe_u32 v20, v17, 3, 1
    v_xor_b32 v19, v19, v20
    v_cmp_le_u32 vcc, 9, v19
    s_nop 1
    v_cndmask_b32 v20, 0, 1, vcc
    v_mul_u32_u24 v21, 9, v20
    v_sub_u32 v19, v19, v21
    v_lshlrev_b32 v20, 5, v20
    v_add_u32 v17, v17, v20
    v_mul_u32_u24 v17, 9216, v17
    v_lshlrev_b32 v19, 5, v19
    v_and_b32 v18, 1, v18
    v_lshlrev_b32 v18, 4, v18
    v_add3_u32 v3, v17, v19, v18

    s_lshl_b32 s44, s36, 6
    s_add_u32 s44, s44, 512
    v_add_u32 v16, s44, v15
    v_mul_u32_u24 v17, 1821, v16
    v_lshrrev_b32 v17, 16, v17
    v_mul_u32_u24 v18, 36, v17
    v_sub_u32 v18, v16, v18
    v_lshrrev_b32 v19, 1, v18
    v_bfe_u32 v20, v17, 3, 1
    v_xor_b32 v19, v19, v20
    v_cmp_le_u32 vcc, 9, v19
    s_nop 1
    v_cndmask_b32 v20, 0, 1, vcc
    v_mul_u32_u24 v21, 9, v20
    v_sub_u32 v19, v19, v21
    v_lshlrev_b32 v20, 5, v20
    v_add_u32 v17, v17, v20
    v_mul_u32_u24 v17, 9216, v17
    v_lshlrev_b32 v19, 5, v19
    v_and_b32 v18, 1, v18
    v_lshlrev_b32 v18, 4, v18
    v_add3_u32 v4, v17, v19, v18

    s_lshl_b32 s44, s36, 6
    s_add_u32 s44, s44, 768
    v_add_u32 v16, s44, v15
    v_mul_u32_u24 v17, 1821, v16
    v_lshrrev_b32 v17, 16, v17
    v_mul_u32_u24 v18, 36, v17
    v_sub_u32 v18, v16, v18
    v_lshrrev_b32 v19, 1, v18
    v_bfe_u32 v20, v17, 3, 1
    v_xor_b32 v19, v19, v20
    v_cmp_le_u32 vcc, 9, v19
    s_nop 1
    v_cndmask_b32 v20, 0, 1, vcc
    v_mul_u32_u24 v21, 9, v20
    v_sub_u32 v19, v19, v21
    v_lshlrev_b32 v20, 5, v20
    v_add_u32 v17, v17, v20
    v_mul_u32_u24 v17, 9216, v17
    v_lshlrev_b32 v19, 5, v19
    v_and_b32 v18, 1, v18
    v_lshlrev_b32 v18, 4, v18
    v_add3_u32 v5, v17, v19, v18

    s_lshl_b32 s44, s36, 6
    s_add_u32 s44, s44, 1024
    v_add_u32 v16, s44, v15
    v_mul_u32_u24 v17, 1821, v16
    v_lshrrev_b32 v17, 16, v17
    v_mul_u32_u24 v18, 36, v17
    v_sub_u32 v18, v16, v18
    v_lshrrev_b32 v19, 1, v18
    v_bfe_u32 v20, v17, 3, 1
    v_xor_b32 v19, v19, v20
    v_cmp_le_u32 vcc, 9, v19
    s_nop 1
    v_cndmask_b32 v20, 0, 1, vcc
    v_mul_u32_u24 v21, 9, v20
    v_sub_u32 v19, v19, v21
    v_lshlrev_b32 v20, 5, v20
    v_add_u32 v17, v17, v20
    v_mul_u32_u24 v17, 9216, v17
    v_lshlrev_b32 v19, 5, v19
    v_and_b32 v18, 1, v18
    v_lshlrev_b32 v18, 4, v18
    v_add3_u32 v6, v17, v19, v18

    v_mov_b32 v17, 0x80000000
    v_cmp_gt_u32 vcc, 1152, v16
    s_nop 1
    v_cndmask_b32 v6, v17, v6, vcc
    v_lshrrev_b32 v16, 4, v15
    v_bfe_u32 v17, v15, 2, 2
    v_lshlrev_b32 v18, 3, v16
    v_add_u32 v18, v18, v17
    v_mul_u32_u24 v18, 576, v18
    v_and_b32 v19, 3, v15
    v_lshlrev_b32 v19, 3, v19
    v_add_u32 v18, v18, v19
    v_and_b32 v16, 1, v16
    v_lshlrev_b32 v16, 5, v16
    v_add_u32 v7, v18, v16
    v_sub_u32 v8, v18, v16
    v_lshlrev_b32 v1, 4, v15
    s_lshl_b32 s44, s34, 3
    s_lshl_b32 s45, s36, 1
    s_add_u32 s44, s44, s45
    s_mul_i32 s44, s44, 18432
    v_add_u32 v11, s44, v1
    v_add_u32 v12, 18432, v11
    s_waitcnt lgkmcnt(0)

    s_mov_b32 s28, s78
    s_mov_b32 s29, s79
    s_mov_b32 s54, s80
    s_mov_b32 s55, s81
    s_mov_b32 s4, s78
    s_and_b32 s5, s79, 0xffff
    s_mov_b32 s6, 5308416
    s_mov_b32 s7, 0x00020000
    s_add_u32 s8, s32, 0
    s_addc_u32 s9, s33, 0
    s_and_b32 s9, s9, 0xffff
    s_mov_b32 s10, 2359296
    s_mov_b32 s11, 0x00020000
    s_lshl_b32 s44, s34, 4
    s_add_u32 s44, s44, s35
    s_mul_i32 s44, s44, 36864
    s_add_u32 s44, s44, 8388608
    s_add_u32 s12, s32, s44
    s_addc_u32 s13, s33, 0
    s_and_b32 s13, s13, 0xffff
    s_mov_b32 s14, 36864
    s_mov_b32 s15, 0x00020000
    s_add_u32 s16, s32, 18874368
    s_addc_u32 s17, s33, 0
    s_and_b32 s17, s17, 0xffff
    s_mov_b32 s18, 9437184
    s_mov_b32 s19, 0x00020000
    s_add_u32 s20, s32, 48234496
    s_addc_u32 s21, s33, 0
    s_and_b32 s21, s21, 0xffff
    s_mov_b32 s22, 524288
    s_mov_b32 s23, 0x00020000
    s_mul_i32 s38, s35, 288
    s_add_u32 s37, s38, 4608
    s_lshl_b32 s39, s36, 10
    s_mov_b32 s64, 0
    s_mov_b32 s65, 4096
    s_mov_b32 s66, 8192
    s_mov_b32 s67, 12288
    s_mov_b32 s68, 16384
    s_add_u32 s56, s54, 0
    s_addc_u32 s57, s55, 0
    s_and_b32 s57, s57, 0xffff
    s_mov_b32 s58, 8388608
    s_mov_b32 s59, 0x00020000
    s_add_u32 s60, s32, 54525952
    s_addc_u32 s61, s33, 0
    s_and_b32 s61, s61, 0xffff
    s_mov_b32 s62, 8388608
    s_mov_b32 s63, 0x00020000
    s_lshr_b32 s44, s2, 1
    s_lshl_b32 s45, s44, 4
    v_lshrrev_b32 v16, 2, v15
    v_add_u32 v16, s45, v16
    v_lshlrev_b32 v16, 12, v16
    v_and_b32 v17, 3, v15
    v_lshlrev_b32 v17, 4, v17
    v_add_u32 v13, v16, v17
    s_and_b32 s45, s2, 1
    s_lshl_b32 s45, s45, 2
    s_add_u32 s45, s45, s36
    s_lshl_b32 s46, s45, 9
    v_add_u32 v13, s46, v13
    s_lshl_b32 s44, s44, 16
    s_lshl_b32 s45, s45, 13
    s_add_u32 s41, s44, s45
    s_add_u32 s42, s41, 4096
    v_lshlrev_b32 v14, 4, v15
    s_lshl_b32 s43, s36, 13
    s_add_u32 s43, s43, 102400
    v_and_b32 v16, 15, v15
    v_lshlrev_b32 v16, 2, v16
    v_lshrrev_b32 v17, 4, v15
    v_add_u32 v16, v16, v17
    v_lshlrev_b32 v16, 4, v16
    v_add_u32 v253, s43, v16

    s_add_u32 s40, s37, 0
    s_add_u32 m0, s39, 0
    s_nop 0
    buffer_load_dwordx4 v2, s[4:7], s40 offen lds
    s_add_u32 s40, s37, 0
    s_add_u32 m0, s39, 4096
    s_nop 0
    buffer_load_dwordx4 v3, s[4:7], s40 offen lds
    s_add_u32 s40, s37, 0
    s_add_u32 m0, s39, 8192
    s_nop 0
    buffer_load_dwordx4 v4, s[4:7], s40 offen lds
    s_add_u32 s40, s37, 0
    s_add_u32 m0, s39, 12288
    s_nop 0
    buffer_load_dwordx4 v5, s[4:7], s40 offen lds
    s_add_u32 s40, s37, 0
    s_add_u32 m0, s39, 16384
    s_nop 0
    buffer_load_dwordx4 v6, s[4:7], s40 offen lds
    buffer_load_dwordx4 a[0:3], v11, s[8:11], s64 offen offset:0
    buffer_load_dwordx4 a[4:7], v12, s[8:11], s64 offen offset:0
    buffer_load_dwordx4 a[8:11], v11, s[8:11], s64 offen offset:1024
    buffer_load_dwordx4 a[12:15], v12, s[8:11], s64 offen offset:1024
    s_barrier
    s_add_u32 s40, s37, 589824
    s_add_u32 m0, s39, 20480
    s_nop 0
    buffer_load_dwordx4 v2, s[4:7], s40 offen lds
    s_add_u32 s40, s37, 589824
    s_add_u32 m0, s39, 24576
    s_nop 0
    buffer_load_dwordx4 v3, s[4:7], s40 offen lds
    s_add_u32 s40, s37, 589824
    s_add_u32 m0, s39, 28672
    s_nop 0
    buffer_load_dwordx4 v4, s[4:7], s40 offen lds
    s_add_u32 s40, s37, 589824
    s_add_u32 m0, s39, 32768
    s_nop 0
    buffer_load_dwordx4 v5, s[4:7], s40 offen lds
    s_add_u32 s40, s37, 589824
    s_add_u32 m0, s39, 36864
    s_nop 0
    buffer_load_dwordx4 v6, s[4:7], s40 offen lds
    buffer_load_dwordx4 a[16:19], v11, s[8:11], s64 offen offset:2048
    buffer_load_dwordx4 a[20:23], v12, s[8:11], s64 offen offset:2048
    buffer_load_dwordx4 a[24:27], v11, s[8:11], s64 offen offset:3072
    buffer_load_dwordx4 a[28:31], v12, s[8:11], s64 offen offset:3072
    s_add_u32 s40, s37, 1179648
    s_add_u32 m0, s39, 40960
    s_nop 0
    buffer_load_dwordx4 v2, s[4:7], s40 offen lds
    s_add_u32 s40, s37, 1179648
    s_add_u32 m0, s39, 45056
    s_nop 0
    buffer_load_dwordx4 v3, s[4:7], s40 offen lds
    s_add_u32 s40, s37, 1179648
    s_add_u32 m0, s39, 49152
    s_nop 0
    buffer_load_dwordx4 v4, s[4:7], s40 offen lds
    s_add_u32 s40, s37, 1179648
    s_add_u32 m0, s39, 53248
    s_nop 0
    buffer_load_dwordx4 v5, s[4:7], s40 offen lds
    s_add_u32 s40, s37, 1179648
    s_add_u32 m0, s39, 57344
    s_nop 0
    buffer_load_dwordx4 v6, s[4:7], s40 offen lds
    buffer_load_dwordx4 a[32:35], v11, s[8:11], s65 offen offset:0
    buffer_load_dwordx4 a[36:39], v12, s[8:11], s65 offen offset:0
    buffer_load_dwordx4 a[40:43], v11, s[8:11], s65 offen offset:1024
    buffer_load_dwordx4 a[44:47], v12, s[8:11], s65 offen offset:1024
    v_mov_b32 v200, 0xc0135761
    v_mov_b32 v201, 0xc0135761
    v_mov_b32 v202, 0xbdd2d3e8
    v_mov_b32 v203, 0xbdd2d3e8
    v_mov_b32 v204, 1.0
    v_mov_b32 v205, 1.0
    v_mov_b32 v9, v7
    v_mov_b32 v10, v8
    s_waitcnt vmcnt(18)
    s_barrier
    ds_read_b64_tr_b16 a[144:145], v9 offset:0
    ds_read_b64_tr_b16 a[146:147], v9 offset:2304
    ds_read_b64_tr_b16 a[148:149], v10 offset:32
    ds_read_b64_tr_b16 a[150:151], v10 offset:2336
    ds_read_b64_tr_b16 a[152:153], v9 offset:64
    ds_read_b64_tr_b16 a[154:155], v9 offset:2368
    ds_read_b64_tr_b16 a[156:157], v10 offset:96
    ds_read_b64_tr_b16 a[158:159], v10 offset:2400
    ds_read_b64_tr_b16 a[160:161], v9 offset:128
    ds_read_b64_tr_b16 a[162:163], v9 offset:2432
    ds_read_b64_tr_b16 a[164:165], v10 offset:160
    ds_read_b64_tr_b16 a[166:167], v10 offset:2464
    ds_read_b64_tr_b16 a[168:169], v9 offset:192
    ds_read_b64_tr_b16 a[170:171], v9 offset:2496
    ds_read_b64_tr_b16 a[172:173], v10 offset:224
    ds_read_b64_tr_b16 a[174:175], v10 offset:2528
    ds_read_b64_tr_b16 a[176:177], v9 offset:256
    ds_read_b64_tr_b16 a[178:179], v9 offset:2560
    s_waitcnt lgkmcnt(0)
    v_mfma_f32_16x16x32_bf16 v[128:131], a[0:3], a[144:147], 0
    ds_read_b64_tr_b16 a[180:181], v10 offset:288
    v_mfma_f32_16x16x32_bf16 v[164:167], a[4:7], a[144:147], 0
    ds_read_b64_tr_b16 a[182:183], v10 offset:2592
    s_add_u32 s40, s37, 1769472
    s_add_u32 m0, s39, 61440
    s_nop 0
    buffer_load_dwordx4 v2, s[4:7], s40 offen lds
    v_mfma_f32_16x16x32_bf16 v[132:135], a[0:3], a[148:151], 0
    ds_read_b64_tr_b16 a[184:185], v9 offset:320
    v_mfma_f32_16x16x32_bf16 v[168:171], a[4:7], a[148:151], 0
    ds_read_b64_tr_b16 a[186:187], v9 offset:2624
    v_mfma_f32_16x16x32_bf16 v[136:139], a[0:3], a[152:155], 0
    ds_read_b64_tr_b16 a[188:189], v10 offset:352
    v_mfma_f32_16x16x32_bf16 v[172:175], a[4:7], a[152:155], 0
    ds_read_b64_tr_b16 a[190:191], v10 offset:2656
    s_add_u32 s40, s37, 1769472
    s_add_u32 m0, s39, 65536
    s_nop 0
    buffer_load_dwordx4 v3, s[4:7], s40 offen lds
    v_mfma_f32_16x16x32_bf16 v[140:143], a[0:3], a[156:159], 0
    ds_read_b64_tr_b16 a[192:193], v9 offset:384
    v_mfma_f32_16x16x32_bf16 v[176:179], a[4:7], a[156:159], 0
    ds_read_b64_tr_b16 a[194:195], v9 offset:2688
    v_mfma_f32_16x16x32_bf16 v[144:147], a[0:3], a[160:163], 0
    ds_read_b64_tr_b16 a[196:197], v10 offset:416
    v_mfma_f32_16x16x32_bf16 v[180:183], a[4:7], a[160:163], 0
    ds_read_b64_tr_b16 a[198:199], v10 offset:2720
    s_add_u32 s40, s37, 1769472
    s_add_u32 m0, s39, 69632
    s_nop 0
    buffer_load_dwordx4 v4, s[4:7], s40 offen lds
    v_mfma_f32_16x16x32_bf16 v[148:151], a[0:3], a[164:167], 0
    ds_read_b64_tr_b16 a[200:201], v9 offset:448
    v_mfma_f32_16x16x32_bf16 v[184:187], a[4:7], a[164:167], 0
    ds_read_b64_tr_b16 a[202:203], v9 offset:2752
    v_mfma_f32_16x16x32_bf16 v[152:155], a[0:3], a[168:171], 0
    ds_read_b64_tr_b16 a[204:205], v10 offset:480
    s_add_u32 s40, s37, 1769472
    s_add_u32 m0, s39, 73728
    s_nop 0
    buffer_load_dwordx4 v5, s[4:7], s40 offen lds
    v_mfma_f32_16x16x32_bf16 v[188:191], a[4:7], a[168:171], 0
    ds_read_b64_tr_b16 a[206:207], v10 offset:2784
    v_mfma_f32_16x16x32_bf16 v[156:159], a[0:3], a[172:175], 0
    ds_read_b64_tr_b16 a[208:209], v9 offset:512
    v_mfma_f32_16x16x32_bf16 v[192:195], a[4:7], a[172:175], 0
    ds_read_b64_tr_b16 a[210:211], v9 offset:2816
    v_mfma_f32_16x16x32_bf16 v[160:163], a[0:3], a[176:179], 0
    ds_read_b64_tr_b16 a[212:213], v10 offset:544
    s_add_u32 s40, s37, 1769472
    s_add_u32 m0, s39, 77824
    s_nop 0
    buffer_load_dwordx4 v6, s[4:7], s40 offen lds
    v_mfma_f32_16x16x32_bf16 v[196:199], a[4:7], a[176:179], 0
    ds_read_b64_tr_b16 a[214:215], v10 offset:2848
    s_waitcnt vmcnt(14)
    s_barrier
    v_add_u32 v9, 20480, v7
    v_add_u32 v10, 20480, v8
    s_waitcnt lgkmcnt(14)
    v_mfma_f32_16x16x32_bf16 v[128:131], a[8:11], a[180:183], v[128:131]
    ds_read_b64_tr_b16 a[144:145], v9 offset:0
    v_mfma_f32_16x16x32_bf16 v[164:167], a[12:15], a[180:183], v[164:167]
    ds_read_b64_tr_b16 a[146:147], v9 offset:2304
    v_mfma_f32_16x16x32_bf16 v[132:135], a[8:11], a[184:187], v[132:135]
    ds_read_b64_tr_b16 a[148:149], v10 offset:32
    buffer_load_dwordx4 a[48:51], v11, s[8:11], s65 offen offset:2048
    v_mfma_f32_16x16x32_bf16 v[168:171], a[12:15], a[184:187], v[168:171]
    ds_read_b64_tr_b16 a[150:151], v10 offset:2336
    s_waitcnt lgkmcnt(14)
    v_mfma_f32_16x16x32_bf16 v[136:139], a[8:11], a[188:191], v[136:139]
    ds_read_b64_tr_b16 a[152:153], v9 offset:64
    v_mfma_f32_16x16x32_bf16 v[172:175], a[12:15], a[188:191], v[172:175]
    ds_read_b64_tr_b16 a[154:155], v9 offset:2368
    v_mfma_f32_16x16x32_bf16 v[140:143], a[8:11], a[192:195], v[140:143]
    ds_read_b64_tr_b16 a[156:157], v10 offset:96
    buffer_load_dwordx4 a[52:55], v12, s[8:11], s65 offen offset:2048
    v_mfma_f32_16x16x32_bf16 v[176:179], a[12:15], a[192:195], v[176:179]
    ds_read_b64_tr_b16 a[158:159], v10 offset:2400
    s_waitcnt lgkmcnt(14)
    v_mfma_f32_16x16x32_bf16 v[144:147], a[8:11], a[196:199], v[144:147]
    ds_read_b64_tr_b16 a[160:161], v9 offset:128
    v_mfma_f32_16x16x32_bf16 v[180:183], a[12:15], a[196:199], v[180:183]
    ds_read_b64_tr_b16 a[162:163], v9 offset:2432
    v_mfma_f32_16x16x32_bf16 v[148:151], a[8:11], a[200:203], v[148:151]
    ds_read_b64_tr_b16 a[164:165], v10 offset:160
    v_mfma_f32_16x16x32_bf16 v[184:187], a[12:15], a[200:203], v[184:187]
    ds_read_b64_tr_b16 a[166:167], v10 offset:2464
    buffer_load_dwordx4 a[56:59], v11, s[8:11], s65 offen offset:3072
    s_waitcnt lgkmcnt(14)
    v_mfma_f32_16x16x32_bf16 v[152:155], a[8:11], a[204:207], v[152:155]
    ds_read_b64_tr_b16 a[168:169], v9 offset:192
    v_mfma_f32_16x16x32_bf16 v[188:191], a[12:15], a[204:207], v[188:191]
    ds_read_b64_tr_b16 a[170:171], v9 offset:2496
    v_mfma_f32_16x16x32_bf16 v[156:159], a[8:11], a[208:211], v[156:159]
    ds_read_b64_tr_b16 a[172:173], v10 offset:224
    v_mfma_f32_16x16x32_bf16 v[192:195], a[12:15], a[208:211], v[192:195]
    ds_read_b64_tr_b16 a[174:175], v10 offset:2528
    buffer_load_dwordx4 a[60:63], v12, s[8:11], s65 offen offset:3072
    s_waitcnt lgkmcnt(15)
    v_mfma_f32_16x16x32_bf16 v[160:163], a[8:11], a[212:215], v[160:163]
    ds_read_b64_tr_b16 a[176:177], v9 offset:256
    v_mfma_f32_16x16x32_bf16 v[196:199], a[12:15], a[212:215], v[196:199]
    ds_read_b64_tr_b16 a[178:179], v9 offset:2560
    s_waitcnt lgkmcnt(14)
    v_mfma_f32_16x16x32_bf16 v[128:131], a[16:19], a[144:147], v[128:131]
    ds_read_b64_tr_b16 a[180:181], v10 offset:288
    v_mfma_f32_16x16x32_bf16 v[164:167], a[20:23], a[144:147], v[164:167]
    ds_read_b64_tr_b16 a[182:183], v10 offset:2592
    s_add_u32 s40, s37, 2359296
    s_add_u32 m0, s39, 81920
    s_nop 0
    buffer_load_dwordx4 v2, s[4:7], s40 offen lds
    v_mfma_f32_16x16x32_bf16 v[132:135], a[16:19], a[148:151], v[132:135]
    ds_read_b64_tr_b16 a[184:185], v9 offset:320
    v_mfma_f32_16x16x32_bf16 v[168:171], a[20:23], a[148:151], v[168:171]
    ds_read_b64_tr_b16 a[186:187], v9 offset:2624
    s_waitcnt lgkmcnt(14)
    v_mfma_f32_16x16x32_bf16 v[136:139], a[16:19], a[152:155], v[136:139]
    ds_read_b64_tr_b16 a[188:189], v10 offset:352
    v_mfma_f32_16x16x32_bf16 v[172:175], a[20:23], a[152:155], v[172:175]
    ds_read_b64_tr_b16 a[190:191], v10 offset:2656
    s_add_u32 s40, s37, 2359296
    s_add_u32 m0, s39, 86016
    s_nop 0
    buffer_load_dwordx4 v3, s[4:7], s40 offen lds
    v_mfma_f32_16x16x32_bf16 v[140:143], a[16:19], a[156:159], v[140:143]
    ds_read_b64_tr_b16 a[192:193], v9 offset:384
    v_mfma_f32_16x16x32_bf16 v[176:179], a[20:23], a[156:159], v[176:179]
    ds_read_b64_tr_b16 a[194:195], v9 offset:2688
    s_waitcnt lgkmcnt(14)
    v_mfma_f32_16x16x32_bf16 v[144:147], a[16:19], a[160:163], v[144:147]
    ds_read_b64_tr_b16 a[196:197], v10 offset:416
    v_mfma_f32_16x16x32_bf16 v[180:183], a[20:23], a[160:163], v[180:183]
    ds_read_b64_tr_b16 a[198:199], v10 offset:2720
    s_add_u32 s40, s37, 2359296
    s_add_u32 m0, s39, 90112
    s_nop 0
    buffer_load_dwordx4 v4, s[4:7], s40 offen lds
    v_mfma_f32_16x16x32_bf16 v[148:151], a[16:19], a[164:167], v[148:151]
    ds_read_b64_tr_b16 a[200:201], v9 offset:448
    v_mfma_f32_16x16x32_bf16 v[184:187], a[20:23], a[164:167], v[184:187]
    ds_read_b64_tr_b16 a[202:203], v9 offset:2752
    s_waitcnt lgkmcnt(14)
    v_mfma_f32_16x16x32_bf16 v[152:155], a[16:19], a[168:171], v[152:155]
    ds_read_b64_tr_b16 a[204:205], v10 offset:480
    s_add_u32 s40, s37, 2359296
    s_add_u32 m0, s39, 94208
    s_nop 0
    buffer_load_dwordx4 v5, s[4:7], s40 offen lds
    v_mfma_f32_16x16x32_bf16 v[188:191], a[20:23], a[168:171], v[188:191]
    ds_read_b64_tr_b16 a[206:207], v10 offset:2784
    v_mfma_f32_16x16x32_bf16 v[156:159], a[16:19], a[172:175], v[156:159]
    ds_read_b64_tr_b16 a[208:209], v9 offset:512
    v_mfma_f32_16x16x32_bf16 v[192:195], a[20:23], a[172:175], v[192:195]
    ds_read_b64_tr_b16 a[210:211], v9 offset:2816
    s_waitcnt lgkmcnt(15)
    v_mfma_f32_16x16x32_bf16 v[160:163], a[16:19], a[176:179], v[160:163]
    ds_read_b64_tr_b16 a[212:213], v10 offset:544
    s_add_u32 s40, s37, 2359296
    s_add_u32 m0, s39, 98304
    s_nop 0
    buffer_load_dwordx4 v6, s[4:7], s40 offen lds
    v_mfma_f32_16x16x32_bf16 v[196:199], a[20:23], a[176:179], v[196:199]
    ds_read_b64_tr_b16 a[214:215], v10 offset:2848
    s_waitcnt vmcnt(14)
    s_barrier
    v_add_u32 v9, 40960, v7
    v_add_u32 v10, 40960, v8
    s_waitcnt lgkmcnt(14)
    v_mfma_f32_16x16x32_bf16 v[128:131], a[24:27], a[180:183], v[128:131]
    ds_read_b64_tr_b16 a[144:145], v9 offset:0
    v_mfma_f32_16x16x32_bf16 v[164:167], a[28:31], a[180:183], v[164:167]
    ds_read_b64_tr_b16 a[146:147], v9 offset:2304
    v_mfma_f32_16x16x32_bf16 v[132:135], a[24:27], a[184:187], v[132:135]
    ds_read_b64_tr_b16 a[148:149], v10 offset:32
    buffer_load_dwordx4 a[64:67], v11, s[8:11], s66 offen offset:0
    v_mfma_f32_16x16x32_bf16 v[168:171], a[28:31], a[184:187], v[168:171]
    ds_read_b64_tr_b16 a[150:151], v10 offset:2336
    s_waitcnt lgkmcnt(14)
    v_mfma_f32_16x16x32_bf16 v[136:139], a[24:27], a[188:191], v[136:139]
    ds_read_b64_tr_b16 a[152:153], v9 offset:64
    v_mfma_f32_16x16x32_bf16 v[172:175], a[28:31], a[188:191], v[172:175]
    ds_read_b64_tr_b16 a[154:155], v9 offset:2368
    v_mfma_f32_16x16x32_bf16 v[140:143], a[24:27], a[192:195], v[140:143]
    ds_read_b64_tr_b16 a[156:157], v10 offset:96
    buffer_load_dwordx4 a[68:71], v12, s[8:11], s66 offen offset:0
    v_mfma_f32_16x16x32_bf16 v[176:179], a[28:31], a[192:195], v[176:179]
    ds_read_b64_tr_b16 a[158:159], v10 offset:2400
    s_waitcnt lgkmcnt(14)
    v_mfma_f32_16x16x32_bf16 v[144:147], a[24:27], a[196:199], v[144:147]
    ds_read_b64_tr_b16 a[160:161], v9 offset:128
    v_mfma_f32_16x16x32_bf16 v[180:183], a[28:31], a[196:199], v[180:183]
    ds_read_b64_tr_b16 a[162:163], v9 offset:2432
    v_mfma_f32_16x16x32_bf16 v[148:151], a[24:27], a[200:203], v[148:151]
    ds_read_b64_tr_b16 a[164:165], v10 offset:160
    v_mfma_f32_16x16x32_bf16 v[184:187], a[28:31], a[200:203], v[184:187]
    ds_read_b64_tr_b16 a[166:167], v10 offset:2464
    buffer_load_dwordx4 a[72:75], v11, s[8:11], s66 offen offset:1024
    s_waitcnt lgkmcnt(14)
    v_mfma_f32_16x16x32_bf16 v[152:155], a[24:27], a[204:207], v[152:155]
    ds_read_b64_tr_b16 a[168:169], v9 offset:192
    v_mfma_f32_16x16x32_bf16 v[188:191], a[28:31], a[204:207], v[188:191]
    ds_read_b64_tr_b16 a[170:171], v9 offset:2496
    v_mfma_f32_16x16x32_bf16 v[156:159], a[24:27], a[208:211], v[156:159]
    ds_read_b64_tr_b16 a[172:173], v10 offset:224
    v_mfma_f32_16x16x32_bf16 v[192:195], a[28:31], a[208:211], v[192:195]
    ds_read_b64_tr_b16 a[174:175], v10 offset:2528
    buffer_load_dwordx4 a[76:79], v12, s[8:11], s66 offen offset:1024
    s_waitcnt lgkmcnt(15)
    v_mfma_f32_16x16x32_bf16 v[160:163], a[24:27], a[212:215], v[160:163]
    ds_read_b64_tr_b16 a[176:177], v9 offset:256
    v_mfma_f32_16x16x32_bf16 v[196:199], a[28:31], a[212:215], v[196:199]
    ds_read_b64_tr_b16 a[178:179], v9 offset:2560
    s_waitcnt lgkmcnt(14)
    v_mfma_f32_16x16x32_bf16 v[128:131], a[32:35], a[144:147], v[128:131]
    ds_read_b64_tr_b16 a[180:181], v10 offset:288
    v_mfma_f32_16x16x32_bf16 v[164:167], a[36:39], a[144:147], v[164:167]
    ds_read_b64_tr_b16 a[182:183], v10 offset:2592
    s_add_u32 s40, s37, 2949120
    s_add_u32 m0, s39, 0
    s_nop 0
    buffer_load_dwordx4 v2, s[4:7], s40 offen lds
    v_mfma_f32_16x16x32_bf16 v[132:135], a[32:35], a[148:151], v[132:135]
    ds_read_b64_tr_b16 a[184:185], v9 offset:320
    v_mfma_f32_16x16x32_bf16 v[168:171], a[36:39], a[148:151], v[168:171]
    ds_read_b64_tr_b16 a[186:187], v9 offset:2624
    s_waitcnt lgkmcnt(14)
    v_mfma_f32_16x16x32_bf16 v[136:139], a[32:35], a[152:155], v[136:139]
    ds_read_b64_tr_b16 a[188:189], v10 offset:352
    v_mfma_f32_16x16x32_bf16 v[172:175], a[36:39], a[152:155], v[172:175]
    ds_read_b64_tr_b16 a[190:191], v10 offset:2656
    s_add_u32 s40, s37, 2949120
    s_add_u32 m0, s39, 4096
    s_nop 0
    buffer_load_dwordx4 v3, s[4:7], s40 offen lds
    v_mfma_f32_16x16x32_bf16 v[140:143], a[32:35], a[156:159], v[140:143]
    ds_read_b64_tr_b16 a[192:193], v9 offset:384
    v_mfma_f32_16x16x32_bf16 v[176:179], a[36:39], a[156:159], v[176:179]
    ds_read_b64_tr_b16 a[194:195], v9 offset:2688
    s_waitcnt lgkmcnt(14)
    v_mfma_f32_16x16x32_bf16 v[144:147], a[32:35], a[160:163], v[144:147]
    ds_read_b64_tr_b16 a[196:197], v10 offset:416
    v_mfma_f32_16x16x32_bf16 v[180:183], a[36:39], a[160:163], v[180:183]
    ds_read_b64_tr_b16 a[198:199], v10 offset:2720
    s_add_u32 s40, s37, 2949120
    s_add_u32 m0, s39, 8192
    s_nop 0
    buffer_load_dwordx4 v4, s[4:7], s40 offen lds
    v_mfma_f32_16x16x32_bf16 v[148:151], a[32:35], a[164:167], v[148:151]
    ds_read_b64_tr_b16 a[200:201], v9 offset:448
    v_mfma_f32_16x16x32_bf16 v[184:187], a[36:39], a[164:167], v[184:187]
    ds_read_b64_tr_b16 a[202:203], v9 offset:2752
    s_waitcnt lgkmcnt(14)
    v_mfma_f32_16x16x32_bf16 v[152:155], a[32:35], a[168:171], v[152:155]
    ds_read_b64_tr_b16 a[204:205], v10 offset:480
    s_add_u32 s40, s37, 2949120
    s_add_u32 m0, s39, 12288
    s_nop 0
    buffer_load_dwordx4 v5, s[4:7], s40 offen lds
    v_mfma_f32_16x16x32_bf16 v[188:191], a[36:39], a[168:171], v[188:191]
    ds_read_b64_tr_b16 a[206:207], v10 offset:2784
    v_mfma_f32_16x16x32_bf16 v[156:159], a[32:35], a[172:175], v[156:159]
    ds_read_b64_tr_b16 a[208:209], v9 offset:512
    v_mfma_f32_16x16x32_bf16 v[192:195], a[36:39], a[172:175], v[192:195]
    ds_read_b64_tr_b16 a[210:211], v9 offset:2816
    s_waitcnt lgkmcnt(15)
    v_mfma_f32_16x16x32_bf16 v[160:163], a[32:35], a[176:179], v[160:163]
    ds_read_b64_tr_b16 a[212:213], v10 offset:544
    s_add_u32 s40, s37, 2949120
    s_add_u32 m0, s39, 16384
    s_nop 0
    buffer_load_dwordx4 v6, s[4:7], s40 offen lds
    v_mfma_f32_16x16x32_bf16 v[196:199], a[36:39], a[176:179], v[196:199]
    ds_read_b64_tr_b16 a[214:215], v10 offset:2848
    s_waitcnt vmcnt(14)
    s_barrier
    v_add_u32 v9, 61440, v7
    v_add_u32 v10, 61440, v8
    s_waitcnt lgkmcnt(14)
    v_mfma_f32_16x16x32_bf16 v[128:131], a[40:43], a[180:183], v[128:131]
    ds_read_b64_tr_b16 a[144:145], v9 offset:0
    v_mfma_f32_16x16x32_bf16 v[164:167], a[44:47], a[180:183], v[164:167]
    ds_read_b64_tr_b16 a[146:147], v9 offset:2304
    v_mfma_f32_16x16x32_bf16 v[132:135], a[40:43], a[184:187], v[132:135]
    ds_read_b64_tr_b16 a[148:149], v10 offset:32
    buffer_load_dwordx4 a[80:83], v11, s[8:11], s66 offen offset:2048
    v_mfma_f32_16x16x32_bf16 v[168:171], a[44:47], a[184:187], v[168:171]
    ds_read_b64_tr_b16 a[150:151], v10 offset:2336
    s_waitcnt lgkmcnt(14)
    v_mfma_f32_16x16x32_bf16 v[136:139], a[40:43], a[188:191], v[136:139]
    ds_read_b64_tr_b16 a[152:153], v9 offset:64
    v_mfma_f32_16x16x32_bf16 v[172:175], a[44:47], a[188:191], v[172:175]
    ds_read_b64_tr_b16 a[154:155], v9 offset:2368
    v_mfma_f32_16x16x32_bf16 v[140:143], a[40:43], a[192:195], v[140:143]
    ds_read_b64_tr_b16 a[156:157], v10 offset:96
    buffer_load_dwordx4 a[84:87], v12, s[8:11], s66 offen offset:2048
    v_mfma_f32_16x16x32_bf16 v[176:179], a[44:47], a[192:195], v[176:179]
    ds_read_b64_tr_b16 a[158:159], v10 offset:2400
    s_waitcnt lgkmcnt(14)
    v_mfma_f32_16x16x32_bf16 v[144:147], a[40:43], a[196:199], v[144:147]
    ds_read_b64_tr_b16 a[160:161], v9 offset:128
    v_mfma_f32_16x16x32_bf16 v[180:183], a[44:47], a[196:199], v[180:183]
    ds_read_b64_tr_b16 a[162:163], v9 offset:2432
    v_mfma_f32_16x16x32_bf16 v[148:151], a[40:43], a[200:203], v[148:151]
    ds_read_b64_tr_b16 a[164:165], v10 offset:160
    v_mfma_f32_16x16x32_bf16 v[184:187], a[44:47], a[200:203], v[184:187]
    ds_read_b64_tr_b16 a[166:167], v10 offset:2464
    buffer_load_dwordx4 a[88:91], v11, s[8:11], s66 offen offset:3072
    s_waitcnt lgkmcnt(14)
    v_mfma_f32_16x16x32_bf16 v[152:155], a[40:43], a[204:207], v[152:155]
    ds_read_b64_tr_b16 a[168:169], v9 offset:192
    v_mfma_f32_16x16x32_bf16 v[188:191], a[44:47], a[204:207], v[188:191]
    ds_read_b64_tr_b16 a[170:171], v9 offset:2496
    v_mfma_f32_16x16x32_bf16 v[156:159], a[40:43], a[208:211], v[156:159]
    ds_read_b64_tr_b16 a[172:173], v10 offset:224
    v_mfma_f32_16x16x32_bf16 v[192:195], a[44:47], a[208:211], v[192:195]
    ds_read_b64_tr_b16 a[174:175], v10 offset:2528
    buffer_load_dwordx4 a[92:95], v12, s[8:11], s66 offen offset:3072
    s_waitcnt lgkmcnt(15)
    v_mfma_f32_16x16x32_bf16 v[160:163], a[40:43], a[212:215], v[160:163]
    ds_read_b64_tr_b16 a[176:177], v9 offset:256
    v_mfma_f32_16x16x32_bf16 v[196:199], a[44:47], a[212:215], v[196:199]
    ds_read_b64_tr_b16 a[178:179], v9 offset:2560
    s_waitcnt lgkmcnt(14)
    v_mfma_f32_16x16x32_bf16 v[128:131], a[48:51], a[144:147], v[128:131]
    ds_read_b64_tr_b16 a[180:181], v10 offset:288
    v_mfma_f32_16x16x32_bf16 v[164:167], a[52:55], a[144:147], v[164:167]
    ds_read_b64_tr_b16 a[182:183], v10 offset:2592
    s_add_u32 s40, s37, 3538944
    s_add_u32 m0, s39, 20480
    s_nop 0
    buffer_load_dwordx4 v2, s[4:7], s40 offen lds
    v_mfma_f32_16x16x32_bf16 v[132:135], a[48:51], a[148:151], v[132:135]
    ds_read_b64_tr_b16 a[184:185], v9 offset:320
    v_mfma_f32_16x16x32_bf16 v[168:171], a[52:55], a[148:151], v[168:171]
    ds_read_b64_tr_b16 a[186:187], v9 offset:2624
    s_waitcnt lgkmcnt(14)
    v_mfma_f32_16x16x32_bf16 v[136:139], a[48:51], a[152:155], v[136:139]
    ds_read_b64_tr_b16 a[188:189], v10 offset:352
    v_mfma_f32_16x16x32_bf16 v[172:175], a[52:55], a[152:155], v[172:175]
    ds_read_b64_tr_b16 a[190:191], v10 offset:2656
    s_add_u32 s40, s37, 3538944
    s_add_u32 m0, s39, 24576
    s_nop 0
    buffer_load_dwordx4 v3, s[4:7], s40 offen lds
    v_mfma_f32_16x16x32_bf16 v[140:143], a[48:51], a[156:159], v[140:143]
    ds_read_b64_tr_b16 a[192:193], v9 offset:384
    v_mfma_f32_16x16x32_bf16 v[176:179], a[52:55], a[156:159], v[176:179]
    ds_read_b64_tr_b16 a[194:195], v9 offset:2688
    s_waitcnt lgkmcnt(14)
    v_mfma_f32_16x16x32_bf16 v[144:147], a[48:51], a[160:163], v[144:147]
    ds_read_b64_tr_b16 a[196:197], v10 offset:416
    v_mfma_f32_16x16x32_bf16 v[180:183], a[52:55], a[160:163], v[180:183]
    ds_read_b64_tr_b16 a[198:199], v10 offset:2720
    s_add_u32 s40, s37, 3538944
    s_add_u32 m0, s39, 28672
    s_nop 0
    buffer_load_dwordx4 v4, s[4:7], s40 offen lds
    v_mfma_f32_16x16x32_bf16 v[148:151], a[48:51], a[164:167], v[148:151]
    ds_read_b64_tr_b16 a[200:201], v9 offset:448
    v_mfma_f32_16x16x32_bf16 v[184:187], a[52:55], a[164:167], v[184:187]
    ds_read_b64_tr_b16 a[202:203], v9 offset:2752
    s_waitcnt lgkmcnt(14)
    v_mfma_f32_16x16x32_bf16 v[152:155], a[48:51], a[168:171], v[152:155]
    ds_read_b64_tr_b16 a[204:205], v10 offset:480
    s_add_u32 s40, s37, 3538944
    s_add_u32 m0, s39, 32768
    s_nop 0
    buffer_load_dwordx4 v5, s[4:7], s40 offen lds
    v_mfma_f32_16x16x32_bf16 v[188:191], a[52:55], a[168:171], v[188:191]
    ds_read_b64_tr_b16 a[206:207], v10 offset:2784
    v_mfma_f32_16x16x32_bf16 v[156:159], a[48:51], a[172:175], v[156:159]
    ds_read_b64_tr_b16 a[208:209], v9 offset:512
    v_mfma_f32_16x16x32_bf16 v[192:195], a[52:55], a[172:175], v[192:195]
    ds_read_b64_tr_b16 a[210:211], v9 offset:2816
    s_waitcnt lgkmcnt(15)
    v_mfma_f32_16x16x32_bf16 v[160:163], a[48:51], a[176:179], v[160:163]
    ds_read_b64_tr_b16 a[212:213], v10 offset:544
    s_add_u32 s40, s37, 3538944
    s_add_u32 m0, s39, 36864
    s_nop 0
    buffer_load_dwordx4 v6, s[4:7], s40 offen lds
    v_mfma_f32_16x16x32_bf16 v[196:199], a[52:55], a[176:179], v[196:199]
    ds_read_b64_tr_b16 a[214:215], v10 offset:2848
    s_waitcnt vmcnt(14)
    s_barrier
    v_add_u32 v9, 81920, v7
    v_add_u32 v10, 81920, v8
    s_waitcnt lgkmcnt(14)
    v_mfma_f32_16x16x32_bf16 v[128:131], a[56:59], a[180:183], v[128:131]
    ds_read_b64_tr_b16 a[144:145], v9 offset:0
    v_mfma_f32_16x16x32_bf16 v[164:167], a[60:63], a[180:183], v[164:167]
    ds_read_b64_tr_b16 a[146:147], v9 offset:2304
    v_mfma_f32_16x16x32_bf16 v[132:135], a[56:59], a[184:187], v[132:135]
    ds_read_b64_tr_b16 a[148:149], v10 offset:32
    buffer_load_dwordx4 a[96:99], v11, s[8:11], s67 offen offset:0
    v_mfma_f32_16x16x32_bf16 v[168:171], a[60:63], a[184:187], v[168:171]
    ds_read_b64_tr_b16 a[150:151], v10 offset:2336
    s_waitcnt lgkmcnt(14)
    v_mfma_f32_16x16x32_bf16 v[136:139], a[56:59], a[188:191], v[136:139]
    ds_read_b64_tr_b16 a[152:153], v9 offset:64
    v_mfma_f32_16x16x32_bf16 v[172:175], a[60:63], a[188:191], v[172:175]
    ds_read_b64_tr_b16 a[154:155], v9 offset:2368
    v_mfma_f32_16x16x32_bf16 v[140:143], a[56:59], a[192:195], v[140:143]
    ds_read_b64_tr_b16 a[156:157], v10 offset:96
    buffer_load_dwordx4 a[100:103], v12, s[8:11], s67 offen offset:0
    v_mfma_f32_16x16x32_bf16 v[176:179], a[60:63], a[192:195], v[176:179]
    ds_read_b64_tr_b16 a[158:159], v10 offset:2400
    s_waitcnt lgkmcnt(14)
    v_mfma_f32_16x16x32_bf16 v[144:147], a[56:59], a[196:199], v[144:147]
    ds_read_b64_tr_b16 a[160:161], v9 offset:128
    v_mfma_f32_16x16x32_bf16 v[180:183], a[60:63], a[196:199], v[180:183]
    ds_read_b64_tr_b16 a[162:163], v9 offset:2432
    v_mfma_f32_16x16x32_bf16 v[148:151], a[56:59], a[200:203], v[148:151]
    ds_read_b64_tr_b16 a[164:165], v10 offset:160
    v_mfma_f32_16x16x32_bf16 v[184:187], a[60:63], a[200:203], v[184:187]
    ds_read_b64_tr_b16 a[166:167], v10 offset:2464
    buffer_load_dwordx4 a[104:107], v11, s[8:11], s67 offen offset:1024
    s_waitcnt lgkmcnt(14)
    v_mfma_f32_16x16x32_bf16 v[152:155], a[56:59], a[204:207], v[152:155]
    ds_read_b64_tr_b16 a[168:169], v9 offset:192
    v_mfma_f32_16x16x32_bf16 v[188:191], a[60:63], a[204:207], v[188:191]
    ds_read_b64_tr_b16 a[170:171], v9 offset:2496
    v_mfma_f32_16x16x32_bf16 v[156:159], a[56:59], a[208:211], v[156:159]
    ds_read_b64_tr_b16 a[172:173], v10 offset:224
    v_mfma_f32_16x16x32_bf16 v[192:195], a[60:63], a[208:211], v[192:195]
    ds_read_b64_tr_b16 a[174:175], v10 offset:2528
    buffer_load_dwordx4 a[108:111], v12, s[8:11], s67 offen offset:1024
    s_waitcnt lgkmcnt(15)
    v_mfma_f32_16x16x32_bf16 v[160:163], a[56:59], a[212:215], v[160:163]
    ds_read_b64_tr_b16 a[176:177], v9 offset:256
    v_mfma_f32_16x16x32_bf16 v[196:199], a[60:63], a[212:215], v[196:199]
    ds_read_b64_tr_b16 a[178:179], v9 offset:2560
    s_waitcnt lgkmcnt(14)
    v_mfma_f32_16x16x32_bf16 v[128:131], a[64:67], a[144:147], v[128:131]
    ds_read_b64_tr_b16 a[180:181], v10 offset:288
    v_mfma_f32_16x16x32_bf16 v[164:167], a[68:71], a[144:147], v[164:167]
    ds_read_b64_tr_b16 a[182:183], v10 offset:2592
    s_add_u32 s40, s37, 4128768
    s_add_u32 m0, s39, 40960
    s_nop 0
    buffer_load_dwordx4 v2, s[4:7], s40 offen lds
    v_mfma_f32_16x16x32_bf16 v[132:135], a[64:67], a[148:151], v[132:135]
    ds_read_b64_tr_b16 a[184:185], v9 offset:320
    v_mfma_f32_16x16x32_bf16 v[168:171], a[68:71], a[148:151], v[168:171]
    ds_read_b64_tr_b16 a[186:187], v9 offset:2624
    s_waitcnt lgkmcnt(14)
    v_mfma_f32_16x16x32_bf16 v[136:139], a[64:67], a[152:155], v[136:139]
    ds_read_b64_tr_b16 a[188:189], v10 offset:352
    s_add_u32 s40, s37, 4128768
    s_add_u32 m0, s39, 45056
    s_nop 0
    buffer_load_dwordx4 v3, s[4:7], s40 offen lds
    v_mfma_f32_16x16x32_bf16 v[172:175], a[68:71], a[152:155], v[172:175]
    ds_read_b64_tr_b16 a[190:191], v10 offset:2656
    v_mfma_f32_16x16x32_bf16 v[140:143], a[64:67], a[156:159], v[140:143]
    ds_read_b64_tr_b16 a[192:193], v9 offset:384
    v_mfma_f32_16x16x32_bf16 v[176:179], a[68:71], a[156:159], v[176:179]
    ds_read_b64_tr_b16 a[194:195], v9 offset:2688
    s_add_u32 s40, s37, 4128768
    s_add_u32 m0, s39, 49152
    s_nop 0
    buffer_load_dwordx4 v4, s[4:7], s40 offen lds
    s_waitcnt lgkmcnt(14)
    v_mfma_f32_16x16x32_bf16 v[144:147], a[64:67], a[160:163], v[144:147]
    ds_read_b64_tr_b16 a[196:197], v10 offset:416
    v_mfma_f32_16x16x32_bf16 v[180:183], a[68:71], a[160:163], v[180:183]
    ds_read_b64_tr_b16 a[198:199], v10 offset:2720
    v_mfma_f32_16x16x32_bf16 v[148:151], a[64:67], a[164:167], v[148:151]
    ds_read_b64_tr_b16 a[200:201], v9 offset:448
    s_add_u32 s40, s37, 4128768
    s_add_u32 m0, s39, 53248
    s_nop 0
    buffer_load_dwordx4 v5, s[4:7], s40 offen lds
    v_mfma_f32_16x16x32_bf16 v[184:187], a[68:71], a[164:167], v[184:187]
    ds_read_b64_tr_b16 a[202:203], v9 offset:2752
    s_waitcnt lgkmcnt(14)
    v_mfma_f32_16x16x32_bf16 v[152:155], a[64:67], a[168:171], v[152:155]
    ds_read_b64_tr_b16 a[204:205], v10 offset:480
    v_mfma_f32_16x16x32_bf16 v[188:191], a[68:71], a[168:171], v[188:191]
    ds_read_b64_tr_b16 a[206:207], v10 offset:2784
    s_add_u32 s40, s37, 4128768
    s_add_u32 m0, s39, 57344
    s_nop 0
    buffer_load_dwordx4 v6, s[4:7], s40 offen lds
    v_mfma_f32_16x16x32_bf16 v[156:159], a[64:67], a[172:175], v[156:159]
    ds_read_b64_tr_b16 a[208:209], v9 offset:512
    v_mfma_f32_16x16x32_bf16 v[192:195], a[68:71], a[172:175], v[192:195]
    ds_read_b64_tr_b16 a[210:211], v9 offset:2816
    s_waitcnt lgkmcnt(15)
    v_mfma_f32_16x16x32_bf16 v[160:163], a[64:67], a[176:179], v[160:163]
    ds_read_b64_tr_b16 a[212:213], v10 offset:544
    s_mov_b32 s40, 0
    s_add_u32 m0, s43, 0
    s_nop 0
    buffer_load_dwordx4 v13, s[56:59], s40 offen lds
    v_mfma_f32_16x16x32_bf16 v[196:199], a[68:71], a[176:179], v[196:199]
    ds_read_b64_tr_b16 a[214:215], v10 offset:2848
    s_waitcnt vmcnt(15)
    s_barrier
    v_add_u32 v9, 0, v7
    v_add_u32 v10, 0, v8
    s_waitcnt lgkmcnt(14)
    v_mfma_f32_16x16x32_bf16 v[128:131], a[72:75], a[180:183], v[128:131]
    ds_read_b64_tr_b16 a[144:145], v9 offset:0
    v_mfma_f32_16x16x32_bf16 v[164:167], a[76:79], a[180:183], v[164:167]
    ds_read_b64_tr_b16 a[146:147], v9 offset:2304
    buffer_load_dwordx4 a[112:115], v11, s[8:11], s67 offen offset:2048
    v_mfma_f32_16x16x32_bf16 v[132:135], a[72:75], a[184:187], v[132:135]
    ds_read_b64_tr_b16 a[148:149], v10 offset:32
    v_mfma_f32_16x16x32_bf16 v[168:171], a[76:79], a[184:187], v[168:171]
    ds_read_b64_tr_b16 a[150:151], v10 offset:2336
    s_waitcnt lgkmcnt(14)
    v_mfma_f32_16x16x32_bf16 v[136:139], a[72:75], a[188:191], v[136:139]
    ds_read_b64_tr_b16 a[152:153], v9 offset:64
    v_mfma_f32_16x16x32_bf16 v[172:175], a[76:79], a[188:191], v[172:175]
    ds_read_b64_tr_b16 a[154:155], v9 offset:2368
    buffer_load_dwordx4 a[116:119], v12, s[8:11], s67 offen offset:2048
    v_mfma_f32_16x16x32_bf16 v[140:143], a[72:75], a[192:195], v[140:143]
    ds_read_b64_tr_b16 a[156:157], v10 offset:96
    v_mfma_f32_16x16x32_bf16 v[176:179], a[76:79], a[192:195], v[176:179]
    ds_read_b64_tr_b16 a[158:159], v10 offset:2400
    s_waitcnt lgkmcnt(14)
    v_mfma_f32_16x16x32_bf16 v[144:147], a[72:75], a[196:199], v[144:147]
    ds_read_b64_tr_b16 a[160:161], v9 offset:128
    v_mfma_f32_16x16x32_bf16 v[180:183], a[76:79], a[196:199], v[180:183]
    ds_read_b64_tr_b16 a[162:163], v9 offset:2432
    buffer_load_dwordx4 a[120:123], v11, s[8:11], s67 offen offset:3072
    v_mfma_f32_16x16x32_bf16 v[148:151], a[72:75], a[200:203], v[148:151]
    ds_read_b64_tr_b16 a[164:165], v10 offset:160
    v_mfma_f32_16x16x32_bf16 v[184:187], a[76:79], a[200:203], v[184:187]
    ds_read_b64_tr_b16 a[166:167], v10 offset:2464
    s_waitcnt lgkmcnt(14)
    v_mfma_f32_16x16x32_bf16 v[152:155], a[72:75], a[204:207], v[152:155]
    ds_read_b64_tr_b16 a[168:169], v9 offset:192
    buffer_load_dwordx4 a[124:127], v12, s[8:11], s67 offen offset:3072
    v_mfma_f32_16x16x32_bf16 v[188:191], a[76:79], a[204:207], v[188:191]
    ds_read_b64_tr_b16 a[170:171], v9 offset:2496
    v_mfma_f32_16x16x32_bf16 v[156:159], a[72:75], a[208:211], v[156:159]
    ds_read_b64_tr_b16 a[172:173], v10 offset:224
    v_mfma_f32_16x16x32_bf16 v[192:195], a[76:79], a[208:211], v[192:195]
    ds_read_b64_tr_b16 a[174:175], v10 offset:2528
    s_waitcnt lgkmcnt(15)
    v_mfma_f32_16x16x32_bf16 v[160:163], a[72:75], a[212:215], v[160:163]
    ds_read_b64_tr_b16 a[176:177], v9 offset:256
    s_mov_b32 s40, 64
    s_add_u32 m0, s43, 1024
    s_nop 0
    buffer_load_dwordx4 v13, s[56:59], s40 offen lds
    v_mfma_f32_16x16x32_bf16 v[196:199], a[76:79], a[212:215], v[196:199]
    ds_read_b64_tr_b16 a[178:179], v9 offset:2560
    s_waitcnt lgkmcnt(14)
    v_mfma_f32_16x16x32_bf16 v[128:131], a[80:83], a[144:147], v[128:131]
    ds_read_b64_tr_b16 a[180:181], v10 offset:288
    v_mfma_f32_16x16x32_bf16 v[164:167], a[84:87], a[144:147], v[164:167]
    ds_read_b64_tr_b16 a[182:183], v10 offset:2592
    s_add_u32 s40, s37, 4718592
    s_add_u32 m0, s39, 61440
    s_nop 0
    buffer_load_dwordx4 v2, s[4:7], s40 offen lds
    v_mfma_f32_16x16x32_bf16 v[132:135], a[80:83], a[148:151], v[132:135]
    ds_read_b64_tr_b16 a[184:185], v9 offset:320
    v_mfma_f32_16x16x32_bf16 v[168:171], a[84:87], a[148:151], v[168:171]
    ds_read_b64_tr_b16 a[186:187], v9 offset:2624
    s_waitcnt lgkmcnt(14)
    v_mfma_f32_16x16x32_bf16 v[136:139], a[80:83], a[152:155], v[136:139]
    ds_read_b64_tr_b16 a[188:189], v10 offset:352
    s_add_u32 s40, s37, 4718592
    s_add_u32 m0, s39, 65536
    s_nop 0
    buffer_load_dwordx4 v3, s[4:7], s40 offen lds
    v_mfma_f32_16x16x32_bf16 v[172:175], a[84:87], a[152:155], v[172:175]
    ds_read_b64_tr_b16 a[190:191], v10 offset:2656
    v_mfma_f32_16x16x32_bf16 v[140:143], a[80:83], a[156:159], v[140:143]
    ds_read_b64_tr_b16 a[192:193], v9 offset:384
    v_mfma_f32_16x16x32_bf16 v[176:179], a[84:87], a[156:159], v[176:179]
    ds_read_b64_tr_b16 a[194:195], v9 offset:2688
    s_add_u32 s40, s37, 4718592
    s_add_u32 m0, s39, 69632
    s_nop 0
    buffer_load_dwordx4 v4, s[4:7], s40 offen lds
    s_waitcnt lgkmcnt(14)
    v_mfma_f32_16x16x32_bf16 v[144:147], a[80:83], a[160:163], v[144:147]
    ds_read_b64_tr_b16 a[196:197], v10 offset:416
    v_mfma_f32_16x16x32_bf16 v[180:183], a[84:87], a[160:163], v[180:183]
    ds_read_b64_tr_b16 a[198:199], v10 offset:2720
    v_mfma_f32_16x16x32_bf16 v[148:151], a[80:83], a[164:167], v[148:151]
    ds_read_b64_tr_b16 a[200:201], v9 offset:448
    s_add_u32 s40, s37, 4718592
    s_add_u32 m0, s39, 73728
    s_nop 0
    buffer_load_dwordx4 v5, s[4:7], s40 offen lds
    v_mfma_f32_16x16x32_bf16 v[184:187], a[84:87], a[164:167], v[184:187]
    ds_read_b64_tr_b16 a[202:203], v9 offset:2752
    s_waitcnt lgkmcnt(14)
    v_mfma_f32_16x16x32_bf16 v[152:155], a[80:83], a[168:171], v[152:155]
    ds_read_b64_tr_b16 a[204:205], v10 offset:480
    v_mfma_f32_16x16x32_bf16 v[188:191], a[84:87], a[168:171], v[188:191]
    ds_read_b64_tr_b16 a[206:207], v10 offset:2784
    s_add_u32 s40, s37, 4718592
    s_add_u32 m0, s39, 77824
    s_nop 0
    buffer_load_dwordx4 v6, s[4:7], s40 offen lds
    v_mfma_f32_16x16x32_bf16 v[156:159], a[80:83], a[172:175], v[156:159]
    ds_read_b64_tr_b16 a[208:209], v9 offset:512
    v_mfma_f32_16x16x32_bf16 v[192:195], a[84:87], a[172:175], v[192:195]
    ds_read_b64_tr_b16 a[210:211], v9 offset:2816
    s_waitcnt lgkmcnt(15)
    v_mfma_f32_16x16x32_bf16 v[160:163], a[80:83], a[176:179], v[160:163]
    ds_read_b64_tr_b16 a[212:213], v10 offset:544
    s_mov_b32 s40, 128
    s_add_u32 m0, s43, 2048
    s_nop 0
    buffer_load_dwordx4 v13, s[56:59], s40 offen lds
    v_mfma_f32_16x16x32_bf16 v[196:199], a[84:87], a[176:179], v[196:199]
    ds_read_b64_tr_b16 a[214:215], v10 offset:2848
    s_waitcnt vmcnt(17)
    s_barrier
    v_add_u32 v9, 20480, v7
    v_add_u32 v10, 20480, v8
    s_waitcnt lgkmcnt(14)
    v_mfma_f32_16x16x32_bf16 v[128:131], a[88:91], a[180:183], v[128:131]
    ds_read_b64_tr_b16 a[144:145], v9 offset:0
    v_mfma_f32_16x16x32_bf16 v[164:167], a[92:95], a[180:183], v[164:167]
    ds_read_b64_tr_b16 a[146:147], v9 offset:2304
    buffer_load_dwordx4 a[128:131], v11, s[8:11], s68 offen offset:0
    v_mfma_f32_16x16x32_bf16 v[132:135], a[88:91], a[184:187], v[132:135]
    ds_read_b64_tr_b16 a[148:149], v10 offset:32
    v_mfma_f32_16x16x32_bf16 v[168:171], a[92:95], a[184:187], v[168:171]
    ds_read_b64_tr_b16 a[150:151], v10 offset:2336
    s_waitcnt lgkmcnt(14)
    v_mfma_f32_16x16x32_bf16 v[136:139], a[88:91], a[188:191], v[136:139]
    ds_read_b64_tr_b16 a[152:153], v9 offset:64
    v_mfma_f32_16x16x32_bf16 v[172:175], a[92:95], a[188:191], v[172:175]
    ds_read_b64_tr_b16 a[154:155], v9 offset:2368
    buffer_load_dwordx4 a[132:135], v12, s[8:11], s68 offen offset:0
    v_mfma_f32_16x16x32_bf16 v[140:143], a[88:91], a[192:195], v[140:143]
    ds_read_b64_tr_b16 a[156:157], v10 offset:96
    v_mfma_f32_16x16x32_bf16 v[176:179], a[92:95], a[192:195], v[176:179]
    ds_read_b64_tr_b16 a[158:159], v10 offset:2400
    s_waitcnt lgkmcnt(14)
    v_mfma_f32_16x16x32_bf16 v[144:147], a[88:91], a[196:199], v[144:147]
    ds_read_b64_tr_b16 a[160:161], v9 offset:128
    v_mfma_f32_16x16x32_bf16 v[180:183], a[92:95], a[196:199], v[180:183]
    ds_read_b64_tr_b16 a[162:163], v9 offset:2432
    buffer_load_dwordx4 a[136:139], v11, s[8:11], s68 offen offset:1024
    v_mfma_f32_16x16x32_bf16 v[148:151], a[88:91], a[200:203], v[148:151]
    ds_read_b64_tr_b16 a[164:165], v10 offset:160
    v_mfma_f32_16x16x32_bf16 v[184:187], a[92:95], a[200:203], v[184:187]
    ds_read_b64_tr_b16 a[166:167], v10 offset:2464
    s_waitcnt lgkmcnt(14)
    v_mfma_f32_16x16x32_bf16 v[152:155], a[88:91], a[204:207], v[152:155]
    ds_read_b64_tr_b16 a[168:169], v9 offset:192
    buffer_load_dwordx4 a[140:143], v12, s[8:11], s68 offen offset:1024
    v_mfma_f32_16x16x32_bf16 v[188:191], a[92:95], a[204:207], v[188:191]
    ds_read_b64_tr_b16 a[170:171], v9 offset:2496
    v_mfma_f32_16x16x32_bf16 v[156:159], a[88:91], a[208:211], v[156:159]
    ds_read_b64_tr_b16 a[172:173], v10 offset:224
    v_mfma_f32_16x16x32_bf16 v[192:195], a[92:95], a[208:211], v[192:195]
    ds_read_b64_tr_b16 a[174:175], v10 offset:2528
    s_waitcnt lgkmcnt(15)
    v_mfma_f32_16x16x32_bf16 v[160:163], a[88:91], a[212:215], v[160:163]
    ds_read_b64_tr_b16 a[176:177], v9 offset:256
    s_mov_b32 s40, 192
    s_add_u32 m0, s43, 3072
    s_nop 0
    buffer_load_dwordx4 v13, s[56:59], s40 offen lds
    v_mfma_f32_16x16x32_bf16 v[196:199], a[92:95], a[212:215], v[196:199]
    ds_read_b64_tr_b16 a[178:179], v9 offset:2560
    s_waitcnt lgkmcnt(14)
    v_mfma_f32_16x16x32_bf16 v[128:131], a[96:99], a[144:147], v[128:131]
    ds_read_b64_tr_b16 a[180:181], v10 offset:288
    v_mfma_f32_16x16x32_bf16 v[164:167], a[100:103], a[144:147], v[164:167]
    ds_read_b64_tr_b16 a[182:183], v10 offset:2592
    v_mfma_f32_16x16x32_bf16 v[132:135], a[96:99], a[148:151], v[132:135]
    ds_read_b64_tr_b16 a[184:185], v9 offset:320
    s_add_u32 s40, s38, 0
    s_add_u32 m0, s39, 81920
    s_nop 0
    buffer_load_dwordx4 v2, s[4:7], s40 offen lds
    v_mfma_f32_16x16x32_bf16 v[168:171], a[100:103], a[148:151], v[168:171]
    ds_read_b64_tr_b16 a[186:187], v9 offset:2624
    s_waitcnt lgkmcnt(14)
    v_mfma_f32_16x16x32_bf16 v[136:139], a[96:99], a[152:155], v[136:139]
    ds_read_b64_tr_b16 a[188:189], v10 offset:352
    v_mfma_f32_16x16x32_bf16 v[172:175], a[100:103], a[152:155], v[172:175]
    ds_read_b64_tr_b16 a[190:191], v10 offset:2656
    v_mfma_f32_16x16x32_bf16 v[140:143], a[96:99], a[156:159], v[140:143]
    ds_read_b64_tr_b16 a[192:193], v9 offset:384
    s_add_u32 s40, s38, 0
    s_add_u32 m0, s39, 86016
    s_nop 0
    buffer_load_dwordx4 v3, s[4:7], s40 offen lds
    v_mfma_f32_16x16x32_bf16 v[176:179], a[100:103], a[156:159], v[176:179]
    ds_read_b64_tr_b16 a[194:195], v9 offset:2688
    s_waitcnt lgkmcnt(14)
    v_mfma_f32_16x16x32_bf16 v[144:147], a[96:99], a[160:163], v[144:147]
    ds_read_b64_tr_b16 a[196:197], v10 offset:416
    v_mfma_f32_16x16x32_bf16 v[180:183], a[100:103], a[160:163], v[180:183]
    ds_read_b64_tr_b16 a[198:199], v10 offset:2720
    v_mfma_f32_16x16x32_bf16 v[148:151], a[96:99], a[164:167], v[148:151]
    ds_read_b64_tr_b16 a[200:201], v9 offset:448
    v_mfma_f32_16x16x32_bf16 v[184:187], a[100:103], a[164:167], v[184:187]
    ds_read_b64_tr_b16 a[202:203], v9 offset:2752
    s_add_u32 s40, s38, 0
    s_add_u32 m0, s39, 90112
    s_nop 0
    buffer_load_dwordx4 v4, s[4:7], s40 offen lds
    s_waitcnt lgkmcnt(14)
    v_mfma_f32_16x16x32_bf16 v[152:155], a[96:99], a[168:171], v[152:155]
    ds_read_b64_tr_b16 a[204:205], v10 offset:480
    v_mfma_f32_16x16x32_bf16 v[188:191], a[100:103], a[168:171], v[188:191]
    ds_read_b64_tr_b16 a[206:207], v10 offset:2784
    v_mfma_f32_16x16x32_bf16 v[156:159], a[96:99], a[172:175], v[156:159]
    ds_read_b64_tr_b16 a[208:209], v9 offset:512
    v_mfma_f32_16x16x32_bf16 v[192:195], a[100:103], a[172:175], v[192:195]
    ds_read_b64_tr_b16 a[210:211], v9 offset:2816
    s_mov_b32 s40, 256
    s_add_u32 m0, s43, 4096
    s_nop 0
    buffer_load_dwordx4 v13, s[56:59], s40 offen lds
    s_waitcnt lgkmcnt(15)
    v_mfma_f32_16x16x32_bf16 v[160:163], a[96:99], a[176:179], v[160:163]
    ds_read_b64_tr_b16 a[212:213], v10 offset:544
    v_mfma_f32_16x16x32_bf16 v[196:199], a[100:103], a[176:179], v[196:199]
    ds_read_b64_tr_b16 a[214:215], v10 offset:2848
    s_waitcnt vmcnt(16)
    s_barrier
    v_add_u32 v9, 40960, v7
    v_add_u32 v10, 40960, v8
    s_waitcnt lgkmcnt(14)
    v_mfma_f32_16x16x32_bf16 v[128:131], a[104:107], a[180:183], v[128:131]
    ds_read_b64_tr_b16 a[144:145], v9 offset:0
    v_mfma_f32_16x16x32_bf16 v[164:167], a[108:111], a[180:183], v[164:167]
    ds_read_b64_tr_b16 a[146:147], v9 offset:2304
    v_mfma_f32_16x16x32_bf16 v[132:135], a[104:107], a[184:187], v[132:135]
    ds_read_b64_tr_b16 a[148:149], v10 offset:32
    v_mfma_f32_16x16x32_bf16 v[168:171], a[108:111], a[184:187], v[168:171]
    ds_read_b64_tr_b16 a[150:151], v10 offset:2336
    s_add_u32 s40, s38, 0
    s_add_u32 m0, s39, 94208
    s_nop 0
    buffer_load_dwordx4 v5, s[4:7], s40 offen lds
    s_waitcnt lgkmcnt(14)
    v_mfma_f32_16x16x32_bf16 v[136:139], a[104:107], a[188:191], v[136:139]
    ds_read_b64_tr_b16 a[152:153], v9 offset:64
    v_mfma_f32_16x16x32_bf16 v[172:175], a[108:111], a[188:191], v[172:175]
    ds_read_b64_tr_b16 a[154:155], v9 offset:2368
    v_mfma_f32_16x16x32_bf16 v[140:143], a[104:107], a[192:195], v[140:143]
    ds_read_b64_tr_b16 a[156:157], v10 offset:96
    v_mfma_f32_16x16x32_bf16 v[176:179], a[108:111], a[192:195], v[176:179]
    ds_read_b64_tr_b16 a[158:159], v10 offset:2400
    s_waitcnt lgkmcnt(14)
    v_mfma_f32_16x16x32_bf16 v[144:147], a[104:107], a[196:199], v[144:147]
    ds_read_b64_tr_b16 a[160:161], v9 offset:128
    v_mfma_f32_16x16x32_bf16 v[180:183], a[108:111], a[196:199], v[180:183]
    ds_read_b64_tr_b16 a[162:163], v9 offset:2432
    s_add_u32 s40, s38, 0
    s_add_u32 m0, s39, 98304
    s_nop 0
    buffer_load_dwordx4 v6, s[4:7], s40 offen lds
    v_mfma_f32_16x16x32_bf16 v[148:151], a[104:107], a[200:203], v[148:151]
    ds_read_b64_tr_b16 a[164:165], v10 offset:160
    v_mfma_f32_16x16x32_bf16 v[184:187], a[108:111], a[200:203], v[184:187]
    ds_read_b64_tr_b16 a[166:167], v10 offset:2464
    s_waitcnt lgkmcnt(14)
    v_mfma_f32_16x16x32_bf16 v[152:155], a[104:107], a[204:207], v[152:155]
    ds_read_b64_tr_b16 a[168:169], v9 offset:192
    v_mfma_f32_16x16x32_bf16 v[188:191], a[108:111], a[204:207], v[188:191]
    ds_read_b64_tr_b16 a[170:171], v9 offset:2496
    v_mfma_f32_16x16x32_bf16 v[156:159], a[104:107], a[208:211], v[156:159]
    ds_read_b64_tr_b16 a[172:173], v10 offset:224
    v_mfma_f32_16x16x32_bf16 v[192:195], a[108:111], a[208:211], v[192:195]
    ds_read_b64_tr_b16 a[174:175], v10 offset:2528
    s_mov_b32 s40, 320
    s_add_u32 m0, s43, 5120
    s_nop 0
    buffer_load_dwordx4 v13, s[56:59], s40 offen lds
    s_waitcnt lgkmcnt(15)
    v_mfma_f32_16x16x32_bf16 v[160:163], a[104:107], a[212:215], v[160:163]
    ds_read_b64_tr_b16 a[176:177], v9 offset:256
    v_mfma_f32_16x16x32_bf16 v[196:199], a[108:111], a[212:215], v[196:199]
    ds_read_b64_tr_b16 a[178:179], v9 offset:2560
    s_waitcnt lgkmcnt(14)
    v_mfma_f32_16x16x32_bf16 v[128:131], a[112:115], a[144:147], v[128:131]
    ds_read_b64_tr_b16 a[180:181], v10 offset:288
    v_mfma_f32_16x16x32_bf16 v[164:167], a[116:119], a[144:147], v[164:167]
    ds_read_b64_tr_b16 a[182:183], v10 offset:2592
    v_mfma_f32_16x16x32_bf16 v[132:135], a[112:115], a[148:151], v[132:135]
    ds_read_b64_tr_b16 a[184:185], v9 offset:320
    s_add_u32 s40, s38, 589824
    s_add_u32 m0, s39, 0
    s_nop 0
    buffer_load_dwordx4 v2, s[4:7], s40 offen lds
    v_mfma_f32_16x16x32_bf16 v[168:171], a[116:119], a[148:151], v[168:171]
    ds_read_b64_tr_b16 a[186:187], v9 offset:2624
    s_waitcnt lgkmcnt(14)
    v_mfma_f32_16x16x32_bf16 v[136:139], a[112:115], a[152:155], v[136:139]
    ds_read_b64_tr_b16 a[188:189], v10 offset:352
    v_mfma_f32_16x16x32_bf16 v[172:175], a[116:119], a[152:155], v[172:175]
    ds_read_b64_tr_b16 a[190:191], v10 offset:2656
    v_mfma_f32_16x16x32_bf16 v[140:143], a[112:115], a[156:159], v[140:143]
    ds_read_b64_tr_b16 a[192:193], v9 offset:384
    s_add_u32 s40, s38, 589824
    s_add_u32 m0, s39, 4096
    s_nop 0
    buffer_load_dwordx4 v3, s[4:7], s40 offen lds
    v_mfma_f32_16x16x32_bf16 v[176:179], a[116:119], a[156:159], v[176:179]
    ds_read_b64_tr_b16 a[194:195], v9 offset:2688
    s_waitcnt lgkmcnt(14)
    v_mfma_f32_16x16x32_bf16 v[144:147], a[112:115], a[160:163], v[144:147]
    ds_read_b64_tr_b16 a[196:197], v10 offset:416
    v_mfma_f32_16x16x32_bf16 v[180:183], a[116:119], a[160:163], v[180:183]
    ds_read_b64_tr_b16 a[198:199], v10 offset:2720
    v_mfma_f32_16x16x32_bf16 v[148:151], a[112:115], a[164:167], v[148:151]
    ds_read_b64_tr_b16 a[200:201], v9 offset:448
    v_mfma_f32_16x16x32_bf16 v[184:187], a[116:119], a[164:167], v[184:187]
    ds_read_b64_tr_b16 a[202:203], v9 offset:2752
    s_add_u32 s40, s38, 589824
    s_add_u32 m0, s39, 8192
    s_nop 0
    buffer_load_dwordx4 v4, s[4:7], s40 offen lds
    s_waitcnt lgkmcnt(14)
    v_mfma_f32_16x16x32_bf16 v[152:155], a[112:115], a[168:171], v[152:155]
    ds_read_b64_tr_b16 a[204:205], v10 offset:480
    v_mfma_f32_16x16x32_bf16 v[188:191], a[116:119], a[168:171], v[188:191]
    ds_read_b64_tr_b16 a[206:207], v10 offset:2784
    v_mfma_f32_16x16x32_bf16 v[156:159], a[112:115], a[172:175], v[156:159]
    ds_read_b64_tr_b16 a[208:209], v9 offset:512
    v_mfma_f32_16x16x32_bf16 v[192:195], a[116:119], a[172:175], v[192:195]
    ds_read_b64_tr_b16 a[210:211], v9 offset:2816
    s_mov_b32 s40, 384
    s_add_u32 m0, s43, 6144
    s_nop 0
    buffer_load_dwordx4 v13, s[56:59], s40 offen lds
    s_waitcnt lgkmcnt(15)
    v_mfma_f32_16x16x32_bf16 v[160:163], a[112:115], a[176:179], v[160:163]
    ds_read_b64_tr_b16 a[212:213], v10 offset:544
    v_mfma_f32_16x16x32_bf16 v[196:199], a[116:119], a[176:179], v[196:199]
    ds_read_b64_tr_b16 a[214:215], v10 offset:2848
    s_waitcnt vmcnt(12)
    s_barrier
    v_add_u32 v9, 61440, v7
    v_add_u32 v10, 61440, v8
    s_waitcnt lgkmcnt(14)
    v_mfma_f32_16x16x32_bf16 v[128:131], a[120:123], a[180:183], v[128:131]
    ds_read_b64_tr_b16 a[144:145], v9 offset:0
    v_mfma_f32_16x16x32_bf16 v[164:167], a[124:127], a[180:183], v[164:167]
    ds_read_b64_tr_b16 a[146:147], v9 offset:2304
    v_mfma_f32_16x16x32_bf16 v[132:135], a[120:123], a[184:187], v[132:135]
    ds_read_b64_tr_b16 a[148:149], v10 offset:32
    v_mfma_f32_16x16x32_bf16 v[168:171], a[124:127], a[184:187], v[168:171]
    ds_read_b64_tr_b16 a[150:151], v10 offset:2336
    s_add_u32 s40, s38, 589824
    s_add_u32 m0, s39, 12288
    s_nop 0
    buffer_load_dwordx4 v5, s[4:7], s40 offen lds
    s_waitcnt lgkmcnt(14)
    v_mfma_f32_16x16x32_bf16 v[136:139], a[120:123], a[188:191], v[136:139]
    ds_read_b64_tr_b16 a[152:153], v9 offset:64
    v_mfma_f32_16x16x32_bf16 v[172:175], a[124:127], a[188:191], v[172:175]
    ds_read_b64_tr_b16 a[154:155], v9 offset:2368
    v_mfma_f32_16x16x32_bf16 v[140:143], a[120:123], a[192:195], v[140:143]
    ds_read_b64_tr_b16 a[156:157], v10 offset:96
    v_mfma_f32_16x16x32_bf16 v[176:179], a[124:127], a[192:195], v[176:179]
    ds_read_b64_tr_b16 a[158:159], v10 offset:2400
    s_waitcnt lgkmcnt(14)
    v_mfma_f32_16x16x32_bf16 v[144:147], a[120:123], a[196:199], v[144:147]
    ds_read_b64_tr_b16 a[160:161], v9 offset:128
    v_mfma_f32_16x16x32_bf16 v[180:183], a[124:127], a[196:199], v[180:183]
    ds_read_b64_tr_b16 a[162:163], v9 offset:2432
    s_add_u32 s40, s38, 589824
    s_add_u32 m0, s39, 16384
    s_nop 0
    buffer_load_dwordx4 v6, s[4:7], s40 offen lds
    v_mfma_f32_16x16x32_bf16 v[148:151], a[120:123], a[200:203], v[148:151]
    ds_read_b64_tr_b16 a[164:165], v10 offset:160
    v_mfma_f32_16x16x32_bf16 v[184:187], a[124:127], a[200:203], v[184:187]
    ds_read_b64_tr_b16 a[166:167], v10 offset:2464
    s_waitcnt lgkmcnt(14)
    v_mfma_f32_16x16x32_bf16 v[152:155], a[120:123], a[204:207], v[152:155]
    ds_read_b64_tr_b16 a[168:169], v9 offset:192
    v_mfma_f32_16x16x32_bf16 v[188:191], a[124:127], a[204:207], v[188:191]
    ds_read_b64_tr_b16 a[170:171], v9 offset:2496
    v_mfma_f32_16x16x32_bf16 v[156:159], a[120:123], a[208:211], v[156:159]
    ds_read_b64_tr_b16 a[172:173], v10 offset:224
    v_mfma_f32_16x16x32_bf16 v[192:195], a[124:127], a[208:211], v[192:195]
    ds_read_b64_tr_b16 a[174:175], v10 offset:2528
    s_mov_b32 s40, 448
    s_add_u32 m0, s43, 7168
    s_nop 0
    buffer_load_dwordx4 v13, s[56:59], s40 offen lds
    s_waitcnt lgkmcnt(15)
    v_mfma_f32_16x16x32_bf16 v[160:163], a[120:123], a[212:215], v[160:163]
    ds_read_b64_tr_b16 a[176:177], v9 offset:256
    v_mfma_f32_16x16x32_bf16 v[196:199], a[124:127], a[212:215], v[196:199]
    ds_read_b64_tr_b16 a[178:179], v9 offset:2560
    s_waitcnt lgkmcnt(14)
    v_mfma_f32_16x16x32_bf16 v[128:131], a[128:131], a[144:147], v[128:131]
    ds_read_b64_tr_b16 a[180:181], v10 offset:288
    v_mfma_f32_16x16x32_bf16 v[164:167], a[132:135], a[144:147], v[164:167]
    ds_read_b64_tr_b16 a[182:183], v10 offset:2592
    v_mfma_f32_16x16x32_bf16 v[132:135], a[128:131], a[148:151], v[132:135]
    ds_read_b64_tr_b16 a[184:185], v9 offset:320
    v_mfma_f32_16x16x32_bf16 v[168:171], a[132:135], a[148:151], v[168:171]
    ds_read_b64_tr_b16 a[186:187], v9 offset:2624
    s_add_u32 s40, s38, 1179648
    s_add_u32 m0, s39, 20480
    s_nop 0
    buffer_load_dwordx4 v2, s[4:7], s40 offen lds
    s_waitcnt lgkmcnt(14)
    v_mfma_f32_16x16x32_bf16 v[136:139], a[128:131], a[152:155], v[136:139]
    ds_read_b64_tr_b16 a[188:189], v10 offset:352
    v_mfma_f32_16x16x32_bf16 v[172:175], a[132:135], a[152:155], v[172:175]
    ds_read_b64_tr_b16 a[190:191], v10 offset:2656
    v_mfma_f32_16x16x32_bf16 v[140:143], a[128:131], a[156:159], v[140:143]
    ds_read_b64_tr_b16 a[192:193], v9 offset:384
    v_mfma_f32_16x16x32_bf16 v[176:179], a[132:135], a[156:159], v[176:179]
    ds_read_b64_tr_b16 a[194:195], v9 offset:2688
    s_waitcnt lgkmcnt(14)
    v_mfma_f32_16x16x32_bf16 v[144:147], a[128:131], a[160:163], v[144:147]
    ds_read_b64_tr_b16 a[196:197], v10 offset:416
    v_mfma_f32_16x16x32_bf16 v[180:183], a[132:135], a[160:163], v[180:183]
    ds_read_b64_tr_b16 a[198:199], v10 offset:2720
    s_add_u32 s40, s38, 1179648
    s_add_u32 m0, s39, 24576
    s_nop 0
    buffer_load_dwordx4 v3, s[4:7], s40 offen lds
    v_mfma_f32_16x16x32_bf16 v[148:151], a[128:131], a[164:167], v[148:151]
    ds_read_b64_tr_b16 a[200:201], v9 offset:448
    v_mfma_f32_16x16x32_bf16 v[184:187], a[132:135], a[164:167], v[184:187]
    ds_read_b64_tr_b16 a[202:203], v9 offset:2752
    s_waitcnt lgkmcnt(14)
    v_mfma_f32_16x16x32_bf16 v[152:155], a[128:131], a[168:171], v[152:155]
    ds_read_b64_tr_b16 a[204:205], v10 offset:480
    v_mfma_f32_16x16x32_bf16 v[188:191], a[132:135], a[168:171], v[188:191]
    ds_read_b64_tr_b16 a[206:207], v10 offset:2784
    v_mfma_f32_16x16x32_bf16 v[156:159], a[128:131], a[172:175], v[156:159]
    ds_read_b64_tr_b16 a[208:209], v9 offset:512
    v_mfma_f32_16x16x32_bf16 v[192:195], a[132:135], a[172:175], v[192:195]
    ds_read_b64_tr_b16 a[210:211], v9 offset:2816
    s_add_u32 s40, s38, 1179648
    s_add_u32 m0, s39, 28672
    s_nop 0
    buffer_load_dwordx4 v4, s[4:7], s40 offen lds
    s_waitcnt lgkmcnt(15)
    v_mfma_f32_16x16x32_bf16 v[160:163], a[128:131], a[176:179], v[160:163]
    ds_read_b64_tr_b16 a[212:213], v10 offset:544
    v_mfma_f32_16x16x32_bf16 v[196:199], a[132:135], a[176:179], v[196:199]
    ds_read_b64_tr_b16 a[214:215], v10 offset:2848
    s_waitcnt vmcnt(11)
    s_barrier
    v_add_u32 v9, 81920, v7
    v_add_u32 v10, 81920, v8
    s_waitcnt lgkmcnt(14)
    v_mfma_f32_16x16x32_bf16 v[128:131], a[136:139], a[180:183], v[128:131]
    ds_read_b64_tr_b16 a[144:145], v9 offset:0
    v_mfma_f32_16x16x32_bf16 v[164:167], a[140:143], a[180:183], v[164:167]
    ds_read_b64_tr_b16 a[146:147], v9 offset:2304
    v_mfma_f32_16x16x32_bf16 v[132:135], a[136:139], a[184:187], v[132:135]
    ds_read_b64_tr_b16 a[148:149], v10 offset:32
    v_mfma_f32_16x16x32_bf16 v[168:171], a[140:143], a[184:187], v[168:171]
    ds_read_b64_tr_b16 a[150:151], v10 offset:2336
    s_waitcnt lgkmcnt(14)
    v_mfma_f32_16x16x32_bf16 v[136:139], a[136:139], a[188:191], v[136:139]
    ds_read_b64_tr_b16 a[152:153], v9 offset:64
    s_add_u32 s40, s38, 1179648
    s_add_u32 m0, s39, 32768
    s_nop 0
    buffer_load_dwordx4 v5, s[4:7], s40 offen lds
    v_mfma_f32_16x16x32_bf16 v[172:175], a[140:143], a[188:191], v[172:175]
    ds_read_b64_tr_b16 a[154:155], v9 offset:2368
    v_mfma_f32_16x16x32_bf16 v[140:143], a[136:139], a[192:195], v[140:143]
    ds_read_b64_tr_b16 a[156:157], v10 offset:96
    v_mfma_f32_16x16x32_bf16 v[176:179], a[140:143], a[192:195], v[176:179]
    ds_read_b64_tr_b16 a[158:159], v10 offset:2400
    s_waitcnt lgkmcnt(14)
    v_mfma_f32_16x16x32_bf16 v[144:147], a[136:139], a[196:199], v[144:147]
    ds_read_b64_tr_b16 a[160:161], v9 offset:128
    v_mfma_f32_16x16x32_bf16 v[180:183], a[140:143], a[196:199], v[180:183]
    ds_read_b64_tr_b16 a[162:163], v9 offset:2432
    v_mfma_f32_16x16x32_bf16 v[148:151], a[136:139], a[200:203], v[148:151]
    ds_read_b64_tr_b16 a[164:165], v10 offset:160
    v_mfma_f32_16x16x32_bf16 v[184:187], a[140:143], a[200:203], v[184:187]
    ds_read_b64_tr_b16 a[166:167], v10 offset:2464
    s_waitcnt lgkmcnt(14)
    v_mfma_f32_16x16x32_bf16 v[152:155], a[136:139], a[204:207], v[152:155]
    ds_read_b64_tr_b16 a[168:169], v9 offset:192
    v_mfma_f32_16x16x32_bf16 v[188:191], a[140:143], a[204:207], v[188:191]
    ds_read_b64_tr_b16 a[170:171], v9 offset:2496
    s_add_u32 s40, s38, 1179648
    s_add_u32 m0, s39, 36864
    s_nop 0
    buffer_load_dwordx4 v6, s[4:7], s40 offen lds
    v_mfma_f32_16x16x32_bf16 v[156:159], a[136:139], a[208:211], v[156:159]
    ds_read_b64_tr_b16 a[172:173], v10 offset:224
    v_mfma_f32_16x16x32_bf16 v[192:195], a[140:143], a[208:211], v[192:195]
    ds_read_b64_tr_b16 a[174:175], v10 offset:2528
    s_waitcnt lgkmcnt(15)
    v_mfma_f32_16x16x32_bf16 v[160:163], a[136:139], a[212:215], v[160:163]
    ds_read_b64_tr_b16 a[176:177], v9 offset:256
    v_mfma_f32_16x16x32_bf16 v[196:199], a[140:143], a[212:215], v[196:199]
    ds_read_b64_tr_b16 a[178:179], v9 offset:2560
    s_waitcnt vmcnt(5) lgkmcnt(0)
    ds_read_b128 a[216:219], v253 offset:0
    ds_read_b128 a[220:223], v253 offset:1024
    ds_read_b128 a[224:227], v253 offset:2048
    ds_read_b128 a[228:231], v253 offset:3072
    ds_read_b128 a[232:235], v253 offset:4096
    ds_read_b128 a[236:239], v253 offset:5120
    ds_read_b128 a[240:243], v253 offset:6144
    ds_read_b128 a[244:247], v253 offset:7168
    s_waitcnt lgkmcnt(0)
    s_barrier
    v_mov_b32 v218, 0
    v_mov_b32 v219, 0
    v_mov_b32 v220, 0
    v_mov_b32 v221, 0
    v_mov_b32 v222, 0
    v_mov_b32 v223, 0
    v_mov_b32 v224, 0
    v_mov_b32 v225, 0
    v_mov_b32 v226, 0
    v_mov_b32 v227, 0
    v_mov_b32 v228, 0
    v_mov_b32 v229, 0
    v_mov_b32 v230, 0
    v_mov_b32 v231, 0
    v_mov_b32 v232, 0
    v_mov_b32 v233, 0
    v_pk_mul_f32 v[206:207], v[128:129], v[128:129]
    v_pk_mul_f32 v[208:209], v[130:131], v[130:131]
    v_pk_mul_f32 v[210:211], v[132:133], v[132:133]
    v_pk_mul_f32 v[212:213], v[134:135], v[134:135]
    v_pk_mul_f32 v[214:215], v[136:137], v[136:137]
    v_pk_mul_f32 v[216:217], v[138:139], v[138:139]
    v_pk_fma_f32 v[206:207], v[206:207], v[202:203], v[200:201]
    s_add_u32 s4, s32, 39845888
    s_addc_u32 s5, s33, 0
    s_and_b32 s5, s5, 0xffff
    s_mov_b32 s6, 6193152
    s_mov_b32 s7, 0x00020000
    s_add_u32 s8, s32, 4194304
    s_addc_u32 s9, s33, 0
    s_and_b32 s9, s9, 0xffff
    s_mov_b32 s10, 2359296
    s_mov_b32 s11, 0x00020000
    v_lshlrev_b32 v252, 4, v15
    s_mul_i32 s44, s70, 10752
    s_lshl_b32 s45, s36, 2
    s_add_u32 s44, s44, s45
    s_lshl_b32 s45, s36, 1
    s_add_u32 s45, s45, 0
    s_mul_i32 s46, s45, 320
    s_lshl_b32 s48, s36, 2
    s_add_u32 s48, s48, 0
    s_cmp_ge_u32 s45, 5
    s_subb_u32 s48, s48, 0
    s_add_u32 s46, s46, s48
    s_lshl_b32 s46, s46, 4
    s_add_u32 s48, s44, 0
    s_add_u32 m0, s46, 110592
    s_add_u32 s49, s48, 0
    buffer_load_dwordx4 v252, s[4:7], s49 offen lds
    v_pk_fma_f32 v[208:209], v[208:209], v[202:203], v[200:201]
    v_pk_fma_f32 v[210:211], v[210:211], v[202:203], v[200:201]
    v_pk_fma_f32 v[212:213], v[212:213], v[202:203], v[200:201]
    v_pk_fma_f32 v[214:215], v[214:215], v[202:203], v[200:201]
    v_pk_fma_f32 v[216:217], v[216:217], v[202:203], v[200:201]
    v_pk_mul_f32 v[206:207], v[206:207], v[128:129]
    v_pk_mul_f32 v[208:209], v[208:209], v[130:131]
    v_pk_mul_f32 v[210:211], v[210:211], v[132:133]
    v_pk_mul_f32 v[212:213], v[212:213], v[134:135]
    v_pk_mul_f32 v[214:215], v[214:215], v[136:137]
    v_pk_mul_f32 v[216:217], v[216:217], v[138:139]
    v_exp_f32 v206, v206
    v_exp_f32 v208, v208
    v_exp_f32 v210, v210
    v_exp_f32 v212, v212
    v_exp_f32 v214, v214
    v_exp_f32 v216, v216
    v_exp_f32 v207, v207
    v_exp_f32 v209, v209
    v_exp_f32 v211, v211
    v_exp_f32 v213, v213
    v_exp_f32 v215, v215
    v_exp_f32 v217, v217
    s_add_u32 m0, s46, 111616
    s_add_u32 s49, s48, 1024
    buffer_load_dwordx4 v252, s[4:7], s49 offen lds
    v_pk_add_f32 v[206:207], v[206:207], v[204:205]
    v_pk_add_f32 v[208:209], v[208:209], v[204:205]
    v_pk_add_f32 v[210:211], v[210:211], v[204:205]
    v_pk_add_f32 v[212:213], v[212:213], v[204:205]
    v_pk_add_f32 v[214:215], v[214:215], v[204:205]
    v_pk_add_f32 v[216:217], v[216:217], v[204:205]
    v_rcp_f32 v206, v206
    v_rcp_f32 v208, v208
    v_rcp_f32 v210, v210
    v_rcp_f32 v212, v212
    v_rcp_f32 v214, v214
    v_rcp_f32 v216, v216
    v_rcp_f32 v207, v207
    v_rcp_f32 v209, v209
    v_rcp_f32 v211, v211
    v_rcp_f32 v213, v213
    v_rcp_f32 v215, v215
    v_rcp_f32 v217, v217
    v_pk_mul_f32 v[128:129], v[128:129], v[206:207]
    v_pk_mul_f32 v[130:131], v[130:131], v[208:209]
    v_pk_mul_f32 v[132:133], v[132:133], v[210:211]
    v_pk_mul_f32 v[134:135], v[134:135], v[212:213]
    v_pk_mul_f32 v[136:137], v[136:137], v[214:215]
    s_add_u32 m0, s46, 112640
    s_add_u32 s49, s48, 2048
    buffer_load_dwordx4 v252, s[4:7], s49 offen lds
    v_pk_mul_f32 v[138:139], v[138:139], v[216:217]
    v_pk_add_f32 v[218:219], v[218:219], v[128:129]
    v_pk_fma_f32 v[226:227], v[128:129], v[128:129], v[226:227]
    v_pk_add_f32 v[220:221], v[220:221], v[130:131]
    v_pk_fma_f32 v[228:229], v[130:131], v[130:131], v[228:229]
    v_pk_add_f32 v[218:219], v[218:219], v[132:133]
    v_pk_fma_f32 v[226:227], v[132:133], v[132:133], v[226:227]
    v_pk_add_f32 v[220:221], v[220:221], v[134:135]
    v_pk_fma_f32 v[228:229], v[134:135], v[134:135], v[228:229]
    v_pk_add_f32 v[218:219], v[218:219], v[136:137]
    v_pk_fma_f32 v[226:227], v[136:137], v[136:137], v[226:227]
    v_pk_add_f32 v[220:221], v[220:221], v[138:139]
    v_pk_fma_f32 v[228:229], v[138:139], v[138:139], v[228:229]
    v_pk_mul_f32 v[206:207], v[140:141], v[140:141]
    v_pk_mul_f32 v[208:209], v[142:143], v[142:143]
    v_pk_mul_f32 v[210:211], v[144:145], v[144:145]
    v_pk_mul_f32 v[212:213], v[146:147], v[146:147]
    v_pk_mul_f32 v[214:215], v[148:149], v[148:149]
    v_pk_mul_f32 v[216:217], v[150:151], v[150:151]
    v_pk_fma_f32 v[206:207], v[206:207], v[202:203], v[200:201]
    v_pk_fma_f32 v[208:209], v[208:209], v[202:203], v[200:201]
    v_pk_fma_f32 v[210:211], v[210:211], v[202:203], v[200:201]
    v_pk_fma_f32 v[212:213], v[212:213], v[202:203], v[200:201]
    s_add_u32 m0, s46, 113664
    s_add_u32 s49, s48, 3072
    buffer_load_dwordx4 v252, s[4:7], s49 offen lds
    v_pk_fma_f32 v[214:215], v[214:215], v[202:203], v[200:201]
    v_pk_fma_f32 v[216:217], v[216:217], v[202:203], v[200:201]
    v_pk_mul_f32 v[206:207], v[206:207], v[140:141]
    v_pk_mul_f32 v[208:209], v[208:209], v[142:143]
    v_pk_mul_f32 v[210:211], v[210:211], v[144:145]
    v_pk_mul_f32 v[212:213], v[212:213], v[146:147]
    v_pk_mul_f32 v[214:215], v[214:215], v[148:149]
    v_pk_mul_f32 v[216:217], v[216:217], v[150:151]
    v_exp_f32 v206, v206
    v_exp_f32 v208, v208
    v_exp_f32 v210, v210
    v_exp_f32 v212, v212
    v_exp_f32 v214, v214
    v_exp_f32 v216, v216
    v_exp_f32 v207, v207
    v_exp_f32 v209, v209
    v_exp_f32 v211, v211
    v_exp_f32 v213, v213
    v_exp_f32 v215, v215
    v_exp_f32 v217, v217
    v_pk_add_f32 v[206:207], v[206:207], v[204:205]
    v_pk_add_f32 v[208:209], v[208:209], v[204:205]
    v_pk_add_f32 v[210:211], v[210:211], v[204:205]
    s_add_u32 m0, s46, 114688
    s_add_u32 s49, s48, 4096
    buffer_load_dwordx4 v252, s[4:7], s49 offen lds
    v_pk_add_f32 v[212:213], v[212:213], v[204:205]
    v_pk_add_f32 v[214:215], v[214:215], v[204:205]
    v_pk_add_f32 v[216:217], v[216:217], v[204:205]
    v_rcp_f32 v206, v206
    v_rcp_f32 v208, v208
    v_rcp_f32 v210, v210
    v_rcp_f32 v212, v212
    v_rcp_f32 v214, v214
    v_rcp_f32 v216, v216
    v_rcp_f32 v207, v207
    v_rcp_f32 v209, v209
    v_rcp_f32 v211, v211
    v_rcp_f32 v213, v213
    v_rcp_f32 v215, v215
    v_rcp_f32 v217, v217
    v_pk_mul_f32 v[140:141], v[140:141], v[206:207]
    v_pk_mul_f32 v[142:143], v[142:143], v[208:209]
    v_pk_mul_f32 v[144:145], v[144:145], v[210:211]
    v_pk_mul_f32 v[146:147], v[146:147], v[212:213]
    v_pk_mul_f32 v[148:149], v[148:149], v[214:215]
    v_pk_mul_f32 v[150:151], v[150:151], v[216:217]
    v_pk_add_f32 v[218:219], v[218:219], v[140:141]
    v_pk_fma_f32 v[226:227], v[140:141], v[140:141], v[226:227]
    s_lshl_b32 s45, s36, 1
    s_add_u32 s45, s45, 1
    s_mul_i32 s46, s45, 320
    s_lshl_b32 s48, s36, 2
    s_add_u32 s48, s48, 1
    s_cmp_ge_u32 s45, 5
    s_subb_u32 s48, s48, 0
    s_add_u32 s46, s46, s48
    s_lshl_b32 s46, s46, 4
    s_add_u32 s48, s44, 2
    s_add_u32 m0, s46, 110592
    s_add_u32 s49, s48, 0
    buffer_load_dwordx4 v252, s[4:7], s49 offen lds
    v_pk_add_f32 v[220:221], v[220:221], v[142:143]
    v_pk_fma_f32 v[228:229], v[142:143], v[142:143], v[228:229]
    v_pk_add_f32 v[218:219], v[218:219], v[144:145]
    v_pk_fma_f32 v[226:227], v[144:145], v[144:145], v[226:227]
    v_pk_add_f32 v[220:221], v[220:221], v[146:147]
    v_pk_fma_f32 v[228:229], v[146:147], v[146:147], v[228:229]
    v_pk_add_f32 v[218:219], v[218:219], v[148:149]
    v_pk_fma_f32 v[226:227], v[148:149], v[148:149], v[226:227]
    v_pk_add_f32 v[220:221], v[220:221], v[150:151]
    v_pk_fma_f32 v[228:229], v[150:151], v[150:151], v[228:229]
    v_pk_mul_f32 v[206:207], v[152:153], v[152:153]
    v_pk_mul_f32 v[208:209], v[154:155], v[154:155]
    v_pk_mul_f32 v[210:211], v[156:157], v[156:157]
    v_pk_mul_f32 v[212:213], v[158:159], v[158:159]
    v_pk_mul_f32 v[214:215], v[160:161], v[160:161]
    v_pk_mul_f32 v[216:217], v[162:163], v[162:163]
    v_pk_fma_f32 v[206:207], v[206:207], v[202:203], v[200:201]
    v_pk_fma_f32 v[208:209], v[208:209], v[202:203], v[200:201]
    v_pk_fma_f32 v[210:211], v[210:211], v[202:203], v[200:201]
    v_pk_fma_f32 v[212:213], v[212:213], v[202:203], v[200:201]
    v_pk_fma_f32 v[214:215], v[214:215], v[202:203], v[200:201]
    v_pk_fma_f32 v[216:217], v[216:217], v[202:203], v[200:201]
    v_pk_mul_f32 v[206:207], v[206:207], v[152:153]
    s_add_u32 m0, s46, 111616
    s_add_u32 s49, s48, 1024
    buffer_load_dwordx4 v252, s[4:7], s49 offen lds
    v_pk_mul_f32 v[208:209], v[208:209], v[154:155]
    v_pk_mul_f32 v[210:211], v[210:211], v[156:157]
    v_pk_mul_f32 v[212:213], v[212:213], v[158:159]
    v_pk_mul_f32 v[214:215], v[214:215], v[160:161]
    v_pk_mul_f32 v[216:217], v[216:217], v[162:163]
    v_exp_f32 v206, v206
    v_exp_f32 v208, v208
    v_exp_f32 v210, v210
    v_exp_f32 v212, v212
    v_exp_f32 v214, v214
    v_exp_f32 v216, v216
    v_exp_f32 v207, v207
    v_exp_f32 v209, v209
    v_exp_f32 v211, v211
    v_exp_f32 v213, v213
    v_exp_f32 v215, v215
    v_exp_f32 v217, v217
    v_pk_add_f32 v[206:207], v[206:207], v[204:205]
    v_pk_add_f32 v[208:209], v[208:209], v[204:205]
    v_pk_add_f32 v[210:211], v[210:211], v[204:205]
    v_pk_add_f32 v[212:213], v[212:213], v[204:205]
    v_pk_add_f32 v[214:215], v[214:215], v[204:205]
    v_pk_add_f32 v[216:217], v[216:217], v[204:205]
    s_add_u32 m0, s46, 112640
    s_add_u32 s49, s48, 2048
    buffer_load_dwordx4 v252, s[4:7], s49 offen lds
    v_rcp_f32 v206, v206
    v_rcp_f32 v208, v208
    v_rcp_f32 v210, v210
    v_rcp_f32 v212, v212
    v_rcp_f32 v214, v214
    v_rcp_f32 v216, v216
    v_rcp_f32 v207, v207
    v_rcp_f32 v209, v209
    v_rcp_f32 v211, v211
    v_rcp_f32 v213, v213
    v_rcp_f32 v215, v215
    v_rcp_f32 v217, v217
    v_pk_mul_f32 v[152:153], v[152:153], v[206:207]
    v_pk_mul_f32 v[154:155], v[154:155], v[208:209]
    v_pk_mul_f32 v[156:157], v[156:157], v[210:211]
    v_pk_mul_f32 v[158:159], v[158:159], v[212:213]
    v_pk_mul_f32 v[160:161], v[160:161], v[214:215]
    v_pk_mul_f32 v[162:163], v[162:163], v[216:217]
    v_pk_add_f32 v[218:219], v[218:219], v[152:153]
    v_pk_fma_f32 v[226:227], v[152:153], v[152:153], v[226:227]
    v_pk_add_f32 v[220:221], v[220:221], v[154:155]
    v_pk_fma_f32 v[228:229], v[154:155], v[154:155], v[228:229]
    v_pk_add_f32 v[218:219], v[218:219], v[156:157]
    s_add_u32 m0, s46, 113664
    s_add_u32 s49, s48, 3072
    buffer_load_dwordx4 v252, s[4:7], s49 offen lds
    v_pk_fma_f32 v[226:227], v[156:157], v[156:157], v[226:227]
    v_pk_add_f32 v[220:221], v[220:221], v[158:159]
    v_pk_fma_f32 v[228:229], v[158:159], v[158:159], v[228:229]
    v_pk_add_f32 v[218:219], v[218:219], v[160:161]
    v_pk_fma_f32 v[226:227], v[160:161], v[160:161], v[226:227]
    v_pk_add_f32 v[220:221], v[220:221], v[162:163]
    v_pk_fma_f32 v[228:229], v[162:163], v[162:163], v[228:229]
    v_pk_mul_f32 v[206:207], v[164:165], v[164:165]
    v_pk_mul_f32 v[208:209], v[166:167], v[166:167]
    v_pk_mul_f32 v[210:211], v[168:169], v[168:169]
    v_pk_mul_f32 v[212:213], v[170:171], v[170:171]
    v_pk_mul_f32 v[214:215], v[172:173], v[172:173]
    v_pk_mul_f32 v[216:217], v[174:175], v[174:175]
    v_pk_fma_f32 v[206:207], v[206:207], v[202:203], v[200:201]
    v_pk_fma_f32 v[208:209], v[208:209], v[202:203], v[200:201]
    v_pk_fma_f32 v[210:211], v[210:211], v[202:203], v[200:201]
    v_pk_fma_f32 v[212:213], v[212:213], v[202:203], v[200:201]
    v_pk_fma_f32 v[214:215], v[214:215], v[202:203], v[200:201]
    v_pk_fma_f32 v[216:217], v[216:217], v[202:203], v[200:201]
    v_pk_mul_f32 v[206:207], v[206:207], v[164:165]
    v_pk_mul_f32 v[208:209], v[208:209], v[166:167]
    v_pk_mul_f32 v[210:211], v[210:211], v[168:169]
    v_pk_mul_f32 v[212:213], v[212:213], v[170:171]
    s_add_u32 m0, s46, 114688
    s_add_u32 s49, s48, 4096
    buffer_load_dwordx4 v252, s[4:7], s49 offen lds
    v_pk_mul_f32 v[214:215], v[214:215], v[172:173]
    v_pk_mul_f32 v[216:217], v[216:217], v[174:175]
    v_exp_f32 v206, v206
    v_exp_f32 v208, v208
    v_exp_f32 v210, v210
    v_exp_f32 v212, v212
    v_exp_f32 v214, v214
    v_exp_f32 v216, v216
    v_exp_f32 v207, v207
    v_exp_f32 v209, v209
    v_exp_f32 v211, v211
    v_exp_f32 v213, v213
    v_exp_f32 v215, v215
    v_exp_f32 v217, v217
    v_pk_add_f32 v[206:207], v[206:207], v[204:205]
    v_pk_add_f32 v[208:209], v[208:209], v[204:205]
    v_pk_add_f32 v[210:211], v[210:211], v[204:205]
    v_pk_add_f32 v[212:213], v[212:213], v[204:205]
    v_pk_add_f32 v[214:215], v[214:215], v[204:205]
    v_pk_add_f32 v[216:217], v[216:217], v[204:205]
    v_rcp_f32 v206, v206
    v_rcp_f32 v208, v208
    v_rcp_f32 v210, v210
    s_lshl_b32 s46, s70, 12
    s_lshl_b32 s44, s36, 7
    s_add_u32 s44, s44, 0
    v_add_u32 v252, s44, v15
    v_mul_u32_u24 v253, 6554, v252
    v_lshrrev_b32 v253, 16, v253
    v_mul_u32_u24 v250, 10, v253
    v_sub_u32 v250, v252, v250
    v_subrev_u32 v253, 15, v253
    v_cmp_gt_u32 vcc, 32, v253
    v_cmp_gt_u32 s[52:53], 8, v250
    v_lshlrev_b32 v253, 7, v253
    v_lshl_add_u32 v253, v250, 4, v253
    s_and_b64 vcc, vcc, s[52:53]
    v_mov_b32 v250, 0x80000000
    s_nop 1
    v_cndmask_b32 v253, v250, v253, vcc
    s_lshl_b32 s45, s36, 11
    s_nop 0
    s_add_u32 m0, s45, 151808
    s_nop 0
    buffer_load_dwordx4 v253, s[8:11], s46 offen lds
    v_rcp_f32 v212, v212
    v_rcp_f32 v214, v214
    v_rcp_f32 v216, v216
    v_rcp_f32 v207, v207
    v_rcp_f32 v209, v209
    v_rcp_f32 v211, v211
    v_rcp_f32 v213, v213
    v_rcp_f32 v215, v215
    v_rcp_f32 v217, v217
    v_pk_mul_f32 v[164:165], v[164:165], v[206:207]
    v_pk_mul_f32 v[166:167], v[166:167], v[208:209]
    v_pk_mul_f32 v[168:169], v[168:169], v[210:211]
    v_pk_mul_f32 v[170:171], v[170:171], v[212:213]
    v_pk_mul_f32 v[172:173], v[172:173], v[214:215]
    v_pk_mul_f32 v[174:175], v[174:175], v[216:217]
    v_pk_add_f32 v[222:223], v[222:223], v[164:165]
    v_pk_fma_f32 v[230:231], v[164:165], v[164:165], v[230:231]
    v_pk_add_f32 v[224:225], v[224:225], v[166:167]
    v_pk_fma_f32 v[232:233], v[166:167], v[166:167], v[232:233]
    v_pk_add_f32 v[222:223], v[222:223], v[168:169]
    v_pk_fma_f32 v[230:231], v[168:169], v[168:169], v[230:231]
    v_pk_add_f32 v[224:225], v[224:225], v[170:171]
    v_pk_fma_f32 v[232:233], v[170:171], v[170:171], v[232:233]
    s_lshl_b32 s44, s36, 7
    s_add_u32 s44, s44, 64
    v_add_u32 v252, s44, v15
    v_mul_u32_u24 v253, 6554, v252
    v_lshrrev_b32 v253, 16, v253
    v_mul_u32_u24 v250, 10, v253
    v_sub_u32 v250, v252, v250
    v_subrev_u32 v253, 15, v253
    v_cmp_gt_u32 vcc, 32, v253
    v_cmp_gt_u32 s[52:53], 8, v250
    v_lshlrev_b32 v253, 7, v253
    v_lshl_add_u32 v253, v250, 4, v253
    s_and_b64 vcc, vcc, s[52:53]
    v_mov_b32 v250, 0x80000000
    s_nop 1
    v_cndmask_b32 v253, v250, v253, vcc
    s_lshl_b32 s45, s36, 11
    s_nop 0
    s_add_u32 m0, s45, 152832
    s_nop 0
    buffer_load_dwordx4 v253, s[8:11], s46 offen lds
    v_pk_add_f32 v[222:223], v[222:223], v[172:173]
    v_pk_fma_f32 v[230:231], v[172:173], v[172:173], v[230:231]
    v_pk_add_f32 v[224:225], v[224:225], v[174:175]
    v_pk_fma_f32 v[232:233], v[174:175], v[174:175], v[232:233]
    v_pk_mul_f32 v[206:207], v[176:177], v[176:177]
    v_pk_mul_f32 v[208:209], v[178:179], v[178:179]
    v_pk_mul_f32 v[210:211], v[180:181], v[180:181]
    v_pk_mul_f32 v[212:213], v[182:183], v[182:183]
    v_pk_mul_f32 v[214:215], v[184:185], v[184:185]
    v_pk_mul_f32 v[216:217], v[186:187], v[186:187]
    v_pk_fma_f32 v[206:207], v[206:207], v[202:203], v[200:201]
    v_pk_fma_f32 v[208:209], v[208:209], v[202:203], v[200:201]
    v_pk_fma_f32 v[210:211], v[210:211], v[202:203], v[200:201]
    v_pk_fma_f32 v[212:213], v[212:213], v[202:203], v[200:201]
    v_pk_fma_f32 v[214:215], v[214:215], v[202:203], v[200:201]
    v_pk_fma_f32 v[216:217], v[216:217], v[202:203], v[200:201]
    v_pk_mul_f32 v[206:207], v[206:207], v[176:177]
    v_pk_mul_f32 v[208:209], v[208:209], v[178:179]
    v_pk_mul_f32 v[210:211], v[210:211], v[180:181]
    v_pk_mul_f32 v[212:213], v[212:213], v[182:183]
    v_pk_mul_f32 v[214:215], v[214:215], v[184:185]
    v_pk_mul_f32 v[216:217], v[216:217], v[186:187]
    v_exp_f32 v206, v206
    s_mov_b32 s12, s88
    s_and_b32 s13, s89, 0xffff
    s_mov_b32 s14, 1152
    s_mov_b32 s15, 0x00020000
    s_lshl_b32 s44, s70, 1
    v_mov_b32 v252, s44
    buffer_load_ushort v248, v252, s[12:15], 0 offen
    v_exp_f32 v208, v208
    v_exp_f32 v210, v210
    v_exp_f32 v212, v212
    v_exp_f32 v214, v214
    v_exp_f32 v216, v216
    v_exp_f32 v207, v207
    v_exp_f32 v209, v209
    v_exp_f32 v211, v211
    v_exp_f32 v213, v213
    v_exp_f32 v215, v215
    v_exp_f32 v217, v217
    v_pk_add_f32 v[206:207], v[206:207], v[204:205]
    v_pk_add_f32 v[208:209], v[208:209], v[204:205]
    v_pk_add_f32 v[210:211], v[210:211], v[204:205]
    v_pk_add_f32 v[212:213], v[212:213], v[204:205]
    v_pk_add_f32 v[214:215], v[214:215], v[204:205]
    v_pk_add_f32 v[216:217], v[216:217], v[204:205]
    v_rcp_f32 v206, v206
    v_rcp_f32 v208, v208
    v_rcp_f32 v210, v210
    v_rcp_f32 v212, v212
    v_rcp_f32 v214, v214
    v_rcp_f32 v216, v216
    buffer_store_dwordx4 a[216:219], v14, s[60:63], s41 offen offset:0 sc1
    v_rcp_f32 v207, v207
    v_rcp_f32 v209, v209
    v_rcp_f32 v211, v211
    v_rcp_f32 v213, v213
    v_rcp_f32 v215, v215
    v_rcp_f32 v217, v217
    v_pk_mul_f32 v[176:177], v[176:177], v[206:207]
    v_pk_mul_f32 v[178:179], v[178:179], v[208:209]
    v_pk_mul_f32 v[180:181], v[180:181], v[210:211]
    v_pk_mul_f32 v[182:183], v[182:183], v[212:213]
    v_pk_mul_f32 v[184:185], v[184:185], v[214:215]
    v_pk_mul_f32 v[186:187], v[186:187], v[216:217]
    v_pk_add_f32 v[222:223], v[222:223], v[176:177]
    v_pk_fma_f32 v[230:231], v[176:177], v[176:177], v[230:231]
    v_pk_add_f32 v[224:225], v[224:225], v[178:179]
    v_pk_fma_f32 v[232:233], v[178:179], v[178:179], v[232:233]
    v_pk_add_f32 v[222:223], v[222:223], v[180:181]
    v_pk_fma_f32 v[230:231], v[180:181], v[180:181], v[230:231]
    v_pk_add_f32 v[224:225], v[224:225], v[182:183]
    v_pk_fma_f32 v[232:233], v[182:183], v[182:183], v[232:233]
    v_pk_add_f32 v[222:223], v[222:223], v[184:185]
    v_pk_fma_f32 v[230:231], v[184:185], v[184:185], v[230:231]
    v_pk_add_f32 v[224:225], v[224:225], v[186:187]
    buffer_store_dwordx4 a[220:223], v14, s[60:63], s41 offen offset:1024 sc1
    v_pk_fma_f32 v[232:233], v[186:187], v[186:187], v[232:233]
    v_pk_mul_f32 v[206:207], v[188:189], v[188:189]
    v_pk_mul_f32 v[208:209], v[190:191], v[190:191]
    v_pk_mul_f32 v[210:211], v[192:193], v[192:193]
    v_pk_mul_f32 v[212:213], v[194:195], v[194:195]
    v_pk_mul_f32 v[214:215], v[196:197], v[196:197]
    v_pk_mul_f32 v[216:217], v[198:199], v[198:199]
    v_pk_fma_f32 v[206:207], v[206:207], v[202:203], v[200:201]
    v_pk_fma_f32 v[208:209], v[208:209], v[202:203], v[200:201]
    v_pk_fma_f32 v[210:211], v[210:211], v[202:203], v[200:201]
    v_pk_fma_f32 v[212:213], v[212:213], v[202:203], v[200:201]
    v_pk_fma_f32 v[214:215], v[214:215], v[202:203], v[200:201]
    v_pk_fma_f32 v[216:217], v[216:217], v[202:203], v[200:201]
    v_pk_mul_f32 v[206:207], v[206:207], v[188:189]
    v_pk_mul_f32 v[208:209], v[208:209], v[190:191]
    v_pk_mul_f32 v[210:211], v[210:211], v[192:193]
    v_pk_mul_f32 v[212:213], v[212:213], v[194:195]
    v_pk_mul_f32 v[214:215], v[214:215], v[196:197]
    v_pk_mul_f32 v[216:217], v[216:217], v[198:199]
    v_exp_f32 v206, v206
    v_exp_f32 v208, v208
    v_exp_f32 v210, v210
    v_exp_f32 v212, v212
    buffer_store_dwordx4 a[224:227], v14, s[60:63], s41 offen offset:2048 sc1
    v_exp_f32 v214, v214
    v_exp_f32 v216, v216
    v_exp_f32 v207, v207
    v_exp_f32 v209, v209
    v_exp_f32 v211, v211
    v_exp_f32 v213, v213
    v_exp_f32 v215, v215
    v_exp_f32 v217, v217
    v_pk_add_f32 v[206:207], v[206:207], v[204:205]
    v_pk_add_f32 v[208:209], v[208:209], v[204:205]
    v_pk_add_f32 v[210:211], v[210:211], v[204:205]
    v_pk_add_f32 v[212:213], v[212:213], v[204:205]
    v_pk_add_f32 v[214:215], v[214:215], v[204:205]
    v_pk_add_f32 v[216:217], v[216:217], v[204:205]
    v_rcp_f32 v206, v206
    v_rcp_f32 v208, v208
    v_rcp_f32 v210, v210
    v_rcp_f32 v212, v212
    v_rcp_f32 v214, v214
    v_rcp_f32 v216, v216
    v_rcp_f32 v207, v207
    v_rcp_f32 v209, v209
    v_rcp_f32 v211, v211
    buffer_store_dwordx4 a[228:231], v14, s[60:63], s41 offen offset:3072 sc1
    v_rcp_f32 v213, v213
    v_rcp_f32 v215, v215
    v_rcp_f32 v217, v217
    v_pk_mul_f32 v[188:189], v[188:189], v[206:207]
    v_pk_mul_f32 v[190:191], v[190:191], v[208:209]
    v_pk_mul_f32 v[192:193], v[192:193], v[210:211]
    v_pk_mul_f32 v[194:195], v[194:195], v[212:213]
    v_pk_mul_f32 v[196:197], v[196:197], v[214:215]
    v_pk_mul_f32 v[198:199], v[198:199], v[216:217]
    v_pk_add_f32 v[222:223], v[222:223], v[188:189]
    v_pk_fma_f32 v[230:231], v[188:189], v[188:189], v[230:231]
    v_pk_add_f32 v[224:225], v[224:225], v[190:191]
    v_pk_fma_f32 v[232:233], v[190:191], v[190:191], v[232:233]
    v_pk_add_f32 v[222:223], v[222:223], v[192:193]
    v_pk_fma_f32 v[230:231], v[192:193], v[192:193], v[230:231]
    v_pk_add_f32 v[224:225], v[224:225], v[194:195]
    v_pk_fma_f32 v[232:233], v[194:195], v[194:195], v[232:233]
    v_pk_add_f32 v[222:223], v[222:223], v[196:197]
    v_pk_fma_f32 v[230:231], v[196:197], v[196:197], v[230:231]
    v_pk_add_f32 v[224:225], v[224:225], v[198:199]
    v_pk_fma_f32 v[232:233], v[198:199], v[198:199], v[232:233]
    v_add_f32_dpp v218, v218, v218 row_ror:8 row_mask:0xf bank_mask:0xf
    v_add_f32_dpp v219, v219, v219 row_ror:8 row_mask:0xf bank_mask:0xf
    buffer_store_dwordx4 a[232:235], v14, s[60:63], s42 offen offset:0 sc1
    v_add_f32_dpp v220, v220, v220 row_ror:8 row_mask:0xf bank_mask:0xf
    v_add_f32_dpp v221, v221, v221 row_ror:8 row_mask:0xf bank_mask:0xf
    v_add_f32_dpp v222, v222, v222 row_ror:8 row_mask:0xf bank_mask:0xf
    v_add_f32_dpp v223, v223, v223 row_ror:8 row_mask:0xf bank_mask:0xf
    v_add_f32_dpp v224, v224, v224 row_ror:8 row_mask:0xf bank_mask:0xf
    v_add_f32_dpp v225, v225, v225 row_ror:8 row_mask:0xf bank_mask:0xf
    v_add_f32_dpp v226, v226, v226 row_ror:8 row_mask:0xf bank_mask:0xf
    v_add_f32_dpp v227, v227, v227 row_ror:8 row_mask:0xf bank_mask:0xf
    v_add_f32_dpp v228, v228, v228 row_ror:8 row_mask:0xf bank_mask:0xf
    v_add_f32_dpp v229, v229, v229 row_ror:8 row_mask:0xf bank_mask:0xf
    v_add_f32_dpp v230, v230, v230 row_ror:8 row_mask:0xf bank_mask:0xf
    v_add_f32_dpp v231, v231, v231 row_ror:8 row_mask:0xf bank_mask:0xf
    v_add_f32_dpp v232, v232, v232 row_ror:8 row_mask:0xf bank_mask:0xf
    v_add_f32_dpp v233, v233, v233 row_ror:8 row_mask:0xf bank_mask:0xf
    v_add_f32_dpp v218, v218, v218 row_ror:4 row_mask:0xf bank_mask:0xf
    v_add_f32_dpp v219, v219, v219 row_ror:4 row_mask:0xf bank_mask:0xf
    v_add_f32_dpp v220, v220, v220 row_ror:4 row_mask:0xf bank_mask:0xf
    v_add_f32_dpp v221, v221, v221 row_ror:4 row_mask:0xf bank_mask:0xf
    v_add_f32_dpp v222, v222, v222 row_ror:4 row_mask:0xf bank_mask:0xf
    v_add_f32_dpp v223, v223, v223 row_ror:4 row_mask:0xf bank_mask:0xf
    v_add_f32_dpp v224, v224, v224 row_ror:4 row_mask:0xf bank_mask:0xf
    v_add_f32_dpp v225, v225, v225 row_ror:4 row_mask:0xf bank_mask:0xf
    v_add_f32_dpp v226, v226, v226 row_ror:4 row_mask:0xf bank_mask:0xf
    buffer_store_dwordx4 a[236:239], v14, s[60:63], s42 offen offset:1024 sc1
    v_add_f32_dpp v227, v227, v227 row_ror:4 row_mask:0xf bank_mask:0xf
    v_add_f32_dpp v228, v228, v228 row_ror:4 row_mask:0xf bank_mask:0xf
    v_add_f32_dpp v229, v229, v229 row_ror:4 row_mask:0xf bank_mask:0xf
    v_add_f32_dpp v230, v230, v230 row_ror:4 row_mask:0xf bank_mask:0xf
    v_add_f32_dpp v231, v231, v231 row_ror:4 row_mask:0xf bank_mask:0xf
    v_add_f32_dpp v232, v232, v232 row_ror:4 row_mask:0xf bank_mask:0xf
    v_add_f32_dpp v233, v233, v233 row_ror:4 row_mask:0xf bank_mask:0xf
    v_add_f32_dpp v218, v218, v218 row_ror:2 row_mask:0xf bank_mask:0xf
    v_add_f32_dpp v219, v219, v219 row_ror:2 row_mask:0xf bank_mask:0xf
    v_add_f32_dpp v220, v220, v220 row_ror:2 row_mask:0xf bank_mask:0xf
    v_add_f32_dpp v221, v221, v221 row_ror:2 row_mask:0xf bank_mask:0xf
    v_add_f32_dpp v222, v222, v222 row_ror:2 row_mask:0xf bank_mask:0xf
    v_add_f32_dpp v223, v223, v223 row_ror:2 row_mask:0xf bank_mask:0xf
    v_add_f32_dpp v224, v224, v224 row_ror:2 row_mask:0xf bank_mask:0xf
    v_add_f32_dpp v225, v225, v225 row_ror:2 row_mask:0xf bank_mask:0xf
    v_add_f32_dpp v226, v226, v226 row_ror:2 row_mask:0xf bank_mask:0xf
    v_add_f32_dpp v227, v227, v227 row_ror:2 row_mask:0xf bank_mask:0xf
    v_add_f32_dpp v228, v228, v228 row_ror:2 row_mask:0xf bank_mask:0xf
    v_add_f32_dpp v229, v229, v229 row_ror:2 row_mask:0xf bank_mask:0xf
    v_add_f32_dpp v230, v230, v230 row_ror:2 row_mask:0xf bank_mask:0xf
    v_add_f32_dpp v231, v231, v231 row_ror:2 row_mask:0xf bank_mask:0xf
    v_add_f32_dpp v232, v232, v232 row_ror:2 row_mask:0xf bank_mask:0xf
    v_add_f32_dpp v233, v233, v233 row_ror:2 row_mask:0xf bank_mask:0xf
    buffer_store_dwordx4 a[240:243], v14, s[60:63], s42 offen offset:2048 sc1
    v_add_f32_dpp v218, v218, v218 row_ror:1 row_mask:0xf bank_mask:0xf
    v_add_f32_dpp v219, v219, v219 row_ror:1 row_mask:0xf bank_mask:0xf
    v_add_f32_dpp v220, v220, v220 row_ror:1 row_mask:0xf bank_mask:0xf
    v_add_f32_dpp v221, v221, v221 row_ror:1 row_mask:0xf bank_mask:0xf
    v_add_f32_dpp v222, v222, v222 row_ror:1 row_mask:0xf bank_mask:0xf
    v_add_f32_dpp v223, v223, v223 row_ror:1 row_mask:0xf bank_mask:0xf
    v_add_f32_dpp v224, v224, v224 row_ror:1 row_mask:0xf bank_mask:0xf
    v_add_f32_dpp v225, v225, v225 row_ror:1 row_mask:0xf bank_mask:0xf
    v_add_f32_dpp v226, v226, v226 row_ror:1 row_mask:0xf bank_mask:0xf
    v_add_f32_dpp v227, v227, v227 row_ror:1 row_mask:0xf bank_mask:0xf
    v_add_f32_dpp v228, v228, v228 row_ror:1 row_mask:0xf bank_mask:0xf
    v_add_f32_dpp v229, v229, v229 row_ror:1 row_mask:0xf bank_mask:0xf
    v_add_f32_dpp v230, v230, v230 row_ror:1 row_mask:0xf bank_mask:0xf
    v_add_f32_dpp v231, v231, v231 row_ror:1 row_mask:0xf bank_mask:0xf
    v_add_f32_dpp v232, v232, v232 row_ror:1 row_mask:0xf bank_mask:0xf
    v_add_f32_dpp v233, v233, v233 row_ror:1 row_mask:0xf bank_mask:0xf
    v_mov_b32 v88, v218
    v_max_f32 v89, 0, v226
    v_mov_b32 v90, v219
    v_max_f32 v91, 0, v227
    v_mov_b32 v92, v220
    v_max_f32 v93, 0, v228
    v_mov_b32 v94, v221
    buffer_store_dwordx4 a[244:247], v14, s[60:63], s42 offen offset:3072 sc1
    v_max_f32 v95, 0, v229
    v_mov_b32 v96, v222
    v_max_f32 v97, 0, v230
    v_mov_b32 v98, v223
    v_max_f32 v99, 0, v231
    v_mov_b32 v100, v224
    v_max_f32 v101, 0, v232
    v_mov_b32 v102, v225
    v_max_f32 v103, 0, v233
    s_lshl_b32 s44, s34, 4
    s_add_u32 s44, s44, s35
    s_lshl_b32 s44, s44, 11
    s_lshl_b32 s45, s36, 9
    s_lshr_b32 s44, s44, 1
    s_lshr_b32 s45, s45, 1
    s_add_u32 s44, s44, s45
    v_lshrrev_b32 v1, 4, v15
    v_lshlrev_b32 v1, 5, v1
    v_and_b32 v206, 15, v15

    v_cmp_eq_u32 vcc, 0, v206
    s_and_saveexec_b64 s[52:53], vcc
    buffer_store_dwordx4 v[88:91], v1, s[20:23], s44 offen offset:0 sc1
    buffer_store_dwordx4 v[92:95], v1, s[20:23], s44 offen offset:16 sc1
    buffer_store_dwordx4 v[96:99], v1, s[20:23], s44 offen offset:128 sc1
    buffer_store_dwordx4 v[100:103], v1, s[20:23], s44 offen offset:144 sc1
    s_mov_b64 exec, s[52:53]
    s_mov_b32 s61, -1
    s_mov_b32 s62, -1
    s_mov_b32 s60, 0
    s_waitcnt vmcnt(12)
    s_getpc_b64 s[30:31]
m_kernel_pc_3:
    s_add_u32 s30, s30, m_kernel_r1_1-m_kernel_pc_3
    s_addc_u32 s31, s31, 0
m_kernel_subC:
    v_and_b32 v16, 15, v15
    v_sub_u32 v17, 0, v16
    v_and_b32 v17, 7, v17
    v_mul_u32_u24 v18, 320, v17
    v_lshrrev_b32 v19, 1, v17
    v_lshlrev_b32 v19, 2, v19
    v_and_b32 v20, 1, v17
    v_add_u32 v19, v19, v20
    v_cmp_le_u32 vcc, 5, v17
    v_add_u32 v18, v18, v19
    s_nop 0
    v_cndmask_b32 v20, 0, 1, vcc
    v_sub_u32 v18, v18, v20
    v_lshrrev_b32 v19, 4, v15
    v_add_u32 v18, v18, v19
    v_add_u32 v19, 7, v16
    v_lshrrev_b32 v19, 3, v19
    v_sub_u32 v18, v18, v19
    v_lshlrev_b32 v18, 4, v18
    v_add_u32 v236, 110624, v18
    s_nop 0
    v_mul_u32_u24 v18, 160, v16
    v_lshrrev_b32 v19, 4, v15
    v_lshlrev_b32 v19, 4, v19
    v_add_u32 v237, v18, v19
    s_cmp_eq_u32 s36, 0
    s_cselect_b32 s50, 0, 24
    s_cselect_b32 s51, 6, 2
    s_cselect_b32 s54, 0, 2
    s_cmp_ge_u32 s36, 2
    s_cselect_b32 s51, 0, s51
    s_cselect_b32 s54, 3, s54
    s_cmp_eq_u32 s36, 2
    s_cselect_b32 s50, 40, s50
    s_cmp_eq_u32 s36, 3
    s_cselect_b32 s50, 52, s50
    s_lshl_b32 s50, s36, 3
    s_lshl_b32 s44, s50, 6
    v_add_u32 v234, s44, v236
    s_lshr_b32 s44, s50, 1
    s_mul_i32 s44, s44, 160
    s_add_u32 s44, s44, 151808
    s_nop 0
    v_add_u32 v235, s44, v237
    v_subrev_u32 v238, 2560, v235

    v_mov_b32 v96, 0
    v_mov_b32 v97, 0
    v_mov_b32 v98, 0
    v_mov_b32 v99, 0
    v_mov_b32 v100, 0
    v_mov_b32 v101, 0
    v_mov_b32 v102, 0
    v_mov_b32 v103, 0
    v_mov_b32 v104, 0
    v_mov_b32 v105, 0
    v_mov_b32 v106, 0
    v_mov_b32 v107, 0
    v_mov_b32 v108, 0
    v_mov_b32 v109, 0
    v_mov_b32 v110, 0
    v_mov_b32 v111, 0
    v_mov_b32 v112, 0
    v_mov_b32 v113, 0
    v_mov_b32 v114, 0
    v_mov_b32 v115, 0
    v_mov_b32 v116, 0
    v_mov_b32 v117, 0
    v_mov_b32 v118, 0
    v_mov_b32 v119, 0
    v_mov_b32 v120, 0
    v_mov_b32 v121, 0
    v_mov_b32 v122, 0
    v_mov_b32 v123, 0
    v_mov_b32 v124, 0
    v_mov_b32 v125, 0
    v_mov_b32 v126, 0
    v_mov_b32 v127, 0
    s_barrier
    ds_read_b128 v[48:51], v234 offset:32
    ds_read_b128 v[52:55], v234 offset:0
    ds_read_b128 v[24:27], v234 offset:96
    ds_read_b128 v[28:31], v234 offset:64
    ds_read_b128 v[56:59], v235 offset:0
    ds_read_b128 v[32:35], v234 offset:160
    ds_read_b128 v[36:39], v234 offset:128
    ds_read_b128 v[64:67], v235 offset:64
    s_waitcnt lgkmcnt(0)
    s_mov_b32 s55, 2
m_kernel_cv_s_5:
    s_waitcnt lgkmcnt(3)
    v_mfma_f32_16x16x32_bf16 v[100:103], v[24:27], v[56:59], v[100:103]
    ds_read_b128 v[40:43], v234 offset:224
    v_mfma_f32_16x16x32_bf16 v[108:111], v[28:31], v[56:59], v[108:111]
    ds_read_b128 v[44:47], v234 offset:192
    v_mfma_f32_16x16x32_bf16 v[116:119], v[48:51], v[56:59], v[116:119]
    ds_read_b128 v[72:75], v235 offset:160
    v_mfma_f32_16x16x32_bf16 v[124:127], v[52:55], v[56:59], v[124:127]
    s_waitcnt lgkmcnt(3)
    v_mfma_f32_16x16x32_bf16 v[100:103], v[32:35], v[64:67], v[100:103]
    ds_read_b128 v[48:51], v234 offset:288
    v_mfma_f32_16x16x32_bf16 v[108:111], v[36:39], v[64:67], v[108:111]
    ds_read_b128 v[52:55], v234 offset:256
    v_mfma_f32_16x16x32_bf16 v[116:119], v[24:27], v[64:67], v[116:119]
    ds_read_b128 v[80:83], v235 offset:224
    v_mfma_f32_16x16x32_bf16 v[124:127], v[28:31], v[64:67], v[124:127]
    s_waitcnt lgkmcnt(3)
    v_mfma_f32_16x16x32_bf16 v[100:103], v[40:43], v[72:75], v[100:103]
    ds_read_b128 v[24:27], v234 offset:352
    v_mfma_f32_16x16x32_bf16 v[108:111], v[44:47], v[72:75], v[108:111]
    ds_read_b128 v[28:31], v234 offset:320
    v_mfma_f32_16x16x32_bf16 v[116:119], v[32:35], v[72:75], v[116:119]
    ds_read_b128 v[56:59], v235 offset:320
    v_mfma_f32_16x16x32_bf16 v[124:127], v[36:39], v[72:75], v[124:127]
    s_waitcnt lgkmcnt(3)
    v_mfma_f32_16x16x32_bf16 v[100:103], v[48:51], v[80:83], v[100:103]
    ds_read_b128 v[32:35], v234 offset:416
    v_mfma_f32_16x16x32_bf16 v[108:111], v[52:55], v[80:83], v[108:111]
    ds_read_b128 v[36:39], v234 offset:384
    v_mfma_f32_16x16x32_bf16 v[116:119], v[40:43], v[80:83], v[116:119]
    ds_read_b128 v[64:67], v235 offset:384
    v_mfma_f32_16x16x32_bf16 v[124:127], v[44:47], v[80:83], v[124:127]
    v_add_u32 v234, 256, v234
    v_add_u32 v235, 320, v235
    v_add_u32 v238, 320, v238
    s_sub_u32 s55, s55, 1
    s_cmp_lg_u32 s55, 0
    s_cbranch_scc1 m_kernel_cv_s_5
    s_waitcnt lgkmcnt(0)
    v_add_u32 v234, 1536, v234
    v_add_u32 v235, 1920, v235
    v_subrev_u32 v238, 2560, v235
    ds_read_b128 v[48:51], v234 offset:32
    ds_read_b128 v[52:55], v234 offset:0
    ds_read_b128 v[24:27], v234 offset:96
    ds_read_b128 v[28:31], v234 offset:64
    ds_read_b128 v[56:59], v235 offset:0
    ds_read_b128 v[60:63], v238 offset:0
    ds_read_b128 v[32:35], v234 offset:160
    ds_read_b128 v[36:39], v234 offset:128
    ds_read_b128 v[64:67], v235 offset:64
    ds_read_b128 v[68:71], v238 offset:64
    s_waitcnt lgkmcnt(0)
    s_mov_b32 s55, 2
m_kernel_cv_d_7:
    s_waitcnt lgkmcnt(4)
    v_mfma_f32_16x16x32_bf16 v[100:103], v[24:27], v[56:59], v[100:103]
    ds_read_b128 v[40:43], v234 offset:224
    v_mfma_f32_16x16x32_bf16 v[108:111], v[28:31], v[56:59], v[108:111]
    ds_read_b128 v[44:47], v234 offset:192
    v_mfma_f32_16x16x32_bf16 v[116:119], v[48:51], v[56:59], v[116:119]
    ds_read_b128 v[72:75], v235 offset:160
    v_mfma_f32_16x16x32_bf16 v[124:127], v[52:55], v[56:59], v[124:127]
    ds_read_b128 v[76:79], v238 offset:160
    v_mfma_f32_16x16x32_bf16 v[96:99], v[24:27], v[60:63], v[96:99]
    v_mfma_f32_16x16x32_bf16 v[104:107], v[28:31], v[60:63], v[104:107]
    v_mfma_f32_16x16x32_bf16 v[112:115], v[48:51], v[60:63], v[112:115]
    v_mfma_f32_16x16x32_bf16 v[120:123], v[52:55], v[60:63], v[120:123]
    s_waitcnt lgkmcnt(4)
    v_mfma_f32_16x16x32_bf16 v[100:103], v[32:35], v[64:67], v[100:103]
    ds_read_b128 v[48:51], v234 offset:288
    v_mfma_f32_16x16x32_bf16 v[108:111], v[36:39], v[64:67], v[108:111]
    ds_read_b128 v[52:55], v234 offset:256
    v_mfma_f32_16x16x32_bf16 v[116:119], v[24:27], v[64:67], v[116:119]
    ds_read_b128 v[80:83], v235 offset:224
    v_mfma_f32_16x16x32_bf16 v[124:127], v[28:31], v[64:67], v[124:127]
    ds_read_b128 v[84:87], v238 offset:224
    v_mfma_f32_16x16x32_bf16 v[96:99], v[32:35], v[68:71], v[96:99]
    v_mfma_f32_16x16x32_bf16 v[104:107], v[36:39], v[68:71], v[104:107]
    v_mfma_f32_16x16x32_bf16 v[112:115], v[24:27], v[68:71], v[112:115]
    v_mfma_f32_16x16x32_bf16 v[120:123], v[28:31], v[68:71], v[120:123]
    s_waitcnt lgkmcnt(4)
    v_mfma_f32_16x16x32_bf16 v[100:103], v[40:43], v[72:75], v[100:103]
    ds_read_b128 v[24:27], v234 offset:352
    v_mfma_f32_16x16x32_bf16 v[108:111], v[44:47], v[72:75], v[108:111]
    ds_read_b128 v[28:31], v234 offset:320
    v_mfma_f32_16x16x32_bf16 v[116:119], v[32:35], v[72:75], v[116:119]
    ds_read_b128 v[56:59], v235 offset:320
    v_mfma_f32_16x16x32_bf16 v[124:127], v[36:39], v[72:75], v[124:127]
    ds_read_b128 v[60:63], v238 offset:320
    v_mfma_f32_16x16x32_bf16 v[96:99], v[40:43], v[76:79], v[96:99]
    v_mfma_f32_16x16x32_bf16 v[104:107], v[44:47], v[76:79], v[104:107]
    v_mfma_f32_16x16x32_bf16 v[112:115], v[32:35], v[76:79], v[112:115]
    v_mfma_f32_16x16x32_bf16 v[120:123], v[36:39], v[76:79], v[120:123]
    s_waitcnt lgkmcnt(4)
    v_mfma_f32_16x16x32_bf16 v[100:103], v[48:51], v[80:83], v[100:103]
    ds_read_b128 v[32:35], v234 offset:416
    v_mfma_f32_16x16x32_bf16 v[108:111], v[52:55], v[80:83], v[108:111]
    ds_read_b128 v[36:39], v234 offset:384
    v_mfma_f32_16x16x32_bf16 v[116:119], v[40:43], v[80:83], v[116:119]
    ds_read_b128 v[64:67], v235 offset:384
    v_mfma_f32_16x16x32_bf16 v[124:127], v[44:47], v[80:83], v[124:127]
    ds_read_b128 v[68:71], v238 offset:384
    v_mfma_f32_16x16x32_bf16 v[96:99], v[48:51], v[84:87], v[96:99]
    v_mfma_f32_16x16x32_bf16 v[104:107], v[52:55], v[84:87], v[104:107]
    v_mfma_f32_16x16x32_bf16 v[112:115], v[40:43], v[84:87], v[112:115]
    v_mfma_f32_16x16x32_bf16 v[120:123], v[44:47], v[84:87], v[120:123]
    v_add_u32 v234, 256, v234
    v_add_u32 v235, 320, v235
    v_add_u32 v238, 320, v238
    s_sub_u32 s55, s55, 1
    s_cmp_lg_u32 s55, 0
    s_cbranch_scc1 m_kernel_cv_d_7
m_kernel_cv_de_8:
    s_waitcnt vmcnt(0) lgkmcnt(0)
    s_nop 7
    s_barrier
    s_cmp_eq_u32 s36, 0
    s_cbranch_scc0 m_kernel_ms_10
    s_add_u32 s24, s32, 49283072
    s_addc_u32 s25, s33, 0
    s_and_b32 s25, s25, 0xffff
    s_mov_b32 s26, 524288
    s_mov_b32 s27, 0x00020000
    v_mov_b32 v251, 1
    s_mov_b64 exec, 1
    s_cmp_eq_u32 s61, -1
    s_cbranch_scc1 m_kernel_mk_11
    v_mov_b32 v250, s61
    buffer_store_dword v251, v250, s[24:27], 0 offen sc1
m_kernel_mk_11:
    s_cmp_eq_u32 s62, -1
    s_cbranch_scc1 m_kernel_mk_12
    v_mov_b32 v250, s62
    buffer_store_dword v251, v250, s[24:27], 0 offen sc1
m_kernel_mk_12:
    s_mov_b64 exec, -1
m_kernel_ms_10:
    s_setpc_b64 s[30:31]
m_kernel_r1_1:
    s_getpc_b64 s[30:31]
m_kernel_pc_13:
    s_add_u32 s30, s30, m_kernel_r2_2-m_kernel_pc_13
    s_addc_u32 s31, s31, 0
m_kernel_subF:
    v_lshlrev_b32 v244, 4, v15
    s_lshl_b32 s44, s36, 13
    s_add_u32 s44, s44, 110592
    v_add_u32 v240, s44, v244
    ds_write_b128 v240, v[96:99] offset:0
    ds_write_b128 v240, v[100:103] offset:1024
    ds_write_b128 v240, v[104:107] offset:2048
    ds_write_b128 v240, v[108:111] offset:3072
    ds_write_b128 v240, v[112:115] offset:4096
    ds_write_b128 v240, v[116:119] offset:5120
    ds_write_b128 v240, v[120:123] offset:6144
    ds_write_b128 v240, v[124:127] offset:7168
    v_and_b32 v241, 15, v15
    v_mul_u32_u24 v241, 160, v241
    v_lshrrev_b32 v242, 4, v15
    v_lshlrev_b32 v242, 3, v242
    v_add_u32 v241, v241, v242
    s_lshl_b32 s44, s36, 5
    s_add_u32 s44, s44, 151808
    s_nop 0
    v_add_u32 v241, s44, v241

    ds_read_b64 v[56:57], v241 offset:2400
    ds_read_b64 v[58:59], v241 offset:4960
    s_waitcnt lgkmcnt(0)
    s_barrier
    s_lshl_b32 s44, s36, 11
    s_add_u32 s44, s44, 110592
    v_add_u32 v240, s44, v244
    ds_read_b128 v[24:27], v240 offset:0
    ds_read_b128 v[28:31], v240 offset:1024
    ds_read_b128 v[32:35], v240 offset:8192
    ds_read_b128 v[36:39], v240 offset:9216
    ds_read_b128 v[40:43], v240 offset:16384
    ds_read_b128 v[44:47], v240 offset:17408
    ds_read_b128 v[48:51], v240 offset:24576
    ds_read_b128 v[52:55], v240 offset:25600
    v_mov_b32 v243, v248
    s_nop 0
    v_lshlrev_b32 v243, 16, v243
    v_lshlrev_b32 v64, 16, v56
    v_and_b32 v65, 0xffff0000, v56
    v_lshlrev_b32 v66, 16, v57
    v_and_b32 v67, 0xffff0000, v57
    v_mul_f32 v64, v64, v243
    v_mul_f32 v65, v65, v243
    v_mul_f32 v66, v66, v243
    v_mul_f32 v67, v67, v243
    v_cvt_pk_bf16_f32 v60, v64, v65
    v_cvt_pk_bf16_f32 v61, v66, v67
    v_lshlrev_b32 v64, 16, v60
    v_and_b32 v65, 0xffff0000, v60
    v_lshlrev_b32 v66, 16, v61
    v_and_b32 v67, 0xffff0000, v61
    v_lshlrev_b32 v68, 16, v58
    v_and_b32 v69, 0xffff0000, v58
    v_lshlrev_b32 v70, 16, v59
    v_and_b32 v71, 0xffff0000, v59
    v_mul_f32 v68, v68, v243
    v_mul_f32 v69, v69, v243
    v_mul_f32 v70, v70, v243
    v_mul_f32 v71, v71, v243
    v_cvt_pk_bf16_f32 v60, v68, v69
    v_cvt_pk_bf16_f32 v61, v70, v71
    v_lshlrev_b32 v68, 16, v60
    v_and_b32 v69, 0xffff0000, v60
    v_lshlrev_b32 v70, 16, v61
    v_and_b32 v71, 0xffff0000, v61
    s_waitcnt lgkmcnt(0)
    v_pk_add_f32 v[24:25], v[24:25], v[32:33]
    v_pk_add_f32 v[26:27], v[26:27], v[34:35]
    v_pk_add_f32 v[24:25], v[24:25], v[40:41]
    v_pk_add_f32 v[26:27], v[26:27], v[42:43]
    v_pk_add_f32 v[24:25], v[24:25], v[48:49]
    v_pk_add_f32 v[26:27], v[26:27], v[50:51]
    v_pk_add_f32 v[28:29], v[28:29], v[36:37]
    v_pk_add_f32 v[30:31], v[30:31], v[38:39]
    v_pk_add_f32 v[28:29], v[28:29], v[44:45]
    v_pk_add_f32 v[30:31], v[30:31], v[46:47]
    v_pk_add_f32 v[28:29], v[28:29], v[52:53]
    v_pk_add_f32 v[30:31], v[30:31], v[54:55]
    v_cvt_pk_bf16_f32 v60, v24, v25
    v_cvt_pk_bf16_f32 v61, v26, v27
    v_lshlrev_b32 v24, 16, v60
    v_and_b32 v25, 0xffff0000, v60
    v_lshlrev_b32 v26, 16, v61
    v_and_b32 v27, 0xffff0000, v61
    v_add_f32 v24, v24, v64
    v_add_f32 v25, v25, v65
    v_add_f32 v26, v26, v66
    v_add_f32 v27, v27, v67
    v_cvt_pk_bf16_f32 v60, v24, v25
    v_cvt_pk_bf16_f32 v61, v26, v27
    v_mov_b32 v80, v60
    v_mov_b32 v81, v61
    v_cvt_pk_bf16_f32 v60, v28, v29
    v_cvt_pk_bf16_f32 v61, v30, v31
    v_lshlrev_b32 v28, 16, v60
    v_and_b32 v29, 0xffff0000, v60
    v_lshlrev_b32 v30, 16, v61
    v_and_b32 v31, 0xffff0000, v61
    v_add_f32 v28, v28, v68
    v_add_f32 v29, v29, v69
    v_add_f32 v30, v30, v70
    v_add_f32 v31, v31, v71
    v_cvt_pk_bf16_f32 v60, v28, v29
    v_cvt_pk_bf16_f32 v61, v30, v31
    v_mov_b32 v82, v60
    v_mov_b32 v83, v61
    s_cmp_eq_u32 s60, 1
    s_cbranch_scc1 m_kernel_cv_2nd_14
    v_accvgpr_write_b32 a252, v80
    v_accvgpr_write_b32 a253, v81
    v_accvgpr_write_b32 a254, v82
    v_accvgpr_write_b32 a255, v83
    s_branch m_kernel_cv_ce_15
m_kernel_cv_2nd_14:
    s_mov_b32 s44, 0x05040100
    s_mov_b32 s45, 0x07060302
    v_accvgpr_read_b32 v62, a252
    v_accvgpr_read_b32 v63, a253
    s_nop 0
    v_perm_b32 v72, v80, v62, s44
    v_perm_b32 v73, v80, v62, s45
    v_perm_b32 v74, v81, v63, s44
    v_perm_b32 v75, v81, v63, s45
    v_accvgpr_read_b32 v62, a254
    v_accvgpr_read_b32 v63, a255
    s_nop 0
    v_perm_b32 v76, v82, v62, s44
    v_perm_b32 v77, v82, v62, s45
    v_perm_b32 v78, v83, v63, s44
    v_perm_b32 v79, v83, v63, s45
    s_add_u32 s12, s32, 46137344
    s_addc_u32 s13, s33, 0
    s_and_b32 s13, s13, 0xffff
    s_mov_b32 s14, 2359296
    s_mov_b32 s15, 0x00020000
    v_and_b32 v241, 15, v15
    v_lshlrev_b32 v241, 8, v241
    v_lshrrev_b32 v242, 4, v15
    v_lshlrev_b32 v242, 4, v242
    v_add_u32 v241, v241, v242
    s_lshl_b32 s44, s72, 13
    s_lshl_b32 s45, s36, 6
    s_add_u32 s44, s44, s45
    s_add_u32 s45, s44, 4096

    buffer_store_dwordx4 v[72:75], v241, s[12:15], s44 offen sc1
    buffer_store_dwordx4 v[76:79], v241, s[12:15], s45 offen sc1
m_kernel_cv_ce_15:
    s_setpc_b64 s[30:31]
m_kernel_r2_2:
    s_mov_b32 s4, s78
    s_and_b32 s5, s79, 0xffff
    s_mov_b32 s6, 5308416
    s_mov_b32 s7, 0x00020000
    s_add_u32 s16, s32, 18874368
    s_addc_u32 s17, s33, 0
    s_and_b32 s17, s17, 0xffff
    s_mov_b32 s18, 9437184
    s_mov_b32 s19, 0x00020000
    s_add_u32 s20, s32, 48234496
    s_addc_u32 s21, s33, 0
    s_and_b32 s21, s21, 0xffff
    s_mov_b32 s22, 524288
    s_mov_b32 s23, 0x00020000
    v_and_b32 v1, 31, v15
    v_lshlrev_b32 v1, 3, v1
    v_lshrrev_b32 v13, 5, v15
    v_lshlrev_b32 v13, 13, v13
    v_add_u32 v1, v1, v13
    s_lshl_b32 s44, s34, 14
    s_lshl_b32 s45, s36, 8
    s_add_u32 s44, s44, s45

m_kernel_g1_poll_16:
    s_add_u32 s45, s44, 0
    buffer_load_dwordx2 v[234:235], v1, s[20:23], s45 offen sc1
    s_add_u32 s45, s44, 1024
    buffer_load_dwordx2 v[236:237], v1, s[20:23], s45 offen sc1
    s_add_u32 s45, s44, 2048
    buffer_load_dwordx2 v[238:239], v1, s[20:23], s45 offen sc1
    s_add_u32 s45, s44, 3072
    buffer_load_dwordx2 v[240:241], v1, s[20:23], s45 offen sc1
    s_add_u32 s45, s44, 4096
    buffer_load_dwordx2 v[242:243], v1, s[20:23], s45 offen sc1
    s_add_u32 s45, s44, 5120
    buffer_load_dwordx2 v[244:245], v1, s[20:23], s45 offen sc1
    s_add_u32 s45, s44, 6144
    buffer_load_dwordx2 v[246:247], v1, s[20:23], s45 offen sc1
    s_add_u32 s45, s44, 7168
    buffer_load_dwordx2 v[248:249], v1, s[20:23], s45 offen sc1
    s_waitcnt vmcnt(0)
    v_or_b32 v13, v235, v237
    v_or_b32 v13, v13, v239
    v_or_b32 v13, v13, v241
    v_or_b32 v13, v13, v243
    v_or_b32 v13, v13, v245
    v_or_b32 v13, v13, v247
    v_or_b32 v13, v13, v249
    v_cmp_gt_i32 s[52:53], 0, v13
    s_cmp_eq_u64 s[52:53], 0
    s_cbranch_scc1 m_kernel_g1_poll_16_ok
    s_sleep 4
    s_branch m_kernel_g1_poll_16
m_kernel_g1_poll_16_ok:
    v_pk_add_f32 v[234:235], v[234:235], v[236:237]
    v_pk_add_f32 v[234:235], v[234:235], v[238:239]
    v_pk_add_f32 v[234:235], v[234:235], v[240:241]
    v_pk_add_f32 v[234:235], v[234:235], v[242:243]
    v_pk_add_f32 v[234:235], v[234:235], v[244:245]
    v_pk_add_f32 v[234:235], v[234:235], v[246:247]
    v_pk_add_f32 v[234:235], v[234:235], v[248:249]
    v_mov_b32 v236, v234
    v_mov_b32 v237, v235
    s_nop 1
    v_permlane32_swap_b32 v236, v234
    v_permlane32_swap_b32 v237, v235
    v_pk_add_f32 v[234:235], v[234:235], v[236:237]
    v_mul_f32 v234, 0x39e38e39, v234
    v_mul_f32 v235, 0x39e38e39, v235
    v_fma_f32 v235, -v234, v234, v235
    v_max_f32 v235, 0, v235
    v_cvt_pk_bf16_f32 v235, v235, v235
    v_and_b32 v235, 0xffff0000, v235
    v_add_f32 v235, 0x3727c5ac, v235
    v_cvt_pk_bf16_f32 v235, v235, v235
    v_and_b32 v235, 0xffff0000, v235
    v_sqrt_f32 v235, v235
    s_nop 0
    v_cvt_pk_bf16_f32 v235, v235, v235
    v_and_b32 v235, 0xffff0000, v235
    v_rcp_f32 v235, v235
    v_cvt_pk_bf16_f32 v234, v234, v234
    v_and_b32 v234, 0xffff0000, v234
    v_mul_f32 v234, v234, v235
    v_and_b32 v1, 31, v15
    v_lshlrev_b32 v1, 3, v1
    s_lshl_b32 s45, s36, 8
    s_add_u32 s45, s45, 162816
    v_add_u32 v1, s45, v1
    ds_write_b64 v1, v[234:235]
    v_lshrrev_b32 v13, 4, v15
    v_lshlrev_b32 v13, 5, v13
    v_add_u32 v13, s45, v13
    s_waitcnt lgkmcnt(0)

    ds_read_b128 v[218:221], v13 offset:0
    ds_read_b128 v[222:225], v13 offset:16
    ds_read_b128 v[226:229], v13 offset:128
    ds_read_b128 v[230:233], v13 offset:144
    s_mul_i32 s44, s35, 64
    s_lshl_b32 s45, s34, 2
    s_add_u32 s44, s44, s45
    s_add_u32 s44, s44, s36
    s_mul_i32 s44, s44, 9216
    v_lshrrev_b32 v1, 4, v15
    v_and_b32 v13, 1, v1
    v_lshlrev_b32 v13, 1, v13
    v_lshrrev_b32 v1, 1, v1
    v_or_b32 v1, v1, v13
    v_lshlrev_b32 v1, 4, v1
    v_and_b32 v13, 15, v15
    v_add_u32 v1, v1, v13
    v_lshlrev_b32 v1, 4, v1
    s_waitcnt lgkmcnt(0)

    v_fma_f32 v128, v128, v219, -v218
    v_fma_f32 v129, v129, v221, -v220
    v_fma_f32 v130, v130, v223, -v222
    v_fma_f32 v131, v131, v225, -v224
    v_cvt_pk_bf16_f32 v88, v128, v129
    v_cvt_pk_bf16_f32 v89, v130, v131
    v_fma_f32 v164, v164, v227, -v226
    v_fma_f32 v165, v165, v229, -v228
    v_fma_f32 v166, v166, v231, -v230
    v_fma_f32 v167, v167, v233, -v232
    v_cvt_pk_bf16_f32 v90, v164, v165
    v_cvt_pk_bf16_f32 v91, v166, v167
    v_fma_f32 v132, v132, v219, -v218
    v_fma_f32 v133, v133, v221, -v220
    v_fma_f32 v134, v134, v223, -v222
    v_fma_f32 v135, v135, v225, -v224
    v_cvt_pk_bf16_f32 v92, v132, v133
    v_cvt_pk_bf16_f32 v93, v134, v135
    v_fma_f32 v168, v168, v227, -v226
    v_fma_f32 v169, v169, v229, -v228
    v_fma_f32 v170, v170, v231, -v230
    v_fma_f32 v171, v171, v233, -v232
    v_cvt_pk_bf16_f32 v94, v168, v169
    v_cvt_pk_bf16_f32 v95, v170, v171
    v_permlane16_swap_b32 v88, v90
    v_permlane16_swap_b32 v89, v91
    s_add_u32 s45, s44, 0
    buffer_store_dwordx4 v[88:91], v1, s[16:19], s45 offen sc1
    v_fma_f32 v136, v136, v219, -v218
    v_fma_f32 v137, v137, v221, -v220
    v_fma_f32 v138, v138, v223, -v222
    v_fma_f32 v139, v139, v225, -v224
    v_cvt_pk_bf16_f32 v96, v136, v137
    v_cvt_pk_bf16_f32 v97, v138, v139
    v_fma_f32 v172, v172, v227, -v226
    v_fma_f32 v173, v173, v229, -v228
    v_fma_f32 v174, v174, v231, -v230
    v_fma_f32 v175, v175, v233, -v232
    v_cvt_pk_bf16_f32 v98, v172, v173
    v_cvt_pk_bf16_f32 v99, v174, v175
    v_permlane16_swap_b32 v92, v94
    v_permlane16_swap_b32 v93, v95
    s_add_u32 s45, s44, 1024
    buffer_store_dwordx4 v[92:95], v1, s[16:19], s45 offen sc1
    v_fma_f32 v140, v140, v219, -v218
    v_fma_f32 v141, v141, v221, -v220
    v_fma_f32 v142, v142, v223, -v222
    v_fma_f32 v143, v143, v225, -v224
    v_cvt_pk_bf16_f32 v100, v140, v141
    v_cvt_pk_bf16_f32 v101, v142, v143
    v_fma_f32 v176, v176, v227, -v226
    v_fma_f32 v177, v177, v229, -v228
    v_fma_f32 v178, v178, v231, -v230
    v_fma_f32 v179, v179, v233, -v232
    v_cvt_pk_bf16_f32 v102, v176, v177
    v_cvt_pk_bf16_f32 v103, v178, v179
    v_permlane16_swap_b32 v96, v98
    v_permlane16_swap_b32 v97, v99
    s_add_u32 s45, s44, 2048
    buffer_store_dwordx4 v[96:99], v1, s[16:19], s45 offen sc1
    v_fma_f32 v144, v144, v219, -v218
    v_fma_f32 v145, v145, v221, -v220
    v_fma_f32 v146, v146, v223, -v222
    v_fma_f32 v147, v147, v225, -v224
    v_cvt_pk_bf16_f32 v104, v144, v145
    v_cvt_pk_bf16_f32 v105, v146, v147
    v_fma_f32 v180, v180, v227, -v226
    v_fma_f32 v181, v181, v229, -v228
    v_fma_f32 v182, v182, v231, -v230
    v_fma_f32 v183, v183, v233, -v232
    v_cvt_pk_bf16_f32 v106, v180, v181
    v_cvt_pk_bf16_f32 v107, v182, v183
    v_permlane16_swap_b32 v100, v102
    v_permlane16_swap_b32 v101, v103
    s_add_u32 s45, s44, 3072
    buffer_store_dwordx4 v[100:103], v1, s[16:19], s45 offen sc1
    v_fma_f32 v148, v148, v219, -v218
    v_fma_f32 v149, v149, v221, -v220
    v_fma_f32 v150, v150, v223, -v222
    v_fma_f32 v151, v151, v225, -v224
    v_cvt_pk_bf16_f32 v108, v148, v149
    v_cvt_pk_bf16_f32 v109, v150, v151
    v_fma_f32 v184, v184, v227, -v226
    v_fma_f32 v185, v185, v229, -v228
    v_fma_f32 v186, v186, v231, -v230
    v_fma_f32 v187, v187, v233, -v232
    v_cvt_pk_bf16_f32 v110, v184, v185
    v_cvt_pk_bf16_f32 v111, v186, v187
    v_permlane16_swap_b32 v104, v106
    v_permlane16_swap_b32 v105, v107
    s_add_u32 s45, s44, 4096
    buffer_store_dwordx4 v[104:107], v1, s[16:19], s45 offen sc1
    v_fma_f32 v152, v152, v219, -v218
    v_fma_f32 v153, v153, v221, -v220
    v_fma_f32 v154, v154, v223, -v222
    v_fma_f32 v155, v155, v225, -v224
    v_cvt_pk_bf16_f32 v112, v152, v153
    v_cvt_pk_bf16_f32 v113, v154, v155
    v_fma_f32 v188, v188, v227, -v226
    v_fma_f32 v189, v189, v229, -v228
    v_fma_f32 v190, v190, v231, -v230
    v_fma_f32 v191, v191, v233, -v232
    v_cvt_pk_bf16_f32 v114, v188, v189
    v_cvt_pk_bf16_f32 v115, v190, v191
    v_permlane16_swap_b32 v108, v110
    v_permlane16_swap_b32 v109, v111
    s_add_u32 s45, s44, 5120
    buffer_store_dwordx4 v[108:111], v1, s[16:19], s45 offen sc1
    v_fma_f32 v156, v156, v219, -v218
    v_fma_f32 v157, v157, v221, -v220
    v_fma_f32 v158, v158, v223, -v222
    v_fma_f32 v159, v159, v225, -v224
    v_cvt_pk_bf16_f32 v116, v156, v157
    v_cvt_pk_bf16_f32 v117, v158, v159
    v_fma_f32 v192, v192, v227, -v226
    v_fma_f32 v193, v193, v229, -v228
    v_fma_f32 v194, v194, v231, -v230
    v_fma_f32 v195, v195, v233, -v232
    v_cvt_pk_bf16_f32 v118, v192, v193
    v_cvt_pk_bf16_f32 v119, v194, v195
    v_permlane16_swap_b32 v112, v114
    v_permlane16_swap_b32 v113, v115
    s_add_u32 s45, s44, 6144
    buffer_store_dwordx4 v[112:115], v1, s[16:19], s45 offen sc1
    v_fma_f32 v160, v160, v219, -v218
    v_fma_f32 v161, v161, v221, -v220
    v_fma_f32 v162, v162, v223, -v222
    v_fma_f32 v163, v163, v225, -v224
    v_cvt_pk_bf16_f32 v120, v160, v161
    v_cvt_pk_bf16_f32 v121, v162, v163
    v_fma_f32 v196, v196, v227, -v226
    v_fma_f32 v197, v197, v229, -v228
    v_fma_f32 v198, v198, v231, -v230
    v_fma_f32 v199, v199, v233, -v232
    v_cvt_pk_bf16_f32 v122, v196, v197
    v_cvt_pk_bf16_f32 v123, v198, v199
    v_permlane16_swap_b32 v116, v118
    v_permlane16_swap_b32 v117, v119
    s_add_u32 s45, s44, 7168
    buffer_store_dwordx4 v[116:119], v1, s[16:19], s45 offen sc1
    s_nop 1
    v_permlane16_swap_b32 v120, v122
    v_permlane16_swap_b32 v121, v123
    s_add_u32 s45, s44, 8192
    buffer_store_dwordx4 v[120:123], v1, s[16:19], s45 offen sc1
    s_waitcnt lgkmcnt(0)
    v_mfma_f32_16x16x32_bf16 v[16:19], a[144:147], a[0:3], 0
    ds_read_b64_tr_b16 a[180:181], v10 offset:288
    v_mfma_f32_16x16x32_bf16 v[52:55], a[144:147], a[4:7], 0
    ds_read_b64_tr_b16 a[182:183], v10 offset:2592
    v_mfma_f32_16x16x32_bf16 v[20:23], a[148:151], a[0:3], 0
    ds_read_b64_tr_b16 a[184:185], v9 offset:320
    v_mfma_f32_16x16x32_bf16 v[56:59], a[148:151], a[4:7], 0
    ds_read_b64_tr_b16 a[186:187], v9 offset:2624
    s_add_u32 s40, s38, 1769472
    s_add_u32 m0, s39, 40960
    s_nop 0
    buffer_load_dwordx4 v2, s[4:7], s40 offen lds
    v_mfma_f32_16x16x32_bf16 v[24:27], a[152:155], a[0:3], 0
    ds_read_b64_tr_b16 a[188:189], v10 offset:352
    v_mfma_f32_16x16x32_bf16 v[60:63], a[152:155], a[4:7], 0
    ds_read_b64_tr_b16 a[190:191], v10 offset:2656
    v_mfma_f32_16x16x32_bf16 v[28:31], a[156:159], a[0:3], 0
    ds_read_b64_tr_b16 a[192:193], v9 offset:384
    v_mfma_f32_16x16x32_bf16 v[64:67], a[156:159], a[4:7], 0
    ds_read_b64_tr_b16 a[194:195], v9 offset:2688
    v_mfma_f32_16x16x32_bf16 v[32:35], a[160:163], a[0:3], 0
    ds_read_b64_tr_b16 a[196:197], v10 offset:416
    v_mfma_f32_16x16x32_bf16 v[68:71], a[160:163], a[4:7], 0
    ds_read_b64_tr_b16 a[198:199], v10 offset:2720
    s_add_u32 s40, s38, 1769472
    s_add_u32 m0, s39, 45056
    s_nop 0
    buffer_load_dwordx4 v3, s[4:7], s40 offen lds
    v_mfma_f32_16x16x32_bf16 v[36:39], a[164:167], a[0:3], 0
    ds_read_b64_tr_b16 a[200:201], v9 offset:448
    v_mfma_f32_16x16x32_bf16 v[72:75], a[164:167], a[4:7], 0
    ds_read_b64_tr_b16 a[202:203], v9 offset:2752
    v_mfma_f32_16x16x32_bf16 v[40:43], a[168:171], a[0:3], 0
    ds_read_b64_tr_b16 a[204:205], v10 offset:480
    v_mfma_f32_16x16x32_bf16 v[76:79], a[168:171], a[4:7], 0
    ds_read_b64_tr_b16 a[206:207], v10 offset:2784
    v_mfma_f32_16x16x32_bf16 v[44:47], a[172:175], a[0:3], 0
    ds_read_b64_tr_b16 a[208:209], v9 offset:512
    v_mfma_f32_16x16x32_bf16 v[80:83], a[172:175], a[4:7], 0
    ds_read_b64_tr_b16 a[210:211], v9 offset:2816
    s_add_u32 s40, s38, 1769472
    s_add_u32 m0, s39, 49152
    s_nop 0
    buffer_load_dwordx4 v4, s[4:7], s40 offen lds
    v_mfma_f32_16x16x32_bf16 v[48:51], a[176:179], a[0:3], 0
    ds_read_b64_tr_b16 a[212:213], v10 offset:544
    v_mfma_f32_16x16x32_bf16 v[84:87], a[176:179], a[4:7], 0
    ds_read_b64_tr_b16 a[214:215], v10 offset:2848
    s_waitcnt vmcnt(30)
    s_barrier
    v_add_u32 v9, 0, v7
    v_add_u32 v10, 0, v8
    s_waitcnt lgkmcnt(14)
    v_mfma_f32_16x16x32_bf16 v[16:19], a[180:183], a[8:11], v[16:19]
    ds_read_b64_tr_b16 a[144:145], v9 offset:0
    v_mfma_f32_16x16x32_bf16 v[52:55], a[180:183], a[12:15], v[52:55]
    ds_read_b64_tr_b16 a[146:147], v9 offset:2304
    v_mfma_f32_16x16x32_bf16 v[20:23], a[184:187], a[8:11], v[20:23]
    ds_read_b64_tr_b16 a[148:149], v10 offset:32
    v_mfma_f32_16x16x32_bf16 v[56:59], a[184:187], a[12:15], v[56:59]
    ds_read_b64_tr_b16 a[150:151], v10 offset:2336
    s_waitcnt lgkmcnt(14)
    v_mfma_f32_16x16x32_bf16 v[24:27], a[188:191], a[8:11], v[24:27]
    ds_read_b64_tr_b16 a[152:153], v9 offset:64
    s_add_u32 s40, s38, 1769472
    s_add_u32 m0, s39, 53248
    s_nop 0
    buffer_load_dwordx4 v5, s[4:7], s40 offen lds
    v_mfma_f32_16x16x32_bf16 v[60:63], a[188:191], a[12:15], v[60:63]
    ds_read_b64_tr_b16 a[154:155], v9 offset:2368
    v_mfma_f32_16x16x32_bf16 v[28:31], a[192:195], a[8:11], v[28:31]
    ds_read_b64_tr_b16 a[156:157], v10 offset:96
    v_mfma_f32_16x16x32_bf16 v[64:67], a[192:195], a[12:15], v[64:67]
    ds_read_b64_tr_b16 a[158:159], v10 offset:2400
    s_waitcnt lgkmcnt(14)
    v_mfma_f32_16x16x32_bf16 v[32:35], a[196:199], a[8:11], v[32:35]
    ds_read_b64_tr_b16 a[160:161], v9 offset:128
    v_mfma_f32_16x16x32_bf16 v[68:71], a[196:199], a[12:15], v[68:71]
    ds_read_b64_tr_b16 a[162:163], v9 offset:2432
    v_mfma_f32_16x16x32_bf16 v[36:39], a[200:203], a[8:11], v[36:39]
    ds_read_b64_tr_b16 a[164:165], v10 offset:160
    v_mfma_f32_16x16x32_bf16 v[72:75], a[200:203], a[12:15], v[72:75]
    ds_read_b64_tr_b16 a[166:167], v10 offset:2464
    s_waitcnt lgkmcnt(14)
    v_mfma_f32_16x16x32_bf16 v[40:43], a[204:207], a[8:11], v[40:43]
    ds_read_b64_tr_b16 a[168:169], v9 offset:192
    v_mfma_f32_16x16x32_bf16 v[76:79], a[204:207], a[12:15], v[76:79]
    ds_read_b64_tr_b16 a[170:171], v9 offset:2496
    s_add_u32 s40, s38, 1769472
    s_add_u32 m0, s39, 57344
    s_nop 0
    buffer_load_dwordx4 v6, s[4:7], s40 offen lds
    v_mfma_f32_16x16x32_bf16 v[44:47], a[208:211], a[8:11], v[44:47]
    ds_read_b64_tr_b16 a[172:173], v10 offset:224
    v_mfma_f32_16x16x32_bf16 v[80:83], a[208:211], a[12:15], v[80:83]
    ds_read_b64_tr_b16 a[174:175], v10 offset:2528
    s_waitcnt lgkmcnt(15)
    v_mfma_f32_16x16x32_bf16 v[48:51], a[212:215], a[8:11], v[48:51]
    ds_read_b64_tr_b16 a[176:177], v9 offset:256
    v_mfma_f32_16x16x32_bf16 v[84:87], a[212:215], a[12:15], v[84:87]
    ds_read_b64_tr_b16 a[178:179], v9 offset:2560
    s_waitcnt lgkmcnt(14)
    v_mfma_f32_16x16x32_bf16 v[16:19], a[144:147], a[16:19], v[16:19]
    ds_read_b64_tr_b16 a[180:181], v10 offset:288
    v_mfma_f32_16x16x32_bf16 v[52:55], a[144:147], a[20:23], v[52:55]
    ds_read_b64_tr_b16 a[182:183], v10 offset:2592
    v_mfma_f32_16x16x32_bf16 v[20:23], a[148:151], a[16:19], v[20:23]
    ds_read_b64_tr_b16 a[184:185], v9 offset:320
    v_mfma_f32_16x16x32_bf16 v[56:59], a[148:151], a[20:23], v[56:59]
    ds_read_b64_tr_b16 a[186:187], v9 offset:2624
    s_add_u32 s40, s38, 2359296
    s_add_u32 m0, s39, 61440
    s_nop 0
    buffer_load_dwordx4 v2, s[4:7], s40 offen lds
    s_waitcnt lgkmcnt(14)
    v_mfma_f32_16x16x32_bf16 v[24:27], a[152:155], a[16:19], v[24:27]
    ds_read_b64_tr_b16 a[188:189], v10 offset:352
    v_mfma_f32_16x16x32_bf16 v[60:63], a[152:155], a[20:23], v[60:63]
    ds_read_b64_tr_b16 a[190:191], v10 offset:2656
    v_mfma_f32_16x16x32_bf16 v[28:31], a[156:159], a[16:19], v[28:31]
    ds_read_b64_tr_b16 a[192:193], v9 offset:384
    v_mfma_f32_16x16x32_bf16 v[64:67], a[156:159], a[20:23], v[64:67]
    ds_read_b64_tr_b16 a[194:195], v9 offset:2688
    s_waitcnt lgkmcnt(14)
    v_mfma_f32_16x16x32_bf16 v[32:35], a[160:163], a[16:19], v[32:35]
    ds_read_b64_tr_b16 a[196:197], v10 offset:416
    v_mfma_f32_16x16x32_bf16 v[68:71], a[160:163], a[20:23], v[68:71]
    ds_read_b64_tr_b16 a[198:199], v10 offset:2720
    s_add_u32 s40, s38, 2359296
    s_add_u32 m0, s39, 65536
    s_nop 0
    buffer_load_dwordx4 v3, s[4:7], s40 offen lds
    v_mfma_f32_16x16x32_bf16 v[36:39], a[164:167], a[16:19], v[36:39]
    ds_read_b64_tr_b16 a[200:201], v9 offset:448
    v_mfma_f32_16x16x32_bf16 v[72:75], a[164:167], a[20:23], v[72:75]
    ds_read_b64_tr_b16 a[202:203], v9 offset:2752
    s_waitcnt lgkmcnt(14)
    v_mfma_f32_16x16x32_bf16 v[40:43], a[168:171], a[16:19], v[40:43]
    ds_read_b64_tr_b16 a[204:205], v10 offset:480
    v_mfma_f32_16x16x32_bf16 v[76:79], a[168:171], a[20:23], v[76:79]
    ds_read_b64_tr_b16 a[206:207], v10 offset:2784
    v_mfma_f32_16x16x32_bf16 v[44:47], a[172:175], a[16:19], v[44:47]
    ds_read_b64_tr_b16 a[208:209], v9 offset:512
    v_mfma_f32_16x16x32_bf16 v[80:83], a[172:175], a[20:23], v[80:83]
    ds_read_b64_tr_b16 a[210:211], v9 offset:2816
    s_add_u32 s40, s38, 2359296
    s_add_u32 m0, s39, 69632
    s_nop 0
    buffer_load_dwordx4 v4, s[4:7], s40 offen lds
    s_waitcnt lgkmcnt(15)
    v_mfma_f32_16x16x32_bf16 v[48:51], a[176:179], a[16:19], v[48:51]
    ds_read_b64_tr_b16 a[212:213], v10 offset:544
    v_mfma_f32_16x16x32_bf16 v[84:87], a[176:179], a[20:23], v[84:87]
    ds_read_b64_tr_b16 a[214:215], v10 offset:2848
    s_waitcnt vmcnt(29)
    s_barrier
    v_add_u32 v9, 20480, v7
    v_add_u32 v10, 20480, v8
    s_waitcnt lgkmcnt(14)
    v_mfma_f32_16x16x32_bf16 v[16:19], a[180:183], a[24:27], v[16:19]
    ds_read_b64_tr_b16 a[144:145], v9 offset:0
    v_mfma_f32_16x16x32_bf16 v[52:55], a[180:183], a[28:31], v[52:55]
    ds_read_b64_tr_b16 a[146:147], v9 offset:2304
    v_mfma_f32_16x16x32_bf16 v[20:23], a[184:187], a[24:27], v[20:23]
    ds_read_b64_tr_b16 a[148:149], v10 offset:32
    v_mfma_f32_16x16x32_bf16 v[56:59], a[184:187], a[28:31], v[56:59]
    ds_read_b64_tr_b16 a[150:151], v10 offset:2336
    s_waitcnt lgkmcnt(14)
    v_mfma_f32_16x16x32_bf16 v[24:27], a[188:191], a[24:27], v[24:27]
    ds_read_b64_tr_b16 a[152:153], v9 offset:64
    s_add_u32 s40, s38, 2359296
    s_add_u32 m0, s39, 73728
    s_nop 0
    buffer_load_dwordx4 v5, s[4:7], s40 offen lds
    v_mfma_f32_16x16x32_bf16 v[60:63], a[188:191], a[28:31], v[60:63]
    ds_read_b64_tr_b16 a[154:155], v9 offset:2368
    v_mfma_f32_16x16x32_bf16 v[28:31], a[192:195], a[24:27], v[28:31]
    ds_read_b64_tr_b16 a[156:157], v10 offset:96
    v_mfma_f32_16x16x32_bf16 v[64:67], a[192:195], a[28:31], v[64:67]
    ds_read_b64_tr_b16 a[158:159], v10 offset:2400
    s_waitcnt lgkmcnt(14)
    v_mfma_f32_16x16x32_bf16 v[32:35], a[196:199], a[24:27], v[32:35]
    ds_read_b64_tr_b16 a[160:161], v9 offset:128
    v_mfma_f32_16x16x32_bf16 v[68:71], a[196:199], a[28:31], v[68:71]
    ds_read_b64_tr_b16 a[162:163], v9 offset:2432
    v_mfma_f32_16x16x32_bf16 v[36:39], a[200:203], a[24:27], v[36:39]
    ds_read_b64_tr_b16 a[164:165], v10 offset:160
    v_mfma_f32_16x16x32_bf16 v[72:75], a[200:203], a[28:31], v[72:75]
    ds_read_b64_tr_b16 a[166:167], v10 offset:2464
    s_waitcnt lgkmcnt(14)
    v_mfma_f32_16x16x32_bf16 v[40:43], a[204:207], a[24:27], v[40:43]
    ds_read_b64_tr_b16 a[168:169], v9 offset:192
    v_mfma_f32_16x16x32_bf16 v[76:79], a[204:207], a[28:31], v[76:79]
    ds_read_b64_tr_b16 a[170:171], v9 offset:2496
    s_add_u32 s40, s38, 2359296
    s_add_u32 m0, s39, 77824
    s_nop 0
    buffer_load_dwordx4 v6, s[4:7], s40 offen lds
    v_mfma_f32_16x16x32_bf16 v[44:47], a[208:211], a[24:27], v[44:47]
    ds_read_b64_tr_b16 a[172:173], v10 offset:224
    v_mfma_f32_16x16x32_bf16 v[80:83], a[208:211], a[28:31], v[80:83]
    ds_read_b64_tr_b16 a[174:175], v10 offset:2528
    s_waitcnt lgkmcnt(15)
    v_mfma_f32_16x16x32_bf16 v[48:51], a[212:215], a[24:27], v[48:51]
    ds_read_b64_tr_b16 a[176:177], v9 offset:256
    v_mfma_f32_16x16x32_bf16 v[84:87], a[212:215], a[28:31], v[84:87]
    ds_read_b64_tr_b16 a[178:179], v9 offset:2560
    s_waitcnt lgkmcnt(14)
    v_mfma_f32_16x16x32_bf16 v[16:19], a[144:147], a[32:35], v[16:19]
    ds_read_b64_tr_b16 a[180:181], v10 offset:288
    v_mfma_f32_16x16x32_bf16 v[52:55], a[144:147], a[36:39], v[52:55]
    ds_read_b64_tr_b16 a[182:183], v10 offset:2592
    v_mfma_f32_16x16x32_bf16 v[20:23], a[148:151], a[32:35], v[20:23]
    ds_read_b64_tr_b16 a[184:185], v9 offset:320
    v_mfma_f32_16x16x32_bf16 v[56:59], a[148:151], a[36:39], v[56:59]
    ds_read_b64_tr_b16 a[186:187], v9 offset:2624
    s_add_u32 s40, s38, 2949120
    s_add_u32 m0, s39, 81920
    s_nop 0
    buffer_load_dwordx4 v2, s[4:7], s40 offen lds
    s_waitcnt lgkmcnt(14)
    v_mfma_f32_16x16x32_bf16 v[24:27], a[152:155], a[32:35], v[24:27]
    ds_read_b64_tr_b16 a[188:189], v10 offset:352
    v_mfma_f32_16x16x32_bf16 v[60:63], a[152:155], a[36:39], v[60:63]
    ds_read_b64_tr_b16 a[190:191], v10 offset:2656
    v_mfma_f32_16x16x32_bf16 v[28:31], a[156:159], a[32:35], v[28:31]
    ds_read_b64_tr_b16 a[192:193], v9 offset:384
    v_mfma_f32_16x16x32_bf16 v[64:67], a[156:159], a[36:39], v[64:67]
    ds_read_b64_tr_b16 a[194:195], v9 offset:2688
    s_waitcnt lgkmcnt(14)
    v_mfma_f32_16x16x32_bf16 v[32:35], a[160:163], a[32:35], v[32:35]
    ds_read_b64_tr_b16 a[196:197], v10 offset:416
    v_mfma_f32_16x16x32_bf16 v[68:71], a[160:163], a[36:39], v[68:71]
    ds_read_b64_tr_b16 a[198:199], v10 offset:2720
    s_add_u32 s40, s38, 2949120
    s_add_u32 m0, s39, 86016
    s_nop 0
    buffer_load_dwordx4 v3, s[4:7], s40 offen lds
    v_mfma_f32_16x16x32_bf16 v[36:39], a[164:167], a[32:35], v[36:39]
    ds_read_b64_tr_b16 a[200:201], v9 offset:448
    v_mfma_f32_16x16x32_bf16 v[72:75], a[164:167], a[36:39], v[72:75]
    ds_read_b64_tr_b16 a[202:203], v9 offset:2752
    s_waitcnt lgkmcnt(14)
    v_mfma_f32_16x16x32_bf16 v[40:43], a[168:171], a[32:35], v[40:43]
    ds_read_b64_tr_b16 a[204:205], v10 offset:480
    v_mfma_f32_16x16x32_bf16 v[76:79], a[168:171], a[36:39], v[76:79]
    ds_read_b64_tr_b16 a[206:207], v10 offset:2784
    v_mfma_f32_16x16x32_bf16 v[44:47], a[172:175], a[32:35], v[44:47]
    ds_read_b64_tr_b16 a[208:209], v9 offset:512
    v_mfma_f32_16x16x32_bf16 v[80:83], a[172:175], a[36:39], v[80:83]
    ds_read_b64_tr_b16 a[210:211], v9 offset:2816
    s_add_u32 s40, s38, 2949120
    s_add_u32 m0, s39, 90112
    s_nop 0
    buffer_load_dwordx4 v4, s[4:7], s40 offen lds
    s_waitcnt lgkmcnt(15)
    v_mfma_f32_16x16x32_bf16 v[48:51], a[176:179], a[32:35], v[48:51]
    ds_read_b64_tr_b16 a[212:213], v10 offset:544
    v_mfma_f32_16x16x32_bf16 v[84:87], a[176:179], a[36:39], v[84:87]
    ds_read_b64_tr_b16 a[214:215], v10 offset:2848
    s_waitcnt vmcnt(8)
    s_barrier
    v_add_u32 v9, 40960, v7
    v_add_u32 v10, 40960, v8
    s_waitcnt lgkmcnt(14)
    v_mfma_f32_16x16x32_bf16 v[16:19], a[180:183], a[40:43], v[16:19]
    ds_read_b64_tr_b16 a[144:145], v9 offset:0
    v_mfma_f32_16x16x32_bf16 v[52:55], a[180:183], a[44:47], v[52:55]
    ds_read_b64_tr_b16 a[146:147], v9 offset:2304
    v_mfma_f32_16x16x32_bf16 v[20:23], a[184:187], a[40:43], v[20:23]
    ds_read_b64_tr_b16 a[148:149], v10 offset:32
    v_mfma_f32_16x16x32_bf16 v[56:59], a[184:187], a[44:47], v[56:59]
    ds_read_b64_tr_b16 a[150:151], v10 offset:2336
    s_waitcnt lgkmcnt(14)
    v_mfma_f32_16x16x32_bf16 v[24:27], a[188:191], a[40:43], v[24:27]
    ds_read_b64_tr_b16 a[152:153], v9 offset:64
    s_add_u32 s40, s38, 2949120
    s_add_u32 m0, s39, 94208
    s_nop 0
    buffer_load_dwordx4 v5, s[4:7], s40 offen lds
    v_mfma_f32_16x16x32_bf16 v[60:63], a[188:191], a[44:47], v[60:63]
    ds_read_b64_tr_b16 a[154:155], v9 offset:2368
    v_mfma_f32_16x16x32_bf16 v[28:31], a[192:195], a[40:43], v[28:31]
    ds_read_b64_tr_b16 a[156:157], v10 offset:96
    v_mfma_f32_16x16x32_bf16 v[64:67], a[192:195], a[44:47], v[64:67]
    ds_read_b64_tr_b16 a[158:159], v10 offset:2400
    s_waitcnt lgkmcnt(14)
    v_mfma_f32_16x16x32_bf16 v[32:35], a[196:199], a[40:43], v[32:35]
    ds_read_b64_tr_b16 a[160:161], v9 offset:128
    v_mfma_f32_16x16x32_bf16 v[68:71], a[196:199], a[44:47], v[68:71]
    ds_read_b64_tr_b16 a[162:163], v9 offset:2432
    v_mfma_f32_16x16x32_bf16 v[36:39], a[200:203], a[40:43], v[36:39]
    ds_read_b64_tr_b16 a[164:165], v10 offset:160
    v_mfma_f32_16x16x32_bf16 v[72:75], a[200:203], a[44:47], v[72:75]
    ds_read_b64_tr_b16 a[166:167], v10 offset:2464
    s_waitcnt lgkmcnt(14)
    v_mfma_f32_16x16x32_bf16 v[40:43], a[204:207], a[40:43], v[40:43]
    ds_read_b64_tr_b16 a[168:169], v9 offset:192
    v_mfma_f32_16x16x32_bf16 v[76:79], a[204:207], a[44:47], v[76:79]
    ds_read_b64_tr_b16 a[170:171], v9 offset:2496
    s_add_u32 s40, s38, 2949120
    s_add_u32 m0, s39, 98304
    s_nop 0
    buffer_load_dwordx4 v6, s[4:7], s40 offen lds
    v_mfma_f32_16x16x32_bf16 v[44:47], a[208:211], a[40:43], v[44:47]
    ds_read_b64_tr_b16 a[172:173], v10 offset:224
    v_mfma_f32_16x16x32_bf16 v[80:83], a[208:211], a[44:47], v[80:83]
    ds_read_b64_tr_b16 a[174:175], v10 offset:2528
    s_waitcnt lgkmcnt(15)
    v_mfma_f32_16x16x32_bf16 v[48:51], a[212:215], a[40:43], v[48:51]
    ds_read_b64_tr_b16 a[176:177], v9 offset:256
    v_mfma_f32_16x16x32_bf16 v[84:87], a[212:215], a[44:47], v[84:87]
    ds_read_b64_tr_b16 a[178:179], v9 offset:2560
    s_waitcnt lgkmcnt(14)
    v_mfma_f32_16x16x32_bf16 v[16:19], a[144:147], a[48:51], v[16:19]
    ds_read_b64_tr_b16 a[180:181], v10 offset:288
    v_mfma_f32_16x16x32_bf16 v[52:55], a[144:147], a[52:55], v[52:55]
    ds_read_b64_tr_b16 a[182:183], v10 offset:2592
    v_mfma_f32_16x16x32_bf16 v[20:23], a[148:151], a[48:51], v[20:23]
    ds_read_b64_tr_b16 a[184:185], v9 offset:320
    v_mfma_f32_16x16x32_bf16 v[56:59], a[148:151], a[52:55], v[56:59]
    ds_read_b64_tr_b16 a[186:187], v9 offset:2624
    s_add_u32 s40, s38, 3538944
    s_add_u32 m0, s39, 0
    s_nop 0
    buffer_load_dwordx4 v2, s[4:7], s40 offen lds
    s_waitcnt lgkmcnt(14)
    v_mfma_f32_16x16x32_bf16 v[24:27], a[152:155], a[48:51], v[24:27]
    ds_read_b64_tr_b16 a[188:189], v10 offset:352
    v_mfma_f32_16x16x32_bf16 v[60:63], a[152:155], a[52:55], v[60:63]
    ds_read_b64_tr_b16 a[190:191], v10 offset:2656
    v_mfma_f32_16x16x32_bf16 v[28:31], a[156:159], a[48:51], v[28:31]
    ds_read_b64_tr_b16 a[192:193], v9 offset:384
    v_mfma_f32_16x16x32_bf16 v[64:67], a[156:159], a[52:55], v[64:67]
    ds_read_b64_tr_b16 a[194:195], v9 offset:2688
    s_waitcnt lgkmcnt(14)
    v_mfma_f32_16x16x32_bf16 v[32:35], a[160:163], a[48:51], v[32:35]
    ds_read_b64_tr_b16 a[196:197], v10 offset:416
    v_mfma_f32_16x16x32_bf16 v[68:71], a[160:163], a[52:55], v[68:71]
    ds_read_b64_tr_b16 a[198:199], v10 offset:2720
    s_add_u32 s40, s38, 3538944
    s_add_u32 m0, s39, 4096
    s_nop 0
    buffer_load_dwordx4 v3, s[4:7], s40 offen lds
    v_mfma_f32_16x16x32_bf16 v[36:39], a[164:167], a[48:51], v[36:39]
    ds_read_b64_tr_b16 a[200:201], v9 offset:448
    v_mfma_f32_16x16x32_bf16 v[72:75], a[164:167], a[52:55], v[72:75]
    ds_read_b64_tr_b16 a[202:203], v9 offset:2752
    s_waitcnt lgkmcnt(14)
    v_mfma_f32_16x16x32_bf16 v[40:43], a[168:171], a[48:51], v[40:43]
    ds_read_b64_tr_b16 a[204:205], v10 offset:480
    v_mfma_f32_16x16x32_bf16 v[76:79], a[168:171], a[52:55], v[76:79]
    ds_read_b64_tr_b16 a[206:207], v10 offset:2784
    v_mfma_f32_16x16x32_bf16 v[44:47], a[172:175], a[48:51], v[44:47]
    ds_read_b64_tr_b16 a[208:209], v9 offset:512
    v_mfma_f32_16x16x32_bf16 v[80:83], a[172:175], a[52:55], v[80:83]
    ds_read_b64_tr_b16 a[210:211], v9 offset:2816
    s_add_u32 s40, s38, 3538944
    s_add_u32 m0, s39, 8192
    s_nop 0
    buffer_load_dwordx4 v4, s[4:7], s40 offen lds
    s_waitcnt lgkmcnt(15)
    v_mfma_f32_16x16x32_bf16 v[48:51], a[176:179], a[48:51], v[48:51]
    ds_read_b64_tr_b16 a[212:213], v10 offset:544
    v_mfma_f32_16x16x32_bf16 v[84:87], a[176:179], a[52:55], v[84:87]
    ds_read_b64_tr_b16 a[214:215], v10 offset:2848
    s_waitcnt vmcnt(8)
    s_barrier
    v_add_u32 v9, 61440, v7
    v_add_u32 v10, 61440, v8
    s_waitcnt lgkmcnt(14)
    v_mfma_f32_16x16x32_bf16 v[16:19], a[180:183], a[56:59], v[16:19]
    ds_read_b64_tr_b16 a[144:145], v9 offset:0
    v_mfma_f32_16x16x32_bf16 v[52:55], a[180:183], a[60:63], v[52:55]
    ds_read_b64_tr_b16 a[146:147], v9 offset:2304
    v_mfma_f32_16x16x32_bf16 v[20:23], a[184:187], a[56:59], v[20:23]
    ds_read_b64_tr_b16 a[148:149], v10 offset:32
    v_mfma_f32_16x16x32_bf16 v[56:59], a[184:187], a[60:63], v[56:59]
    ds_read_b64_tr_b16 a[150:151], v10 offset:2336
    s_waitcnt lgkmcnt(14)
    v_mfma_f32_16x16x32_bf16 v[24:27], a[188:191], a[56:59], v[24:27]
    ds_read_b64_tr_b16 a[152:153], v9 offset:64
    s_add_u32 s40, s38, 3538944
    s_add_u32 m0, s39, 12288
    s_nop 0
    buffer_load_dwordx4 v5, s[4:7], s40 offen lds
    v_mfma_f32_16x16x32_bf16 v[60:63], a[188:191], a[60:63], v[60:63]
    ds_read_b64_tr_b16 a[154:155], v9 offset:2368
    v_mfma_f32_16x16x32_bf16 v[28:31], a[192:195], a[56:59], v[28:31]
    ds_read_b64_tr_b16 a[156:157], v10 offset:96
    v_mfma_f32_16x16x32_bf16 v[64:67], a[192:195], a[60:63], v[64:67]
    ds_read_b64_tr_b16 a[158:159], v10 offset:2400
    s_waitcnt lgkmcnt(14)
    v_mfma_f32_16x16x32_bf16 v[32:35], a[196:199], a[56:59], v[32:35]
    ds_read_b64_tr_b16 a[160:161], v9 offset:128
    v_mfma_f32_16x16x32_bf16 v[68:71], a[196:199], a[60:63], v[68:71]
    ds_read_b64_tr_b16 a[162:163], v9 offset:2432
    v_mfma_f32_16x16x32_bf16 v[36:39], a[200:203], a[56:59], v[36:39]
    ds_read_b64_tr_b16 a[164:165], v10 offset:160
    v_mfma_f32_16x16x32_bf16 v[72:75], a[200:203], a[60:63], v[72:75]
    ds_read_b64_tr_b16 a[166:167], v10 offset:2464
    s_waitcnt lgkmcnt(14)
    v_mfma_f32_16x16x32_bf16 v[40:43], a[204:207], a[56:59], v[40:43]
    ds_read_b64_tr_b16 a[168:169], v9 offset:192
    v_mfma_f32_16x16x32_bf16 v[76:79], a[204:207], a[60:63], v[76:79]
    ds_read_b64_tr_b16 a[170:171], v9 offset:2496
    s_add_u32 s40, s38, 3538944
    s_add_u32 m0, s39, 16384
    s_nop 0
    buffer_load_dwordx4 v6, s[4:7], s40 offen lds
    v_mfma_f32_16x16x32_bf16 v[44:47], a[208:211], a[56:59], v[44:47]
    ds_read_b64_tr_b16 a[172:173], v10 offset:224
    v_mfma_f32_16x16x32_bf16 v[80:83], a[208:211], a[60:63], v[80:83]
    ds_read_b64_tr_b16 a[174:175], v10 offset:2528
    s_waitcnt lgkmcnt(15)
    v_mfma_f32_16x16x32_bf16 v[48:51], a[212:215], a[56:59], v[48:51]
    ds_read_b64_tr_b16 a[176:177], v9 offset:256
    v_mfma_f32_16x16x32_bf16 v[84:87], a[212:215], a[60:63], v[84:87]
    ds_read_b64_tr_b16 a[178:179], v9 offset:2560
    s_waitcnt lgkmcnt(14)
    v_mfma_f32_16x16x32_bf16 v[16:19], a[144:147], a[64:67], v[16:19]
    ds_read_b64_tr_b16 a[180:181], v10 offset:288
    v_mfma_f32_16x16x32_bf16 v[52:55], a[144:147], a[68:71], v[52:55]
    ds_read_b64_tr_b16 a[182:183], v10 offset:2592
    v_mfma_f32_16x16x32_bf16 v[20:23], a[148:151], a[64:67], v[20:23]
    ds_read_b64_tr_b16 a[184:185], v9 offset:320
    v_mfma_f32_16x16x32_bf16 v[56:59], a[148:151], a[68:71], v[56:59]
    ds_read_b64_tr_b16 a[186:187], v9 offset:2624
    s_add_u32 s40, s38, 4128768
    s_add_u32 m0, s39, 20480
    s_nop 0
    buffer_load_dwordx4 v2, s[4:7], s40 offen lds
    s_waitcnt lgkmcnt(14)
    v_mfma_f32_16x16x32_bf16 v[24:27], a[152:155], a[64:67], v[24:27]
    ds_read_b64_tr_b16 a[188:189], v10 offset:352
    v_mfma_f32_16x16x32_bf16 v[60:63], a[152:155], a[68:71], v[60:63]
    ds_read_b64_tr_b16 a[190:191], v10 offset:2656
    v_mfma_f32_16x16x32_bf16 v[28:31], a[156:159], a[64:67], v[28:31]
    ds_read_b64_tr_b16 a[192:193], v9 offset:384
    v_mfma_f32_16x16x32_bf16 v[64:67], a[156:159], a[68:71], v[64:67]
    ds_read_b64_tr_b16 a[194:195], v9 offset:2688
    s_waitcnt lgkmcnt(14)
    v_mfma_f32_16x16x32_bf16 v[32:35], a[160:163], a[64:67], v[32:35]
    ds_read_b64_tr_b16 a[196:197], v10 offset:416
    v_mfma_f32_16x16x32_bf16 v[68:71], a[160:163], a[68:71], v[68:71]
    ds_read_b64_tr_b16 a[198:199], v10 offset:2720
    s_add_u32 s40, s38, 4128768
    s_add_u32 m0, s39, 24576
    s_nop 0
    buffer_load_dwordx4 v3, s[4:7], s40 offen lds
    v_mfma_f32_16x16x32_bf16 v[36:39], a[164:167], a[64:67], v[36:39]
    ds_read_b64_tr_b16 a[200:201], v9 offset:448
    v_mfma_f32_16x16x32_bf16 v[72:75], a[164:167], a[68:71], v[72:75]
    ds_read_b64_tr_b16 a[202:203], v9 offset:2752
    s_waitcnt lgkmcnt(14)
    v_mfma_f32_16x16x32_bf16 v[40:43], a[168:171], a[64:67], v[40:43]
    ds_read_b64_tr_b16 a[204:205], v10 offset:480
    v_mfma_f32_16x16x32_bf16 v[76:79], a[168:171], a[68:71], v[76:79]
    ds_read_b64_tr_b16 a[206:207], v10 offset:2784
    v_mfma_f32_16x16x32_bf16 v[44:47], a[172:175], a[64:67], v[44:47]
    ds_read_b64_tr_b16 a[208:209], v9 offset:512
    v_mfma_f32_16x16x32_bf16 v[80:83], a[172:175], a[68:71], v[80:83]
    ds_read_b64_tr_b16 a[210:211], v9 offset:2816
    s_add_u32 s40, s38, 4128768
    s_add_u32 m0, s39, 28672
    s_nop 0
    buffer_load_dwordx4 v4, s[4:7], s40 offen lds
    s_waitcnt lgkmcnt(15)
    v_mfma_f32_16x16x32_bf16 v[48:51], a[176:179], a[64:67], v[48:51]
    ds_read_b64_tr_b16 a[212:213], v10 offset:544
    v_mfma_f32_16x16x32_bf16 v[84:87], a[176:179], a[68:71], v[84:87]
    ds_read_b64_tr_b16 a[214:215], v10 offset:2848
    s_waitcnt vmcnt(8)
    s_barrier
    v_add_u32 v9, 81920, v7
    v_add_u32 v10, 81920, v8
    s_waitcnt lgkmcnt(14)
    v_mfma_f32_16x16x32_bf16 v[16:19], a[180:183], a[72:75], v[16:19]
    ds_read_b64_tr_b16 a[144:145], v9 offset:0
    v_mfma_f32_16x16x32_bf16 v[52:55], a[180:183], a[76:79], v[52:55]
    ds_read_b64_tr_b16 a[146:147], v9 offset:2304
    v_mfma_f32_16x16x32_bf16 v[20:23], a[184:187], a[72:75], v[20:23]
    ds_read_b64_tr_b16 a[148:149], v10 offset:32
    v_mfma_f32_16x16x32_bf16 v[56:59], a[184:187], a[76:79], v[56:59]
    ds_read_b64_tr_b16 a[150:151], v10 offset:2336
    s_waitcnt lgkmcnt(14)
    v_mfma_f32_16x16x32_bf16 v[24:27], a[188:191], a[72:75], v[24:27]
    ds_read_b64_tr_b16 a[152:153], v9 offset:64
    s_add_u32 s40, s38, 4128768
    s_add_u32 m0, s39, 32768
    s_nop 0
    buffer_load_dwordx4 v5, s[4:7], s40 offen lds
    v_mfma_f32_16x16x32_bf16 v[60:63], a[188:191], a[76:79], v[60:63]
    ds_read_b64_tr_b16 a[154:155], v9 offset:2368
    v_mfma_f32_16x16x32_bf16 v[28:31], a[192:195], a[72:75], v[28:31]
    ds_read_b64_tr_b16 a[156:157], v10 offset:96
    v_mfma_f32_16x16x32_bf16 v[64:67], a[192:195], a[76:79], v[64:67]
    ds_read_b64_tr_b16 a[158:159], v10 offset:2400
    s_waitcnt lgkmcnt(14)
    v_mfma_f32_16x16x32_bf16 v[32:35], a[196:199], a[72:75], v[32:35]
    ds_read_b64_tr_b16 a[160:161], v9 offset:128
    v_mfma_f32_16x16x32_bf16 v[68:71], a[196:199], a[76:79], v[68:71]
    ds_read_b64_tr_b16 a[162:163], v9 offset:2432
    v_mfma_f32_16x16x32_bf16 v[36:39], a[200:203], a[72:75], v[36:39]
    ds_read_b64_tr_b16 a[164:165], v10 offset:160
    v_mfma_f32_16x16x32_bf16 v[72:75], a[200:203], a[76:79], v[72:75]
    ds_read_b64_tr_b16 a[166:167], v10 offset:2464
    s_waitcnt lgkmcnt(14)
    v_mfma_f32_16x16x32_bf16 v[40:43], a[204:207], a[72:75], v[40:43]
    ds_read_b64_tr_b16 a[168:169], v9 offset:192
    v_mfma_f32_16x16x32_bf16 v[76:79], a[204:207], a[76:79], v[76:79]
    ds_read_b64_tr_b16 a[170:171], v9 offset:2496
    s_add_u32 s40, s38, 4128768
    s_add_u32 m0, s39, 36864
    s_nop 0
    buffer_load_dwordx4 v6, s[4:7], s40 offen lds
    v_mfma_f32_16x16x32_bf16 v[44:47], a[208:211], a[72:75], v[44:47]
    ds_read_b64_tr_b16 a[172:173], v10 offset:224
    v_mfma_f32_16x16x32_bf16 v[80:83], a[208:211], a[76:79], v[80:83]
    ds_read_b64_tr_b16 a[174:175], v10 offset:2528
    s_waitcnt lgkmcnt(15)
    v_mfma_f32_16x16x32_bf16 v[48:51], a[212:215], a[72:75], v[48:51]
    ds_read_b64_tr_b16 a[176:177], v9 offset:256
    v_mfma_f32_16x16x32_bf16 v[84:87], a[212:215], a[76:79], v[84:87]
    ds_read_b64_tr_b16 a[178:179], v9 offset:2560
    s_waitcnt lgkmcnt(14)
    v_mfma_f32_16x16x32_bf16 v[16:19], a[144:147], a[80:83], v[16:19]
    ds_read_b64_tr_b16 a[180:181], v10 offset:288
    v_mfma_f32_16x16x32_bf16 v[52:55], a[144:147], a[84:87], v[52:55]
    ds_read_b64_tr_b16 a[182:183], v10 offset:2592
    v_mfma_f32_16x16x32_bf16 v[20:23], a[148:151], a[80:83], v[20:23]
    ds_read_b64_tr_b16 a[184:185], v9 offset:320
    v_mfma_f32_16x16x32_bf16 v[56:59], a[148:151], a[84:87], v[56:59]
    ds_read_b64_tr_b16 a[186:187], v9 offset:2624
    s_add_u32 s40, s38, 4718592
    s_add_u32 m0, s39, 40960
    s_nop 0
    buffer_load_dwordx4 v2, s[4:7], s40 offen lds
    s_waitcnt lgkmcnt(14)
    v_mfma_f32_16x16x32_bf16 v[24:27], a[152:155], a[80:83], v[24:27]
    ds_read_b64_tr_b16 a[188:189], v10 offset:352
    v_mfma_f32_16x16x32_bf16 v[60:63], a[152:155], a[84:87], v[60:63]
    ds_read_b64_tr_b16 a[190:191], v10 offset:2656
    v_mfma_f32_16x16x32_bf16 v[28:31], a[156:159], a[80:83], v[28:31]
    ds_read_b64_tr_b16 a[192:193], v9 offset:384
    v_mfma_f32_16x16x32_bf16 v[64:67], a[156:159], a[84:87], v[64:67]
    ds_read_b64_tr_b16 a[194:195], v9 offset:2688
    s_waitcnt lgkmcnt(14)
    v_mfma_f32_16x16x32_bf16 v[32:35], a[160:163], a[80:83], v[32:35]
    ds_read_b64_tr_b16 a[196:197], v10 offset:416
    v_mfma_f32_16x16x32_bf16 v[68:71], a[160:163], a[84:87], v[68:71]
    ds_read_b64_tr_b16 a[198:199], v10 offset:2720
    s_add_u32 s40, s38, 4718592
    s_add_u32 m0, s39, 45056
    s_nop 0
    buffer_load_dwordx4 v3, s[4:7], s40 offen lds
    v_mfma_f32_16x16x32_bf16 v[36:39], a[164:167], a[80:83], v[36:39]
    ds_read_b64_tr_b16 a[200:201], v9 offset:448
    v_mfma_f32_16x16x32_bf16 v[72:75], a[164:167], a[84:87], v[72:75]
    ds_read_b64_tr_b16 a[202:203], v9 offset:2752
    s_waitcnt lgkmcnt(14)
    v_mfma_f32_16x16x32_bf16 v[40:43], a[168:171], a[80:83], v[40:43]
    ds_read_b64_tr_b16 a[204:205], v10 offset:480
    v_mfma_f32_16x16x32_bf16 v[76:79], a[168:171], a[84:87], v[76:79]
    ds_read_b64_tr_b16 a[206:207], v10 offset:2784
    v_mfma_f32_16x16x32_bf16 v[44:47], a[172:175], a[80:83], v[44:47]
    ds_read_b64_tr_b16 a[208:209], v9 offset:512
    v_mfma_f32_16x16x32_bf16 v[80:83], a[172:175], a[84:87], v[80:83]
    ds_read_b64_tr_b16 a[210:211], v9 offset:2816
    s_add_u32 s40, s38, 4718592
    s_add_u32 m0, s39, 49152
    s_nop 0
    buffer_load_dwordx4 v4, s[4:7], s40 offen lds
    s_waitcnt lgkmcnt(15)
    v_mfma_f32_16x16x32_bf16 v[48:51], a[176:179], a[80:83], v[48:51]
    ds_read_b64_tr_b16 a[212:213], v10 offset:544
    v_mfma_f32_16x16x32_bf16 v[84:87], a[176:179], a[84:87], v[84:87]
    ds_read_b64_tr_b16 a[214:215], v10 offset:2848
    s_waitcnt vmcnt(8)
    s_barrier
    v_add_u32 v9, 0, v7
    v_add_u32 v10, 0, v8
    s_waitcnt lgkmcnt(14)
    v_mfma_f32_16x16x32_bf16 v[16:19], a[180:183], a[88:91], v[16:19]
    ds_read_b64_tr_b16 a[144:145], v9 offset:0
    v_mfma_f32_16x16x32_bf16 v[52:55], a[180:183], a[92:95], v[52:55]
    ds_read_b64_tr_b16 a[146:147], v9 offset:2304
    v_mfma_f32_16x16x32_bf16 v[20:23], a[184:187], a[88:91], v[20:23]
    ds_read_b64_tr_b16 a[148:149], v10 offset:32
    v_mfma_f32_16x16x32_bf16 v[56:59], a[184:187], a[92:95], v[56:59]
    ds_read_b64_tr_b16 a[150:151], v10 offset:2336
    s_waitcnt lgkmcnt(14)
    v_mfma_f32_16x16x32_bf16 v[24:27], a[188:191], a[88:91], v[24:27]
    ds_read_b64_tr_b16 a[152:153], v9 offset:64
    s_add_u32 s40, s38, 4718592
    s_add_u32 m0, s39, 53248
    s_nop 0
    buffer_load_dwordx4 v5, s[4:7], s40 offen lds
    v_mfma_f32_16x16x32_bf16 v[60:63], a[188:191], a[92:95], v[60:63]
    ds_read_b64_tr_b16 a[154:155], v9 offset:2368
    v_mfma_f32_16x16x32_bf16 v[28:31], a[192:195], a[88:91], v[28:31]
    ds_read_b64_tr_b16 a[156:157], v10 offset:96
    v_mfma_f32_16x16x32_bf16 v[64:67], a[192:195], a[92:95], v[64:67]
    ds_read_b64_tr_b16 a[158:159], v10 offset:2400
    s_waitcnt lgkmcnt(14)
    v_mfma_f32_16x16x32_bf16 v[32:35], a[196:199], a[88:91], v[32:35]
    ds_read_b64_tr_b16 a[160:161], v9 offset:128
    v_mfma_f32_16x16x32_bf16 v[68:71], a[196:199], a[92:95], v[68:71]
    ds_read_b64_tr_b16 a[162:163], v9 offset:2432
    v_mfma_f32_16x16x32_bf16 v[36:39], a[200:203], a[88:91], v[36:39]
    ds_read_b64_tr_b16 a[164:165], v10 offset:160
    v_mfma_f32_16x16x32_bf16 v[72:75], a[200:203], a[92:95], v[72:75]
    ds_read_b64_tr_b16 a[166:167], v10 offset:2464
    s_waitcnt lgkmcnt(14)
    v_mfma_f32_16x16x32_bf16 v[40:43], a[204:207], a[88:91], v[40:43]
    ds_read_b64_tr_b16 a[168:169], v9 offset:192
    v_mfma_f32_16x16x32_bf16 v[76:79], a[204:207], a[92:95], v[76:79]
    ds_read_b64_tr_b16 a[170:171], v9 offset:2496
    s_add_u32 s40, s38, 4718592
    s_add_u32 m0, s39, 57344
    s_nop 0
    buffer_load_dwordx4 v6, s[4:7], s40 offen lds
    v_mfma_f32_16x16x32_bf16 v[44:47], a[208:211], a[88:91], v[44:47]
    ds_read_b64_tr_b16 a[172:173], v10 offset:224
    v_mfma_f32_16x16x32_bf16 v[80:83], a[208:211], a[92:95], v[80:83]
    ds_read_b64_tr_b16 a[174:175], v10 offset:2528
    s_waitcnt lgkmcnt(15)
    v_mfma_f32_16x16x32_bf16 v[48:51], a[212:215], a[88:91], v[48:51]
    ds_read_b64_tr_b16 a[176:177], v9 offset:256
    v_mfma_f32_16x16x32_bf16 v[84:87], a[212:215], a[92:95], v[84:87]
    ds_read_b64_tr_b16 a[178:179], v9 offset:2560
    s_waitcnt lgkmcnt(14)
    v_mfma_f32_16x16x32_bf16 v[16:19], a[144:147], a[96:99], v[16:19]
    ds_read_b64_tr_b16 a[180:181], v10 offset:288
    v_mfma_f32_16x16x32_bf16 v[52:55], a[144:147], a[100:103], v[52:55]
    ds_read_b64_tr_b16 a[182:183], v10 offset:2592
    v_mfma_f32_16x16x32_bf16 v[20:23], a[148:151], a[96:99], v[20:23]
    ds_read_b64_tr_b16 a[184:185], v9 offset:320
    v_mfma_f32_16x16x32_bf16 v[56:59], a[148:151], a[100:103], v[56:59]
    ds_read_b64_tr_b16 a[186:187], v9 offset:2624
    s_waitcnt lgkmcnt(14)
    v_mfma_f32_16x16x32_bf16 v[24:27], a[152:155], a[96:99], v[24:27]
    ds_read_b64_tr_b16 a[188:189], v10 offset:352
    v_mfma_f32_16x16x32_bf16 v[60:63], a[152:155], a[100:103], v[60:63]
    ds_read_b64_tr_b16 a[190:191], v10 offset:2656
    v_mfma_f32_16x16x32_bf16 v[28:31], a[156:159], a[96:99], v[28:31]
    ds_read_b64_tr_b16 a[192:193], v9 offset:384
    v_mfma_f32_16x16x32_bf16 v[64:67], a[156:159], a[100:103], v[64:67]
    ds_read_b64_tr_b16 a[194:195], v9 offset:2688
    s_waitcnt lgkmcnt(14)
    v_mfma_f32_16x16x32_bf16 v[32:35], a[160:163], a[96:99], v[32:35]
    ds_read_b64_tr_b16 a[196:197], v10 offset:416
    v_mfma_f32_16x16x32_bf16 v[68:71], a[160:163], a[100:103], v[68:71]
    ds_read_b64_tr_b16 a[198:199], v10 offset:2720
    v_mfma_f32_16x16x32_bf16 v[36:39], a[164:167], a[96:99], v[36:39]
    ds_read_b64_tr_b16 a[200:201], v9 offset:448
    v_mfma_f32_16x16x32_bf16 v[72:75], a[164:167], a[100:103], v[72:75]
    ds_read_b64_tr_b16 a[202:203], v9 offset:2752
    s_waitcnt lgkmcnt(14)
    v_mfma_f32_16x16x32_bf16 v[40:43], a[168:171], a[96:99], v[40:43]
    ds_read_b64_tr_b16 a[204:205], v10 offset:480
    v_mfma_f32_16x16x32_bf16 v[76:79], a[168:171], a[100:103], v[76:79]
    ds_read_b64_tr_b16 a[206:207], v10 offset:2784
    v_mfma_f32_16x16x32_bf16 v[44:47], a[172:175], a[96:99], v[44:47]
    ds_read_b64_tr_b16 a[208:209], v9 offset:512
    v_mfma_f32_16x16x32_bf16 v[80:83], a[172:175], a[100:103], v[80:83]
    ds_read_b64_tr_b16 a[210:211], v9 offset:2816
    s_waitcnt lgkmcnt(15)
    v_mfma_f32_16x16x32_bf16 v[48:51], a[176:179], a[96:99], v[48:51]
    ds_read_b64_tr_b16 a[212:213], v10 offset:544
    v_mfma_f32_16x16x32_bf16 v[84:87], a[176:179], a[100:103], v[84:87]
    ds_read_b64_tr_b16 a[214:215], v10 offset:2848
    s_waitcnt vmcnt(0)
    s_barrier
    s_cmp_eq_u32 s36, 0
    s_cbranch_scc0 m_kernel_sg_17
    s_add_u32 s24, s32, 49283072
    s_addc_u32 s25, s33, 0
    s_and_b32 s25, s25, 0xffff
    s_mov_b32 s26, 524288
    s_mov_b32 s27, 0x00020000
    v_mov_b32 v251, 1
    s_mov_b64 exec, 1
    s_add_u32 s44, s35, 0
    s_lshl_b32 s44, s44, 6
    s_add_u32 s44, s44, s34
    s_lshl_b32 s44, s44, 7
    v_mov_b32 v250, s44
    buffer_store_dword v251, v250, s[24:27], 0 offen sc1
    s_lshr_b32 s45, s2, 4
    s_and_b32 s46, s2, 15
    s_add_u32 s44, s45, 16
    s_lshl_b32 s44, s44, 6
    s_add_u32 s44, s44, s46
    s_lshl_b32 s44, s44, 7
    v_mov_b32 v250, s44
    buffer_store_dword v251, v250, s[24:27], 0 offen sc1
    s_mov_b64 exec, -1
m_kernel_sg_17:
    v_add_u32 v9, 20480, v7
    v_add_u32 v10, 20480, v8
    s_waitcnt lgkmcnt(14)
    v_mfma_f32_16x16x32_bf16 v[16:19], a[180:183], a[104:107], v[16:19]
    ds_read_b64_tr_b16 a[144:145], v9 offset:0
    v_mfma_f32_16x16x32_bf16 v[52:55], a[180:183], a[108:111], v[52:55]
    ds_read_b64_tr_b16 a[146:147], v9 offset:2304
    v_mfma_f32_16x16x32_bf16 v[20:23], a[184:187], a[104:107], v[20:23]
    ds_read_b64_tr_b16 a[148:149], v10 offset:32
    v_mfma_f32_16x16x32_bf16 v[56:59], a[184:187], a[108:111], v[56:59]
    ds_read_b64_tr_b16 a[150:151], v10 offset:2336
    s_waitcnt lgkmcnt(14)
    v_mfma_f32_16x16x32_bf16 v[24:27], a[188:191], a[104:107], v[24:27]
    ds_read_b64_tr_b16 a[152:153], v9 offset:64
    v_mfma_f32_16x16x32_bf16 v[60:63], a[188:191], a[108:111], v[60:63]
    ds_read_b64_tr_b16 a[154:155], v9 offset:2368
    v_mfma_f32_16x16x32_bf16 v[28:31], a[192:195], a[104:107], v[28:31]
    ds_read_b64_tr_b16 a[156:157], v10 offset:96
    v_mfma_f32_16x16x32_bf16 v[64:67], a[192:195], a[108:111], v[64:67]
    ds_read_b64_tr_b16 a[158:159], v10 offset:2400
    s_waitcnt lgkmcnt(14)
    v_mfma_f32_16x16x32_bf16 v[32:35], a[196:199], a[104:107], v[32:35]
    ds_read_b64_tr_b16 a[160:161], v9 offset:128
    v_mfma_f32_16x16x32_bf16 v[68:71], a[196:199], a[108:111], v[68:71]
    ds_read_b64_tr_b16 a[162:163], v9 offset:2432
    v_mfma_f32_16x16x32_bf16 v[36:39], a[200:203], a[104:107], v[36:39]
    ds_read_b64_tr_b16 a[164:165], v10 offset:160
    v_mfma_f32_16x16x32_bf16 v[72:75], a[200:203], a[108:111], v[72:75]
    ds_read_b64_tr_b16 a[166:167], v10 offset:2464
    s_waitcnt lgkmcnt(14)
    v_mfma_f32_16x16x32_bf16 v[40:43], a[204:207], a[104:107], v[40:43]
    ds_read_b64_tr_b16 a[168:169], v9 offset:192
    v_mfma_f32_16x16x32_bf16 v[76:79], a[204:207], a[108:111], v[76:79]
    ds_read_b64_tr_b16 a[170:171], v9 offset:2496
    v_mfma_f32_16x16x32_bf16 v[44:47], a[208:211], a[104:107], v[44:47]
    ds_read_b64_tr_b16 a[172:173], v10 offset:224
    v_mfma_f32_16x16x32_bf16 v[80:83], a[208:211], a[108:111], v[80:83]
    ds_read_b64_tr_b16 a[174:175], v10 offset:2528
    s_waitcnt lgkmcnt(15)
    v_mfma_f32_16x16x32_bf16 v[48:51], a[212:215], a[104:107], v[48:51]
    ds_read_b64_tr_b16 a[176:177], v9 offset:256
    v_mfma_f32_16x16x32_bf16 v[84:87], a[212:215], a[108:111], v[84:87]
    ds_read_b64_tr_b16 a[178:179], v9 offset:2560
    s_waitcnt lgkmcnt(14)
    v_mfma_f32_16x16x32_bf16 v[16:19], a[144:147], a[112:115], v[16:19]
    ds_read_b64_tr_b16 a[180:181], v10 offset:288
    v_mfma_f32_16x16x32_bf16 v[52:55], a[144:147], a[116:119], v[52:55]
    ds_read_b64_tr_b16 a[182:183], v10 offset:2592
    v_mfma_f32_16x16x32_bf16 v[20:23], a[148:151], a[112:115], v[20:23]
    ds_read_b64_tr_b16 a[184:185], v9 offset:320
    v_mfma_f32_16x16x32_bf16 v[56:59], a[148:151], a[116:119], v[56:59]
    ds_read_b64_tr_b16 a[186:187], v9 offset:2624
    s_waitcnt lgkmcnt(14)
    v_mfma_f32_16x16x32_bf16 v[24:27], a[152:155], a[112:115], v[24:27]
    ds_read_b64_tr_b16 a[188:189], v10 offset:352
    v_mfma_f32_16x16x32_bf16 v[60:63], a[152:155], a[116:119], v[60:63]
    ds_read_b64_tr_b16 a[190:191], v10 offset:2656
    v_mfma_f32_16x16x32_bf16 v[28:31], a[156:159], a[112:115], v[28:31]
    ds_read_b64_tr_b16 a[192:193], v9 offset:384
    v_mfma_f32_16x16x32_bf16 v[64:67], a[156:159], a[116:119], v[64:67]
    ds_read_b64_tr_b16 a[194:195], v9 offset:2688
    s_waitcnt lgkmcnt(14)
    v_mfma_f32_16x16x32_bf16 v[32:35], a[160:163], a[112:115], v[32:35]
    ds_read_b64_tr_b16 a[196:197], v10 offset:416
    v_mfma_f32_16x16x32_bf16 v[68:71], a[160:163], a[116:119], v[68:71]
    ds_read_b64_tr_b16 a[198:199], v10 offset:2720
    v_mfma_f32_16x16x32_bf16 v[36:39], a[164:167], a[112:115], v[36:39]
    ds_read_b64_tr_b16 a[200:201], v9 offset:448
    v_mfma_f32_16x16x32_bf16 v[72:75], a[164:167], a[116:119], v[72:75]
    ds_read_b64_tr_b16 a[202:203], v9 offset:2752
    s_waitcnt lgkmcnt(14)
    v_mfma_f32_16x16x32_bf16 v[40:43], a[168:171], a[112:115], v[40:43]
    ds_read_b64_tr_b16 a[204:205], v10 offset:480
    v_mfma_f32_16x16x32_bf16 v[76:79], a[168:171], a[116:119], v[76:79]
    ds_read_b64_tr_b16 a[206:207], v10 offset:2784
    v_mfma_f32_16x16x32_bf16 v[44:47], a[172:175], a[112:115], v[44:47]
    ds_read_b64_tr_b16 a[208:209], v9 offset:512
    v_mfma_f32_16x16x32_bf16 v[80:83], a[172:175], a[116:119], v[80:83]
    ds_read_b64_tr_b16 a[210:211], v9 offset:2816
    s_waitcnt lgkmcnt(15)
    v_mfma_f32_16x16x32_bf16 v[48:51], a[176:179], a[112:115], v[48:51]
    ds_read_b64_tr_b16 a[212:213], v10 offset:544
    v_mfma_f32_16x16x32_bf16 v[84:87], a[176:179], a[116:119], v[84:87]
    ds_read_b64_tr_b16 a[214:215], v10 offset:2848
    s_waitcnt vmcnt(0)
    s_barrier
    v_add_u32 v9, 40960, v7
    v_add_u32 v10, 40960, v8
    s_waitcnt lgkmcnt(14)
    v_mfma_f32_16x16x32_bf16 v[16:19], a[180:183], a[120:123], v[16:19]
    ds_read_b64_tr_b16 a[144:145], v9 offset:0
    v_mfma_f32_16x16x32_bf16 v[52:55], a[180:183], a[124:127], v[52:55]
    ds_read_b64_tr_b16 a[146:147], v9 offset:2304
    v_mfma_f32_16x16x32_bf16 v[20:23], a[184:187], a[120:123], v[20:23]
    ds_read_b64_tr_b16 a[148:149], v10 offset:32
    v_mfma_f32_16x16x32_bf16 v[56:59], a[184:187], a[124:127], v[56:59]
    ds_read_b64_tr_b16 a[150:151], v10 offset:2336
    s_waitcnt lgkmcnt(14)
    v_mfma_f32_16x16x32_bf16 v[24:27], a[188:191], a[120:123], v[24:27]
    ds_read_b64_tr_b16 a[152:153], v9 offset:64
    v_mfma_f32_16x16x32_bf16 v[60:63], a[188:191], a[124:127], v[60:63]
    ds_read_b64_tr_b16 a[154:155], v9 offset:2368
    v_mfma_f32_16x16x32_bf16 v[28:31], a[192:195], a[120:123], v[28:31]
    ds_read_b64_tr_b16 a[156:157], v10 offset:96
    v_mfma_f32_16x16x32_bf16 v[64:67], a[192:195], a[124:127], v[64:67]
    ds_read_b64_tr_b16 a[158:159], v10 offset:2400
    s_waitcnt lgkmcnt(14)
    v_mfma_f32_16x16x32_bf16 v[32:35], a[196:199], a[120:123], v[32:35]
    ds_read_b64_tr_b16 a[160:161], v9 offset:128
    v_mfma_f32_16x16x32_bf16 v[68:71], a[196:199], a[124:127], v[68:71]
    ds_read_b64_tr_b16 a[162:163], v9 offset:2432
    v_mfma_f32_16x16x32_bf16 v[36:39], a[200:203], a[120:123], v[36:39]
    ds_read_b64_tr_b16 a[164:165], v10 offset:160
    v_mfma_f32_16x16x32_bf16 v[72:75], a[200:203], a[124:127], v[72:75]
    ds_read_b64_tr_b16 a[166:167], v10 offset:2464
    s_waitcnt lgkmcnt(14)
    v_mfma_f32_16x16x32_bf16 v[40:43], a[204:207], a[120:123], v[40:43]
    ds_read_b64_tr_b16 a[168:169], v9 offset:192
    v_mfma_f32_16x16x32_bf16 v[76:79], a[204:207], a[124:127], v[76:79]
    ds_read_b64_tr_b16 a[170:171], v9 offset:2496
    v_mfma_f32_16x16x32_bf16 v[44:47], a[208:211], a[120:123], v[44:47]
    ds_read_b64_tr_b16 a[172:173], v10 offset:224
    v_mfma_f32_16x16x32_bf16 v[80:83], a[208:211], a[124:127], v[80:83]
    ds_read_b64_tr_b16 a[174:175], v10 offset:2528
    s_waitcnt lgkmcnt(15)
    v_mfma_f32_16x16x32_bf16 v[48:51], a[212:215], a[120:123], v[48:51]
    ds_read_b64_tr_b16 a[176:177], v9 offset:256
    v_mfma_f32_16x16x32_bf16 v[84:87], a[212:215], a[124:127], v[84:87]
    ds_read_b64_tr_b16 a[178:179], v9 offset:2560
    s_waitcnt lgkmcnt(14)
    v_mfma_f32_16x16x32_bf16 v[16:19], a[144:147], a[128:131], v[16:19]
    ds_read_b64_tr_b16 a[180:181], v10 offset:288
    v_mfma_f32_16x16x32_bf16 v[52:55], a[144:147], a[132:135], v[52:55]
    ds_read_b64_tr_b16 a[182:183], v10 offset:2592
    v_mfma_f32_16x16x32_bf16 v[20:23], a[148:151], a[128:131], v[20:23]
    ds_read_b64_tr_b16 a[184:185], v9 offset:320
    v_mfma_f32_16x16x32_bf16 v[56:59], a[148:151], a[132:135], v[56:59]
    ds_read_b64_tr_b16 a[186:187], v9 offset:2624
    s_waitcnt lgkmcnt(14)
    v_mfma_f32_16x16x32_bf16 v[24:27], a[152:155], a[128:131], v[24:27]
    ds_read_b64_tr_b16 a[188:189], v10 offset:352
    v_mfma_f32_16x16x32_bf16 v[60:63], a[152:155], a[132:135], v[60:63]
    ds_read_b64_tr_b16 a[190:191], v10 offset:2656
    v_mfma_f32_16x16x32_bf16 v[28:31], a[156:159], a[128:131], v[28:31]
    ds_read_b64_tr_b16 a[192:193], v9 offset:384
    v_mfma_f32_16x16x32_bf16 v[64:67], a[156:159], a[132:135], v[64:67]
    ds_read_b64_tr_b16 a[194:195], v9 offset:2688
    s_waitcnt lgkmcnt(14)
    v_mfma_f32_16x16x32_bf16 v[32:35], a[160:163], a[128:131], v[32:35]
    ds_read_b64_tr_b16 a[196:197], v10 offset:416
    v_mfma_f32_16x16x32_bf16 v[68:71], a[160:163], a[132:135], v[68:71]
    ds_read_b64_tr_b16 a[198:199], v10 offset:2720
    v_mfma_f32_16x16x32_bf16 v[36:39], a[164:167], a[128:131], v[36:39]
    ds_read_b64_tr_b16 a[200:201], v9 offset:448
    v_mfma_f32_16x16x32_bf16 v[72:75], a[164:167], a[132:135], v[72:75]
    ds_read_b64_tr_b16 a[202:203], v9 offset:2752
    s_waitcnt lgkmcnt(14)
    v_mfma_f32_16x16x32_bf16 v[40:43], a[168:171], a[128:131], v[40:43]
    ds_read_b64_tr_b16 a[204:205], v10 offset:480
    v_mfma_f32_16x16x32_bf16 v[76:79], a[168:171], a[132:135], v[76:79]
    ds_read_b64_tr_b16 a[206:207], v10 offset:2784
    v_mfma_f32_16x16x32_bf16 v[44:47], a[172:175], a[128:131], v[44:47]
    ds_read_b64_tr_b16 a[208:209], v9 offset:512
    v_mfma_f32_16x16x32_bf16 v[80:83], a[172:175], a[132:135], v[80:83]
    ds_read_b64_tr_b16 a[210:211], v9 offset:2816
    s_waitcnt lgkmcnt(15)
    v_mfma_f32_16x16x32_bf16 v[48:51], a[176:179], a[128:131], v[48:51]
    ds_read_b64_tr_b16 a[212:213], v10 offset:544
    v_mfma_f32_16x16x32_bf16 v[84:87], a[176:179], a[132:135], v[84:87]
    ds_read_b64_tr_b16 a[214:215], v10 offset:2848
    s_waitcnt lgkmcnt(14)
    v_mfma_f32_16x16x32_bf16 v[16:19], a[180:183], a[136:139], v[16:19]
    v_mfma_f32_16x16x32_bf16 v[52:55], a[180:183], a[140:143], v[52:55]
    v_mfma_f32_16x16x32_bf16 v[20:23], a[184:187], a[136:139], v[20:23]
    v_mfma_f32_16x16x32_bf16 v[56:59], a[184:187], a[140:143], v[56:59]
    s_waitcnt lgkmcnt(10)
    v_mfma_f32_16x16x32_bf16 v[24:27], a[188:191], a[136:139], v[24:27]
    v_mfma_f32_16x16x32_bf16 v[60:63], a[188:191], a[140:143], v[60:63]
    v_mfma_f32_16x16x32_bf16 v[28:31], a[192:195], a[136:139], v[28:31]
    v_mfma_f32_16x16x32_bf16 v[64:67], a[192:195], a[140:143], v[64:67]
    s_waitcnt lgkmcnt(6)
    v_mfma_f32_16x16x32_bf16 v[32:35], a[196:199], a[136:139], v[32:35]
    v_mfma_f32_16x16x32_bf16 v[68:71], a[196:199], a[140:143], v[68:71]
    v_mfma_f32_16x16x32_bf16 v[36:39], a[200:203], a[136:139], v[36:39]
    v_mfma_f32_16x16x32_bf16 v[72:75], a[200:203], a[140:143], v[72:75]
    s_waitcnt lgkmcnt(2)
    v_mfma_f32_16x16x32_bf16 v[40:43], a[204:207], a[136:139], v[40:43]
    v_mfma_f32_16x16x32_bf16 v[76:79], a[204:207], a[140:143], v[76:79]
    v_mfma_f32_16x16x32_bf16 v[44:47], a[208:211], a[136:139], v[44:47]
    v_mfma_f32_16x16x32_bf16 v[80:83], a[208:211], a[140:143], v[80:83]
    s_waitcnt lgkmcnt(0)
    v_mfma_f32_16x16x32_bf16 v[48:51], a[212:215], a[136:139], v[48:51]
    v_mfma_f32_16x16x32_bf16 v[84:87], a[212:215], a[140:143], v[84:87]
    s_add_u32 s4, s32, 54525952
    s_addc_u32 s5, s33, 0
    s_and_b32 s5, s5, 0xffff
    s_mov_b32 s6, 8388608
    s_mov_b32 s7, 0x00020000
    s_mul_i32 s44, s35, 589824
    s_add_u32 s44, s44, 18874368
    s_add_u32 s8, s32, s44
    s_addc_u32 s9, s33, 0
    s_and_b32 s9, s9, 0xffff
    s_mov_b32 s10, 589824
    s_mov_b32 s11, 0x00020000
    s_lshl_b32 s44, s34, 7
    s_lshl_b32 s45, s36, 5
    s_add_u32 s44, s44, s45
    v_lshlrev_b32 v1, 4, v15
    s_lshl_b32 s46, s44, 12
    v_add_u32 v2, s46, v1
    v_add_u32 v3, 0x10000, v2
    s_mul_i32 s45, s36, 9216
    v_add_u32 v4, s45, v1
    v_add_u32 v5, 0x1000, v4
    v_add_u32 v6, 0x2000, v4
    s_mov_b32 s40, s45
    s_add_u32 s41, s45, 36864
    s_add_u32 s42, s45, 73728
    s_add_u32 s43, s45, 110592

    s_cmp_eq_u32 s36, 0
    s_cbranch_scc0 m_kernel_g2_w2_18
    s_add_u32 s24, s32, 49283072
    s_addc_u32 s25, s33, 0
    s_and_b32 s25, s25, 0xffff
    s_mov_b32 s26, 524288
    s_mov_b32 s27, 0x00020000
    s_add_u32 s44, s35, 0
    s_lshl_b32 s44, s44, 6
    s_add_u32 s44, s44, 0
    s_lshl_b32 s44, s44, 7
    s_mov_b32 s47, s44
    s_add_u32 s44, s34, 16
    s_lshl_b32 s44, s44, 6
    s_add_u32 s44, s44, 0
    s_lshl_b32 s44, s44, 7
    v_mov_b32 v250, s47
    v_mov_b32 v251, s44
    v_cmp_gt_u32 vcc, 16, v15
    s_nop 1
    v_cndmask_b32 v250, v251, v250, vcc
    v_and_b32 v251, 15, v15
    v_lshlrev_b32 v251, 7, v251
    v_add_u32 v250, v250, v251
m_kernel_g2_p2_19:
    buffer_load_dword v251, v250, s[24:27], 0 offen sc1
    s_waitcnt vmcnt(0)
    v_cmp_eq_u32 s[48:49], 1, v251
    s_cmp_eq_u32 s48, -1
    s_cbranch_scc1 m_kernel_g2_w2_18
    s_sleep 1
    s_branch m_kernel_g2_p2_19
m_kernel_g2_w2_18:
    s_barrier
    s_mov_b32 s38, 0
    s_mov_b32 s39, 0
    s_add_u32 m0, s40, 0
    s_nop 0
    buffer_load_dwordx4 v4, s[8:11], s38 offen offset:0 sc1 lds
    buffer_load_dwordx4 a[0:3], v2, s[4:7], s39 offen offset:0 sc1
    buffer_load_dwordx4 v4, s[8:11], s38 offen offset:1024 sc1 lds
    buffer_load_dwordx4 a[4:7], v3, s[4:7], s39 offen offset:0 sc1
    buffer_load_dwordx4 v4, s[8:11], s38 offen offset:2048 sc1 lds
    buffer_load_dwordx4 a[8:11], v2, s[4:7], s39 offen offset:1024 sc1
    buffer_load_dwordx4 v4, s[8:11], s38 offen offset:3072 sc1 lds
    buffer_load_dwordx4 a[12:15], v3, s[4:7], s39 offen offset:1024 sc1
    s_add_u32 m0, s40, 4096
    s_nop 0
    buffer_load_dwordx4 v5, s[8:11], s38 offen offset:0 sc1 lds
    buffer_load_dwordx4 a[16:19], v2, s[4:7], s39 offen offset:2048 sc1
    buffer_load_dwordx4 v5, s[8:11], s38 offen offset:1024 sc1 lds
    buffer_load_dwordx4 a[20:23], v3, s[4:7], s39 offen offset:2048 sc1
    buffer_load_dwordx4 v5, s[8:11], s38 offen offset:2048 sc1 lds
    buffer_load_dwordx4 a[24:27], v2, s[4:7], s39 offen offset:3072 sc1
    buffer_load_dwordx4 v5, s[8:11], s38 offen offset:3072 sc1 lds
    buffer_load_dwordx4 a[28:31], v3, s[4:7], s39 offen offset:3072 sc1
    s_add_u32 m0, s40, 8192
    s_nop 0
    buffer_load_dwordx4 v6, s[8:11], s38 offen offset:0 sc1 lds
    s_add_u32 s38, s38, 36864
    s_add_u32 s39, s39, 4096
    s_nop 7
    v_pk_mul_f32 v[206:207], v[16:17], v[16:17]
    v_pk_mul_f32 v[208:209], v[18:19], v[18:19]
    v_pk_mul_f32 v[210:211], v[20:21], v[20:21]
    v_pk_mul_f32 v[212:213], v[22:23], v[22:23]
    v_pk_mul_f32 v[214:215], v[24:25], v[24:25]
    v_pk_mul_f32 v[216:217], v[26:27], v[26:27]
    v_pk_fma_f32 v[206:207], v[206:207], v[202:203], v[200:201]
    v_pk_fma_f32 v[208:209], v[208:209], v[202:203], v[200:201]
    v_pk_fma_f32 v[210:211], v[210:211], v[202:203], v[200:201]
    v_pk_fma_f32 v[212:213], v[212:213], v[202:203], v[200:201]
    v_pk_fma_f32 v[214:215], v[214:215], v[202:203], v[200:201]
    s_add_u32 m0, s41, 0
    s_nop 0
    buffer_load_dwordx4 v4, s[8:11], s38 offen offset:0 sc1 lds
    v_pk_fma_f32 v[216:217], v[216:217], v[202:203], v[200:201]
    v_pk_mul_f32 v[206:207], v[206:207], v[16:17]
    v_pk_mul_f32 v[208:209], v[208:209], v[18:19]
    v_pk_mul_f32 v[210:211], v[210:211], v[20:21]
    v_pk_mul_f32 v[212:213], v[212:213], v[22:23]
    v_pk_mul_f32 v[214:215], v[214:215], v[24:25]
    v_pk_mul_f32 v[216:217], v[216:217], v[26:27]
    v_exp_f32 v206, v206
    v_exp_f32 v208, v208
    v_exp_f32 v210, v210
    v_exp_f32 v212, v212
    buffer_load_dwordx4 a[32:35], v2, s[4:7], s39 offen offset:0 sc1
    v_exp_f32 v214, v214
    v_exp_f32 v216, v216
    v_exp_f32 v207, v207
    v_exp_f32 v209, v209
    v_exp_f32 v211, v211
    v_exp_f32 v213, v213
    v_exp_f32 v215, v215
    v_exp_f32 v217, v217
    v_pk_add_f32 v[206:207], v[206:207], v[204:205]
    v_pk_add_f32 v[208:209], v[208:209], v[204:205]
    v_pk_add_f32 v[210:211], v[210:211], v[204:205]
    buffer_load_dwordx4 v4, s[8:11], s38 offen offset:1024 sc1 lds
    v_pk_add_f32 v[212:213], v[212:213], v[204:205]
    v_pk_add_f32 v[214:215], v[214:215], v[204:205]
    v_pk_add_f32 v[216:217], v[216:217], v[204:205]
    v_rcp_f32 v206, v206
    v_rcp_f32 v208, v208
    v_rcp_f32 v210, v210
    v_rcp_f32 v212, v212
    v_rcp_f32 v214, v214
    v_rcp_f32 v216, v216
    v_rcp_f32 v207, v207
    v_rcp_f32 v209, v209
    buffer_load_dwordx4 a[36:39], v3, s[4:7], s39 offen offset:0 sc1
    v_rcp_f32 v211, v211
    v_rcp_f32 v213, v213
    v_rcp_f32 v215, v215
    v_rcp_f32 v217, v217
    v_pk_mul_f32 v[16:17], v[16:17], v[206:207]
    v_pk_mul_f32 v[18:19], v[18:19], v[208:209]
    v_pk_mul_f32 v[20:21], v[20:21], v[210:211]
    v_pk_mul_f32 v[22:23], v[22:23], v[212:213]
    v_pk_mul_f32 v[24:25], v[24:25], v[214:215]
    v_pk_mul_f32 v[26:27], v[26:27], v[216:217]
    v_cvt_pk_bf16_f32 v88, v16, v17
    v_cvt_pk_bf16_f32 v89, v18, v19
    v_cvt_pk_bf16_f32 v90, v20, v21
    v_cvt_pk_bf16_f32 v91, v22, v23
    v_cvt_pk_bf16_f32 v92, v24, v25
    v_cvt_pk_bf16_f32 v93, v26, v27
    v_accvgpr_write_b32 a128, v88
    v_accvgpr_write_b32 a129, v89
    v_accvgpr_write_b32 a130, v90
    v_accvgpr_write_b32 a131, v91
    v_accvgpr_write_b32 a132, v92
    v_accvgpr_write_b32 a133, v93
    v_pk_mul_f32 v[206:207], v[28:29], v[28:29]
    buffer_load_dwordx4 v4, s[8:11], s38 offen offset:2048 sc1 lds
    v_pk_mul_f32 v[208:209], v[30:31], v[30:31]
    v_pk_mul_f32 v[210:211], v[32:33], v[32:33]
    v_pk_mul_f32 v[212:213], v[34:35], v[34:35]
    v_pk_mul_f32 v[214:215], v[36:37], v[36:37]
    v_pk_mul_f32 v[216:217], v[38:39], v[38:39]
    v_pk_fma_f32 v[206:207], v[206:207], v[202:203], v[200:201]
    v_pk_fma_f32 v[208:209], v[208:209], v[202:203], v[200:201]
    v_pk_fma_f32 v[210:211], v[210:211], v[202:203], v[200:201]
    v_pk_fma_f32 v[212:213], v[212:213], v[202:203], v[200:201]
    v_pk_fma_f32 v[214:215], v[214:215], v[202:203], v[200:201]
    v_pk_fma_f32 v[216:217], v[216:217], v[202:203], v[200:201]
    buffer_load_dwordx4 a[40:43], v2, s[4:7], s39 offen offset:1024 sc1
    v_pk_mul_f32 v[206:207], v[206:207], v[28:29]
    v_pk_mul_f32 v[208:209], v[208:209], v[30:31]
    v_pk_mul_f32 v[210:211], v[210:211], v[32:33]
    v_pk_mul_f32 v[212:213], v[212:213], v[34:35]
    v_pk_mul_f32 v[214:215], v[214:215], v[36:37]
    v_pk_mul_f32 v[216:217], v[216:217], v[38:39]
    v_exp_f32 v206, v206
    v_exp_f32 v208, v208
    v_exp_f32 v210, v210
    v_exp_f32 v212, v212
    v_exp_f32 v214, v214
    buffer_load_dwordx4 v4, s[8:11], s38 offen offset:3072 sc1 lds
    v_exp_f32 v216, v216
    v_exp_f32 v207, v207
    v_exp_f32 v209, v209
    v_exp_f32 v211, v211
    v_exp_f32 v213, v213
    v_exp_f32 v215, v215
    v_exp_f32 v217, v217
    v_pk_add_f32 v[206:207], v[206:207], v[204:205]
    v_pk_add_f32 v[208:209], v[208:209], v[204:205]
    v_pk_add_f32 v[210:211], v[210:211], v[204:205]
    v_pk_add_f32 v[212:213], v[212:213], v[204:205]
    buffer_load_dwordx4 a[44:47], v3, s[4:7], s39 offen offset:1024 sc1
    v_pk_add_f32 v[214:215], v[214:215], v[204:205]
    v_pk_add_f32 v[216:217], v[216:217], v[204:205]
    v_rcp_f32 v206, v206
    v_rcp_f32 v208, v208
    v_rcp_f32 v210, v210
    v_rcp_f32 v212, v212
    v_rcp_f32 v214, v214
    v_rcp_f32 v216, v216
    v_rcp_f32 v207, v207
    v_rcp_f32 v209, v209
    v_rcp_f32 v211, v211
    s_add_u32 m0, s41, 4096
    s_nop 0
    buffer_load_dwordx4 v5, s[8:11], s38 offen offset:0 sc1 lds
    v_rcp_f32 v213, v213
    v_rcp_f32 v215, v215
    v_rcp_f32 v217, v217
    v_pk_mul_f32 v[28:29], v[28:29], v[206:207]
    v_pk_mul_f32 v[30:31], v[30:31], v[208:209]
    v_pk_mul_f32 v[32:33], v[32:33], v[210:211]
    v_pk_mul_f32 v[34:35], v[34:35], v[212:213]
    v_pk_mul_f32 v[36:37], v[36:37], v[214:215]
    v_pk_mul_f32 v[38:39], v[38:39], v[216:217]
    v_cvt_pk_bf16_f32 v94, v28, v29
    v_cvt_pk_bf16_f32 v95, v30, v31
    v_cvt_pk_bf16_f32 v96, v32, v33
    v_cvt_pk_bf16_f32 v97, v34, v35
    v_cvt_pk_bf16_f32 v98, v36, v37
    v_cvt_pk_bf16_f32 v99, v38, v39
    v_accvgpr_write_b32 a134, v94
    v_accvgpr_write_b32 a135, v95
    v_accvgpr_write_b32 a136, v96
    v_accvgpr_write_b32 a137, v97
    v_accvgpr_write_b32 a138, v98
    v_accvgpr_write_b32 a139, v99
    v_pk_mul_f32 v[206:207], v[40:41], v[40:41]
    v_pk_mul_f32 v[208:209], v[42:43], v[42:43]
    buffer_load_dwordx4 a[48:51], v2, s[4:7], s39 offen offset:2048 sc1
    v_pk_mul_f32 v[210:211], v[44:45], v[44:45]
    v_pk_mul_f32 v[212:213], v[46:47], v[46:47]
    v_pk_mul_f32 v[214:215], v[48:49], v[48:49]
    v_pk_mul_f32 v[216:217], v[50:51], v[50:51]
    v_pk_fma_f32 v[206:207], v[206:207], v[202:203], v[200:201]
    v_pk_fma_f32 v[208:209], v[208:209], v[202:203], v[200:201]
    v_pk_fma_f32 v[210:211], v[210:211], v[202:203], v[200:201]
    v_pk_fma_f32 v[212:213], v[212:213], v[202:203], v[200:201]
    v_pk_fma_f32 v[214:215], v[214:215], v[202:203], v[200:201]
    v_pk_fma_f32 v[216:217], v[216:217], v[202:203], v[200:201]
    v_pk_mul_f32 v[206:207], v[206:207], v[40:41]
    buffer_load_dwordx4 v5, s[8:11], s38 offen offset:1024 sc1 lds
    v_pk_mul_f32 v[208:209], v[208:209], v[42:43]
    v_pk_mul_f32 v[210:211], v[210:211], v[44:45]
    v_pk_mul_f32 v[212:213], v[212:213], v[46:47]
    v_pk_mul_f32 v[214:215], v[214:215], v[48:49]
    v_pk_mul_f32 v[216:217], v[216:217], v[50:51]
    v_exp_f32 v206, v206
    v_exp_f32 v208, v208
    v_exp_f32 v210, v210
    v_exp_f32 v212, v212
    v_exp_f32 v214, v214
    v_exp_f32 v216, v216
    buffer_load_dwordx4 a[52:55], v3, s[4:7], s39 offen offset:2048 sc1
    v_exp_f32 v207, v207
    v_exp_f32 v209, v209
    v_exp_f32 v211, v211
    v_exp_f32 v213, v213
    v_exp_f32 v215, v215
    v_exp_f32 v217, v217
    v_pk_add_f32 v[206:207], v[206:207], v[204:205]
    v_pk_add_f32 v[208:209], v[208:209], v[204:205]
    v_pk_add_f32 v[210:211], v[210:211], v[204:205]
    v_pk_add_f32 v[212:213], v[212:213], v[204:205]
    v_pk_add_f32 v[214:215], v[214:215], v[204:205]
    buffer_load_dwordx4 v5, s[8:11], s38 offen offset:2048 sc1 lds
    v_pk_add_f32 v[216:217], v[216:217], v[204:205]
    v_rcp_f32 v206, v206
    v_rcp_f32 v208, v208
    v_rcp_f32 v210, v210
    v_rcp_f32 v212, v212
    v_rcp_f32 v214, v214
    v_rcp_f32 v216, v216
    v_rcp_f32 v207, v207
    v_rcp_f32 v209, v209
    v_rcp_f32 v211, v211
    v_rcp_f32 v213, v213
    buffer_load_dwordx4 a[56:59], v2, s[4:7], s39 offen offset:3072 sc1
    v_rcp_f32 v215, v215
    v_rcp_f32 v217, v217
    v_pk_mul_f32 v[40:41], v[40:41], v[206:207]
    v_pk_mul_f32 v[42:43], v[42:43], v[208:209]
    v_pk_mul_f32 v[44:45], v[44:45], v[210:211]
    v_pk_mul_f32 v[46:47], v[46:47], v[212:213]
    v_pk_mul_f32 v[48:49], v[48:49], v[214:215]
    v_pk_mul_f32 v[50:51], v[50:51], v[216:217]
    v_cvt_pk_bf16_f32 v100, v40, v41
    v_cvt_pk_bf16_f32 v101, v42, v43
    v_cvt_pk_bf16_f32 v102, v44, v45
    v_cvt_pk_bf16_f32 v103, v46, v47
    v_cvt_pk_bf16_f32 v104, v48, v49
    v_cvt_pk_bf16_f32 v105, v50, v51
    v_accvgpr_write_b32 a140, v100
    v_accvgpr_write_b32 a141, v101
    v_accvgpr_write_b32 a142, v102
    v_accvgpr_write_b32 a143, v103
    v_accvgpr_write_b32 a144, v104
    v_accvgpr_write_b32 a145, v105
    v_pk_mul_f32 v[206:207], v[52:53], v[52:53]
    v_pk_mul_f32 v[208:209], v[54:55], v[54:55]
    v_pk_mul_f32 v[210:211], v[56:57], v[56:57]
    buffer_load_dwordx4 v5, s[8:11], s38 offen offset:3072 sc1 lds
    v_pk_mul_f32 v[212:213], v[58:59], v[58:59]
    v_pk_mul_f32 v[214:215], v[60:61], v[60:61]
    v_pk_mul_f32 v[216:217], v[62:63], v[62:63]
    v_pk_fma_f32 v[206:207], v[206:207], v[202:203], v[200:201]
    v_pk_fma_f32 v[208:209], v[208:209], v[202:203], v[200:201]
    v_pk_fma_f32 v[210:211], v[210:211], v[202:203], v[200:201]
    v_pk_fma_f32 v[212:213], v[212:213], v[202:203], v[200:201]
    v_pk_fma_f32 v[214:215], v[214:215], v[202:203], v[200:201]
    v_pk_fma_f32 v[216:217], v[216:217], v[202:203], v[200:201]
    v_pk_mul_f32 v[206:207], v[206:207], v[52:53]
    v_pk_mul_f32 v[208:209], v[208:209], v[54:55]
    buffer_load_dwordx4 a[60:63], v3, s[4:7], s39 offen offset:3072 sc1
    v_pk_mul_f32 v[210:211], v[210:211], v[56:57]
    v_pk_mul_f32 v[212:213], v[212:213], v[58:59]
    v_pk_mul_f32 v[214:215], v[214:215], v[60:61]
    v_pk_mul_f32 v[216:217], v[216:217], v[62:63]
    v_exp_f32 v206, v206
    v_exp_f32 v208, v208
    v_exp_f32 v210, v210
    v_exp_f32 v212, v212
    v_exp_f32 v214, v214
    v_exp_f32 v216, v216
    v_exp_f32 v207, v207
    s_add_u32 m0, s41, 8192
    s_nop 0
    buffer_load_dwordx4 v6, s[8:11], s38 offen offset:0 sc1 lds
    s_add_u32 s38, s38, 36864
    s_add_u32 s39, s39, 4096
    v_exp_f32 v209, v209
    v_exp_f32 v211, v211
    v_exp_f32 v213, v213
    v_exp_f32 v215, v215
    v_exp_f32 v217, v217
    v_pk_add_f32 v[206:207], v[206:207], v[204:205]
    v_pk_add_f32 v[208:209], v[208:209], v[204:205]
    v_pk_add_f32 v[210:211], v[210:211], v[204:205]
    v_pk_add_f32 v[212:213], v[212:213], v[204:205]
    v_pk_add_f32 v[214:215], v[214:215], v[204:205]
    v_pk_add_f32 v[216:217], v[216:217], v[204:205]
    s_add_u32 m0, s42, 0
    s_nop 0
    buffer_load_dwordx4 v4, s[8:11], s38 offen offset:0 sc1 lds
    v_rcp_f32 v206, v206
    v_rcp_f32 v208, v208
    v_rcp_f32 v210, v210
    v_rcp_f32 v212, v212
    v_rcp_f32 v214, v214
    v_rcp_f32 v216, v216
    v_rcp_f32 v207, v207
    v_rcp_f32 v209, v209
    v_rcp_f32 v211, v211
    v_rcp_f32 v213, v213
    v_rcp_f32 v215, v215
    buffer_load_dwordx4 a[64:67], v2, s[4:7], s39 offen offset:0 sc1
    v_rcp_f32 v217, v217
    v_pk_mul_f32 v[52:53], v[52:53], v[206:207]
    v_pk_mul_f32 v[54:55], v[54:55], v[208:209]
    v_pk_mul_f32 v[56:57], v[56:57], v[210:211]
    v_pk_mul_f32 v[58:59], v[58:59], v[212:213]
    v_pk_mul_f32 v[60:61], v[60:61], v[214:215]
    v_pk_mul_f32 v[62:63], v[62:63], v[216:217]
    v_cvt_pk_bf16_f32 v106, v52, v53
    v_cvt_pk_bf16_f32 v107, v54, v55
    v_cvt_pk_bf16_f32 v108, v56, v57
    v_cvt_pk_bf16_f32 v109, v58, v59
    v_cvt_pk_bf16_f32 v110, v60, v61
    v_cvt_pk_bf16_f32 v111, v62, v63
    v_accvgpr_write_b32 a146, v106
    v_accvgpr_write_b32 a147, v107
    v_accvgpr_write_b32 a148, v108
    v_accvgpr_write_b32 a149, v109
    v_accvgpr_write_b32 a150, v110
    v_accvgpr_write_b32 a151, v111
    v_pk_mul_f32 v[206:207], v[64:65], v[64:65]
    v_pk_mul_f32 v[208:209], v[66:67], v[66:67]
    v_pk_mul_f32 v[210:211], v[68:69], v[68:69]
    v_pk_mul_f32 v[212:213], v[70:71], v[70:71]
    buffer_load_dwordx4 v4, s[8:11], s38 offen offset:1024 sc1 lds
    v_pk_mul_f32 v[214:215], v[72:73], v[72:73]
    v_pk_mul_f32 v[216:217], v[74:75], v[74:75]
    v_pk_fma_f32 v[206:207], v[206:207], v[202:203], v[200:201]
    v_pk_fma_f32 v[208:209], v[208:209], v[202:203], v[200:201]
    v_pk_fma_f32 v[210:211], v[210:211], v[202:203], v[200:201]
    v_pk_fma_f32 v[212:213], v[212:213], v[202:203], v[200:201]
    v_pk_fma_f32 v[214:215], v[214:215], v[202:203], v[200:201]
    v_pk_fma_f32 v[216:217], v[216:217], v[202:203], v[200:201]
    v_pk_mul_f32 v[206:207], v[206:207], v[64:65]
    v_pk_mul_f32 v[208:209], v[208:209], v[66:67]
    v_pk_mul_f32 v[210:211], v[210:211], v[68:69]
    buffer_load_dwordx4 a[68:71], v3, s[4:7], s39 offen offset:0 sc1
    v_pk_mul_f32 v[212:213], v[212:213], v[70:71]
    v_pk_mul_f32 v[214:215], v[214:215], v[72:73]
    v_pk_mul_f32 v[216:217], v[216:217], v[74:75]
    v_exp_f32 v206, v206
    v_exp_f32 v208, v208
    v_exp_f32 v210, v210
    v_exp_f32 v212, v212
    v_exp_f32 v214, v214
    v_exp_f32 v216, v216
    v_exp_f32 v207, v207
    v_exp_f32 v209, v209
    buffer_load_dwordx4 v4, s[8:11], s38 offen offset:2048 sc1 lds
    v_exp_f32 v211, v211
    v_exp_f32 v213, v213
    v_exp_f32 v215, v215
    v_exp_f32 v217, v217
    v_pk_add_f32 v[206:207], v[206:207], v[204:205]
    v_pk_add_f32 v[208:209], v[208:209], v[204:205]
    v_pk_add_f32 v[210:211], v[210:211], v[204:205]
    v_pk_add_f32 v[212:213], v[212:213], v[204:205]
    v_pk_add_f32 v[214:215], v[214:215], v[204:205]
    v_pk_add_f32 v[216:217], v[216:217], v[204:205]
    v_rcp_f32 v206, v206
    buffer_load_dwordx4 a[72:75], v2, s[4:7], s39 offen offset:1024 sc1
    v_rcp_f32 v208, v208
    v_rcp_f32 v210, v210
    v_rcp_f32 v212, v212
    v_rcp_f32 v214, v214
    v_rcp_f32 v216, v216
    v_rcp_f32 v207, v207
    v_rcp_f32 v209, v209
    v_rcp_f32 v211, v211
    v_rcp_f32 v213, v213
    v_rcp_f32 v215, v215
    v_rcp_f32 v217, v217
    buffer_load_dwordx4 v4, s[8:11], s38 offen offset:3072 sc1 lds
    v_pk_mul_f32 v[64:65], v[64:65], v[206:207]
    v_pk_mul_f32 v[66:67], v[66:67], v[208:209]
    v_pk_mul_f32 v[68:69], v[68:69], v[210:211]
    v_pk_mul_f32 v[70:71], v[70:71], v[212:213]
    v_pk_mul_f32 v[72:73], v[72:73], v[214:215]
    v_pk_mul_f32 v[74:75], v[74:75], v[216:217]
    v_cvt_pk_bf16_f32 v112, v64, v65
    v_cvt_pk_bf16_f32 v113, v66, v67
    v_cvt_pk_bf16_f32 v114, v68, v69
    v_cvt_pk_bf16_f32 v115, v70, v71
    v_cvt_pk_bf16_f32 v116, v72, v73
    v_cvt_pk_bf16_f32 v117, v74, v75
    v_accvgpr_write_b32 a152, v112
    v_accvgpr_write_b32 a153, v113
    v_accvgpr_write_b32 a154, v114
    v_accvgpr_write_b32 a155, v115
    v_accvgpr_write_b32 a156, v116
    v_accvgpr_write_b32 a157, v117
    v_pk_mul_f32 v[206:207], v[76:77], v[76:77]
    v_pk_mul_f32 v[208:209], v[78:79], v[78:79]
    v_pk_mul_f32 v[210:211], v[80:81], v[80:81]
    v_pk_mul_f32 v[212:213], v[82:83], v[82:83]
    v_pk_mul_f32 v[214:215], v[84:85], v[84:85]
    buffer_load_dwordx4 a[76:79], v3, s[4:7], s39 offen offset:1024 sc1
    v_pk_mul_f32 v[216:217], v[86:87], v[86:87]
    v_pk_fma_f32 v[206:207], v[206:207], v[202:203], v[200:201]
    v_pk_fma_f32 v[208:209], v[208:209], v[202:203], v[200:201]
    v_pk_fma_f32 v[210:211], v[210:211], v[202:203], v[200:201]
    v_pk_fma_f32 v[212:213], v[212:213], v[202:203], v[200:201]
    v_pk_fma_f32 v[214:215], v[214:215], v[202:203], v[200:201]
    v_pk_fma_f32 v[216:217], v[216:217], v[202:203], v[200:201]
    v_pk_mul_f32 v[206:207], v[206:207], v[76:77]
    v_pk_mul_f32 v[208:209], v[208:209], v[78:79]
    v_pk_mul_f32 v[210:211], v[210:211], v[80:81]
    v_pk_mul_f32 v[212:213], v[212:213], v[82:83]
    s_add_u32 m0, s42, 4096
    s_nop 0
    buffer_load_dwordx4 v5, s[8:11], s38 offen offset:0 sc1 lds
    v_pk_mul_f32 v[214:215], v[214:215], v[84:85]
    v_pk_mul_f32 v[216:217], v[216:217], v[86:87]
    v_exp_f32 v206, v206
    v_exp_f32 v208, v208
    v_exp_f32 v210, v210
    v_exp_f32 v212, v212
    v_exp_f32 v214, v214
    v_exp_f32 v216, v216
    v_exp_f32 v207, v207
    v_exp_f32 v209, v209
    v_exp_f32 v211, v211
    v_exp_f32 v213, v213
    v_exp_f32 v215, v215
    v_exp_f32 v217, v217
    v_pk_add_f32 v[206:207], v[206:207], v[204:205]
    v_pk_add_f32 v[208:209], v[208:209], v[204:205]
    v_pk_add_f32 v[210:211], v[210:211], v[204:205]
    v_pk_add_f32 v[212:213], v[212:213], v[204:205]
    v_pk_add_f32 v[214:215], v[214:215], v[204:205]
    v_pk_add_f32 v[216:217], v[216:217], v[204:205]
    v_rcp_f32 v206, v206
    v_rcp_f32 v208, v208
    v_rcp_f32 v210, v210
    v_rcp_f32 v212, v212
    v_rcp_f32 v214, v214
    v_rcp_f32 v216, v216
    v_rcp_f32 v207, v207
    v_rcp_f32 v209, v209
    v_rcp_f32 v211, v211
    v_rcp_f32 v213, v213
    v_rcp_f32 v215, v215
    v_rcp_f32 v217, v217
    v_pk_mul_f32 v[76:77], v[76:77], v[206:207]
    v_pk_mul_f32 v[78:79], v[78:79], v[208:209]
    v_pk_mul_f32 v[80:81], v[80:81], v[210:211]
    v_pk_mul_f32 v[82:83], v[82:83], v[212:213]
    v_pk_mul_f32 v[84:85], v[84:85], v[214:215]
    v_pk_mul_f32 v[86:87], v[86:87], v[216:217]
    v_cvt_pk_bf16_f32 v118, v76, v77
    v_cvt_pk_bf16_f32 v119, v78, v79
    v_cvt_pk_bf16_f32 v120, v80, v81
    v_cvt_pk_bf16_f32 v121, v82, v83
    v_cvt_pk_bf16_f32 v122, v84, v85
    v_cvt_pk_bf16_f32 v123, v86, v87
    v_accvgpr_write_b32 a158, v118
    v_accvgpr_write_b32 a159, v119
    v_accvgpr_write_b32 a160, v120
    v_accvgpr_write_b32 a161, v121
    v_accvgpr_write_b32 a162, v122
    v_accvgpr_write_b32 a163, v123
    s_add_u32 s16, s32, 29360128
    s_addc_u32 s17, s33, 0
    s_and_b32 s17, s17, 0xffff
    s_mov_b32 s18, 9437184
    s_mov_b32 s19, 0x00020000
    s_mov_b32 s20, s82
    s_and_b32 s21, s83, 0xffff
    s_mov_b32 s22, 4096
    s_mov_b32 s23, 0x00020000
    s_lshl_b32 s44, s34, 7
    s_lshl_b32 s45, s36, 5
    s_add_u32 s44, s44, s45
    v_and_b32 v1, 15, v15
    v_add_u32 v1, s44, v1
    v_lshlrev_b32 v12, 1, v1
    v_add_u32 v13, 32, v12
    v_lshlrev_b32 v1, 4, v15
    v_mov_b32 v8, v1
    v_add_u32 v9, 36864, v1
    v_add_u32 v10, 73728, v1
    v_add_u32 v11, 110592, v1

    buffer_load_ushort v124, v12, s[20:23], 0 offen
    buffer_load_ushort v125, v13, s[20:23], 0 offen
    v_mov_b32 v128, 0
    v_mov_b32 v129, 0
    v_mov_b32 v130, 0
    v_mov_b32 v131, 0
    v_mov_b32 v132, 0
    v_mov_b32 v133, 0
    v_mov_b32 v134, 0
    v_mov_b32 v135, 0
    v_mov_b32 v136, 0
    v_mov_b32 v137, 0
    v_mov_b32 v138, 0
    v_mov_b32 v139, 0
    v_mov_b32 v140, 0
    v_mov_b32 v141, 0
    v_mov_b32 v142, 0
    v_mov_b32 v143, 0
    v_mov_b32 v144, 0
    v_mov_b32 v145, 0
    v_mov_b32 v146, 0
    v_mov_b32 v147, 0
    v_mov_b32 v148, 0
    v_mov_b32 v149, 0
    v_mov_b32 v150, 0
    v_mov_b32 v151, 0
    v_mov_b32 v152, 0
    v_mov_b32 v153, 0
    v_mov_b32 v154, 0
    v_mov_b32 v155, 0
    v_mov_b32 v156, 0
    v_mov_b32 v157, 0
    v_mov_b32 v158, 0
    v_mov_b32 v159, 0
    v_mov_b32 v160, 0
    v_mov_b32 v161, 0
    v_mov_b32 v162, 0
    v_mov_b32 v163, 0
    v_mov_b32 v164, 0
    v_mov_b32 v165, 0
    v_mov_b32 v166, 0
    v_mov_b32 v167, 0
    v_mov_b32 v168, 0
    v_mov_b32 v169, 0
    v_mov_b32 v170, 0
    v_mov_b32 v171, 0
    v_mov_b32 v172, 0
    v_mov_b32 v173, 0
    v_mov_b32 v174, 0
    v_mov_b32 v175, 0
    v_mov_b32 v176, 0
    v_mov_b32 v177, 0
    v_mov_b32 v178, 0
    v_mov_b32 v179, 0
    v_mov_b32 v180, 0
    v_mov_b32 v181, 0
    v_mov_b32 v182, 0
    v_mov_b32 v183, 0
    v_mov_b32 v184, 0
    v_mov_b32 v185, 0
    v_mov_b32 v186, 0
    v_mov_b32 v187, 0
    v_mov_b32 v188, 0
    v_mov_b32 v189, 0
    v_mov_b32 v190, 0
    v_mov_b32 v191, 0
    v_mov_b32 v192, 0
    v_mov_b32 v193, 0
    v_mov_b32 v194, 0
    v_mov_b32 v195, 0
    v_mov_b32 v196, 0
    v_mov_b32 v197, 0
    v_mov_b32 v198, 0
    v_mov_b32 v199, 0
    s_waitcnt vmcnt(26)
    s_barrier
    ds_read_b128 v[16:19], v8 offset:0
    ds_read_b128 v[20:23], v8 offset:1024
    ds_read_b128 v[24:27], v8 offset:2048
    ds_read_b128 v[28:31], v8 offset:3072
    ds_read_b128 v[32:35], v8 offset:4096
    ds_read_b128 v[36:39], v8 offset:5120
    ds_read_b128 v[40:43], v8 offset:6144
    ds_read_b128 v[44:47], v8 offset:7168
    ds_read_b128 v[48:51], v8 offset:8192
    s_mov_b32 s37, 0
m_kernel_g2_loop:
    s_waitcnt lgkmcnt(0)
    v_mfma_f32_16x16x32_bf16 v[128:131], v[16:19], a[0:3], v[128:131]
    ds_read_b128 v[52:55], v8 offset:9216
    v_mfma_f32_16x16x32_bf16 v[164:167], v[16:19], a[4:7], v[164:167]
    ds_read_b128 v[56:59], v8 offset:10240
    v_mfma_f32_16x16x32_bf16 v[132:135], v[20:23], a[0:3], v[132:135]
    ds_read_b128 v[60:63], v8 offset:11264
    v_mfma_f32_16x16x32_bf16 v[168:171], v[20:23], a[4:7], v[168:171]
    ds_read_b128 v[64:67], v8 offset:12288
    v_mfma_f32_16x16x32_bf16 v[136:139], v[24:27], a[0:3], v[136:139]
    ds_read_b128 v[68:71], v8 offset:13312
    v_mfma_f32_16x16x32_bf16 v[172:175], v[24:27], a[4:7], v[172:175]
    ds_read_b128 v[72:75], v8 offset:14336
    v_mfma_f32_16x16x32_bf16 v[140:143], v[28:31], a[0:3], v[140:143]
    ds_read_b128 v[76:79], v8 offset:15360
    v_mfma_f32_16x16x32_bf16 v[176:179], v[28:31], a[4:7], v[176:179]
    ds_read_b128 v[80:83], v8 offset:16384
    v_mfma_f32_16x16x32_bf16 v[144:147], v[32:35], a[0:3], v[144:147]
    ds_read_b128 v[84:87], v8 offset:17408
    v_mfma_f32_16x16x32_bf16 v[180:183], v[32:35], a[4:7], v[180:183]
    buffer_load_dwordx4 a[80:83], v2, s[4:7], s39 offen offset:2048 sc1
    v_mfma_f32_16x16x32_bf16 v[148:151], v[36:39], a[0:3], v[148:151]
    v_mfma_f32_16x16x32_bf16 v[184:187], v[36:39], a[4:7], v[184:187]
    buffer_load_dwordx4 v5, s[8:11], s38 offen offset:1024 sc1 lds
    v_mfma_f32_16x16x32_bf16 v[152:155], v[40:43], a[0:3], v[152:155]
    v_mfma_f32_16x16x32_bf16 v[188:191], v[40:43], a[4:7], v[188:191]
    buffer_load_dwordx4 a[84:87], v3, s[4:7], s39 offen offset:2048 sc1
    v_mfma_f32_16x16x32_bf16 v[156:159], v[44:47], a[0:3], v[156:159]
    v_mfma_f32_16x16x32_bf16 v[192:195], v[44:47], a[4:7], v[192:195]
    buffer_load_dwordx4 v5, s[8:11], s38 offen offset:2048 sc1 lds
    v_mfma_f32_16x16x32_bf16 v[160:163], v[48:51], a[0:3], v[160:163]
    v_mfma_f32_16x16x32_bf16 v[196:199], v[48:51], a[4:7], v[196:199]
    s_waitcnt lgkmcnt(0)
    v_mfma_f32_16x16x32_bf16 v[128:131], v[52:55], a[8:11], v[128:131]
    ds_read_b128 v[16:19], v8 offset:18432
    v_mfma_f32_16x16x32_bf16 v[164:167], v[52:55], a[12:15], v[164:167]
    ds_read_b128 v[20:23], v8 offset:19456
    v_mfma_f32_16x16x32_bf16 v[132:135], v[56:59], a[8:11], v[132:135]
    ds_read_b128 v[24:27], v8 offset:20480
    v_mfma_f32_16x16x32_bf16 v[168:171], v[56:59], a[12:15], v[168:171]
    ds_read_b128 v[28:31], v8 offset:21504
    v_mfma_f32_16x16x32_bf16 v[136:139], v[60:63], a[8:11], v[136:139]
    ds_read_b128 v[32:35], v8 offset:22528
    v_mfma_f32_16x16x32_bf16 v[172:175], v[60:63], a[12:15], v[172:175]
    ds_read_b128 v[36:39], v8 offset:23552
    v_mfma_f32_16x16x32_bf16 v[140:143], v[64:67], a[8:11], v[140:143]
    ds_read_b128 v[40:43], v8 offset:24576
    v_mfma_f32_16x16x32_bf16 v[176:179], v[64:67], a[12:15], v[176:179]
    ds_read_b128 v[44:47], v8 offset:25600
    v_mfma_f32_16x16x32_bf16 v[144:147], v[68:71], a[8:11], v[144:147]
    ds_read_b128 v[48:51], v8 offset:26624
    v_mfma_f32_16x16x32_bf16 v[180:183], v[68:71], a[12:15], v[180:183]
    buffer_load_dwordx4 a[88:91], v2, s[4:7], s39 offen offset:3072 sc1
    v_mfma_f32_16x16x32_bf16 v[148:151], v[72:75], a[8:11], v[148:151]
    v_mfma_f32_16x16x32_bf16 v[184:187], v[72:75], a[12:15], v[184:187]
    buffer_load_dwordx4 v5, s[8:11], s38 offen offset:3072 sc1 lds
    v_mfma_f32_16x16x32_bf16 v[152:155], v[76:79], a[8:11], v[152:155]
    v_mfma_f32_16x16x32_bf16 v[188:191], v[76:79], a[12:15], v[188:191]
    buffer_load_dwordx4 a[92:95], v3, s[4:7], s39 offen offset:3072 sc1
    v_mfma_f32_16x16x32_bf16 v[156:159], v[80:83], a[8:11], v[156:159]
    v_mfma_f32_16x16x32_bf16 v[192:195], v[80:83], a[12:15], v[192:195]
    s_add_u32 m0, s42, 8192
    s_nop 0
    buffer_load_dwordx4 v6, s[8:11], s38 offen offset:0 sc1 lds
    s_add_u32 s38, s38, 36864
    s_add_u32 s39, s39, 4096
    v_mfma_f32_16x16x32_bf16 v[160:163], v[84:87], a[8:11], v[160:163]
    v_mfma_f32_16x16x32_bf16 v[196:199], v[84:87], a[12:15], v[196:199]
    s_waitcnt vmcnt(17)
    s_barrier
    s_waitcnt lgkmcnt(0)
    v_mfma_f32_16x16x32_bf16 v[128:131], v[16:19], a[16:19], v[128:131]
    ds_read_b128 v[52:55], v8 offset:27648
    v_mfma_f32_16x16x32_bf16 v[164:167], v[16:19], a[20:23], v[164:167]
    ds_read_b128 v[56:59], v8 offset:28672
    v_mfma_f32_16x16x32_bf16 v[132:135], v[20:23], a[16:19], v[132:135]
    ds_read_b128 v[60:63], v8 offset:29696
    v_mfma_f32_16x16x32_bf16 v[168:171], v[20:23], a[20:23], v[168:171]
    ds_read_b128 v[64:67], v8 offset:30720
    v_mfma_f32_16x16x32_bf16 v[136:139], v[24:27], a[16:19], v[136:139]
    ds_read_b128 v[68:71], v8 offset:31744
    v_mfma_f32_16x16x32_bf16 v[172:175], v[24:27], a[20:23], v[172:175]
    ds_read_b128 v[72:75], v8 offset:32768
    v_mfma_f32_16x16x32_bf16 v[140:143], v[28:31], a[16:19], v[140:143]
    ds_read_b128 v[76:79], v8 offset:33792
    v_mfma_f32_16x16x32_bf16 v[176:179], v[28:31], a[20:23], v[176:179]
    ds_read_b128 v[80:83], v8 offset:34816
    v_mfma_f32_16x16x32_bf16 v[144:147], v[32:35], a[16:19], v[144:147]
    ds_read_b128 v[84:87], v8 offset:35840
    v_mfma_f32_16x16x32_bf16 v[180:183], v[32:35], a[20:23], v[180:183]
    s_add_u32 m0, s43, 0
    s_nop 0
    buffer_load_dwordx4 v4, s[8:11], s38 offen offset:0 sc1 lds
    v_mfma_f32_16x16x32_bf16 v[148:151], v[36:39], a[16:19], v[148:151]
    v_mfma_f32_16x16x32_bf16 v[184:187], v[36:39], a[20:23], v[184:187]
    buffer_load_dwordx4 a[96:99], v2, s[4:7], s39 offen offset:0 sc1
    v_mfma_f32_16x16x32_bf16 v[152:155], v[40:43], a[16:19], v[152:155]
    v_mfma_f32_16x16x32_bf16 v[188:191], v[40:43], a[20:23], v[188:191]
    buffer_load_dwordx4 v4, s[8:11], s38 offen offset:1024 sc1 lds
    v_mfma_f32_16x16x32_bf16 v[156:159], v[44:47], a[16:19], v[156:159]
    v_mfma_f32_16x16x32_bf16 v[192:195], v[44:47], a[20:23], v[192:195]
    buffer_load_dwordx4 a[100:103], v3, s[4:7], s39 offen offset:0 sc1
    v_mfma_f32_16x16x32_bf16 v[160:163], v[48:51], a[16:19], v[160:163]
    v_mfma_f32_16x16x32_bf16 v[196:199], v[48:51], a[20:23], v[196:199]
    buffer_load_dwordx4 v4, s[8:11], s38 offen offset:2048 sc1 lds
    s_waitcnt lgkmcnt(0)
    v_mfma_f32_16x16x32_bf16 v[128:131], v[52:55], a[24:27], v[128:131]
    ds_read_b128 v[16:19], v9 offset:0
    v_mfma_f32_16x16x32_bf16 v[164:167], v[52:55], a[28:31], v[164:167]
    ds_read_b128 v[20:23], v9 offset:1024
    v_mfma_f32_16x16x32_bf16 v[132:135], v[56:59], a[24:27], v[132:135]
    ds_read_b128 v[24:27], v9 offset:2048
    v_mfma_f32_16x16x32_bf16 v[168:171], v[56:59], a[28:31], v[168:171]
    ds_read_b128 v[28:31], v9 offset:3072
    v_mfma_f32_16x16x32_bf16 v[136:139], v[60:63], a[24:27], v[136:139]
    ds_read_b128 v[32:35], v9 offset:4096
    v_mfma_f32_16x16x32_bf16 v[172:175], v[60:63], a[28:31], v[172:175]
    ds_read_b128 v[36:39], v9 offset:5120
    v_mfma_f32_16x16x32_bf16 v[140:143], v[64:67], a[24:27], v[140:143]
    ds_read_b128 v[40:43], v9 offset:6144
    v_mfma_f32_16x16x32_bf16 v[176:179], v[64:67], a[28:31], v[176:179]
    ds_read_b128 v[44:47], v9 offset:7168
    v_mfma_f32_16x16x32_bf16 v[144:147], v[68:71], a[24:27], v[144:147]
    ds_read_b128 v[48:51], v9 offset:8192
    v_mfma_f32_16x16x32_bf16 v[180:183], v[68:71], a[28:31], v[180:183]
    buffer_load_dwordx4 a[104:107], v2, s[4:7], s39 offen offset:1024 sc1
    v_mfma_f32_16x16x32_bf16 v[148:151], v[72:75], a[24:27], v[148:151]
    v_mfma_f32_16x16x32_bf16 v[184:187], v[72:75], a[28:31], v[184:187]
    buffer_load_dwordx4 v4, s[8:11], s38 offen offset:3072 sc1 lds
    v_mfma_f32_16x16x32_bf16 v[152:155], v[76:79], a[24:27], v[152:155]
    v_mfma_f32_16x16x32_bf16 v[188:191], v[76:79], a[28:31], v[188:191]
    buffer_load_dwordx4 a[108:111], v3, s[4:7], s39 offen offset:1024 sc1
    v_mfma_f32_16x16x32_bf16 v[156:159], v[80:83], a[24:27], v[156:159]
    v_mfma_f32_16x16x32_bf16 v[192:195], v[80:83], a[28:31], v[192:195]
    s_add_u32 m0, s43, 4096
    s_nop 0
    buffer_load_dwordx4 v5, s[8:11], s38 offen offset:0 sc1 lds
    v_mfma_f32_16x16x32_bf16 v[160:163], v[84:87], a[24:27], v[160:163]
    v_mfma_f32_16x16x32_bf16 v[196:199], v[84:87], a[28:31], v[196:199]
    s_waitcnt lgkmcnt(0)
    v_mfma_f32_16x16x32_bf16 v[128:131], v[16:19], a[32:35], v[128:131]
    ds_read_b128 v[52:55], v9 offset:9216
    v_mfma_f32_16x16x32_bf16 v[164:167], v[16:19], a[36:39], v[164:167]
    ds_read_b128 v[56:59], v9 offset:10240
    v_mfma_f32_16x16x32_bf16 v[132:135], v[20:23], a[32:35], v[132:135]
    ds_read_b128 v[60:63], v9 offset:11264
    v_mfma_f32_16x16x32_bf16 v[168:171], v[20:23], a[36:39], v[168:171]
    ds_read_b128 v[64:67], v9 offset:12288
    v_mfma_f32_16x16x32_bf16 v[136:139], v[24:27], a[32:35], v[136:139]
    ds_read_b128 v[68:71], v9 offset:13312
    v_mfma_f32_16x16x32_bf16 v[172:175], v[24:27], a[36:39], v[172:175]
    ds_read_b128 v[72:75], v9 offset:14336
    v_mfma_f32_16x16x32_bf16 v[140:143], v[28:31], a[32:35], v[140:143]
    ds_read_b128 v[76:79], v9 offset:15360
    v_mfma_f32_16x16x32_bf16 v[176:179], v[28:31], a[36:39], v[176:179]
    ds_read_b128 v[80:83], v9 offset:16384
    v_mfma_f32_16x16x32_bf16 v[144:147], v[32:35], a[32:35], v[144:147]
    ds_read_b128 v[84:87], v9 offset:17408
    v_mfma_f32_16x16x32_bf16 v[180:183], v[32:35], a[36:39], v[180:183]
    buffer_load_dwordx4 a[112:115], v2, s[4:7], s39 offen offset:2048 sc1
    v_mfma_f32_16x16x32_bf16 v[148:151], v[36:39], a[32:35], v[148:151]
    v_mfma_f32_16x16x32_bf16 v[184:187], v[36:39], a[36:39], v[184:187]
    buffer_load_dwordx4 v5, s[8:11], s38 offen offset:1024 sc1 lds
    v_mfma_f32_16x16x32_bf16 v[152:155], v[40:43], a[32:35], v[152:155]
    v_mfma_f32_16x16x32_bf16 v[188:191], v[40:43], a[36:39], v[188:191]
    buffer_load_dwordx4 a[116:119], v3, s[4:7], s39 offen offset:2048 sc1
    v_mfma_f32_16x16x32_bf16 v[156:159], v[44:47], a[32:35], v[156:159]
    v_mfma_f32_16x16x32_bf16 v[192:195], v[44:47], a[36:39], v[192:195]
    buffer_load_dwordx4 v5, s[8:11], s38 offen offset:2048 sc1 lds
    v_mfma_f32_16x16x32_bf16 v[160:163], v[48:51], a[32:35], v[160:163]
    v_mfma_f32_16x16x32_bf16 v[196:199], v[48:51], a[36:39], v[196:199]
    s_waitcnt lgkmcnt(0)
    v_mfma_f32_16x16x32_bf16 v[128:131], v[52:55], a[40:43], v[128:131]
    ds_read_b128 v[16:19], v9 offset:18432
    v_mfma_f32_16x16x32_bf16 v[164:167], v[52:55], a[44:47], v[164:167]
    ds_read_b128 v[20:23], v9 offset:19456
    v_mfma_f32_16x16x32_bf16 v[132:135], v[56:59], a[40:43], v[132:135]
    ds_read_b128 v[24:27], v9 offset:20480
    v_mfma_f32_16x16x32_bf16 v[168:171], v[56:59], a[44:47], v[168:171]
    ds_read_b128 v[28:31], v9 offset:21504
    v_mfma_f32_16x16x32_bf16 v[136:139], v[60:63], a[40:43], v[136:139]
    ds_read_b128 v[32:35], v9 offset:22528
    v_mfma_f32_16x16x32_bf16 v[172:175], v[60:63], a[44:47], v[172:175]
    ds_read_b128 v[36:39], v9 offset:23552
    v_mfma_f32_16x16x32_bf16 v[140:143], v[64:67], a[40:43], v[140:143]
    ds_read_b128 v[40:43], v9 offset:24576
    v_mfma_f32_16x16x32_bf16 v[176:179], v[64:67], a[44:47], v[176:179]
    ds_read_b128 v[44:47], v9 offset:25600
    v_mfma_f32_16x16x32_bf16 v[144:147], v[68:71], a[40:43], v[144:147]
    ds_read_b128 v[48:51], v9 offset:26624
    v_mfma_f32_16x16x32_bf16 v[180:183], v[68:71], a[44:47], v[180:183]
    buffer_load_dwordx4 a[120:123], v2, s[4:7], s39 offen offset:3072 sc1
    v_mfma_f32_16x16x32_bf16 v[148:151], v[72:75], a[40:43], v[148:151]
    v_mfma_f32_16x16x32_bf16 v[184:187], v[72:75], a[44:47], v[184:187]
    buffer_load_dwordx4 v5, s[8:11], s38 offen offset:3072 sc1 lds
    v_mfma_f32_16x16x32_bf16 v[152:155], v[76:79], a[40:43], v[152:155]
    v_mfma_f32_16x16x32_bf16 v[188:191], v[76:79], a[44:47], v[188:191]
    buffer_load_dwordx4 a[124:127], v3, s[4:7], s39 offen offset:3072 sc1
    v_mfma_f32_16x16x32_bf16 v[156:159], v[80:83], a[40:43], v[156:159]
    v_mfma_f32_16x16x32_bf16 v[192:195], v[80:83], a[44:47], v[192:195]
    s_add_u32 m0, s43, 8192
    s_nop 0
    buffer_load_dwordx4 v6, s[8:11], s38 offen offset:0 sc1 lds
    s_add_u32 s38, s38, 36864
    s_add_u32 s39, s39, 4096
    v_mfma_f32_16x16x32_bf16 v[160:163], v[84:87], a[40:43], v[160:163]
    v_mfma_f32_16x16x32_bf16 v[196:199], v[84:87], a[44:47], v[196:199]
    s_waitcnt vmcnt(17)
    s_barrier
    s_cmp_eq_u32 s37, 3
    s_cbranch_scc0 m_kernel_g2_sk_20
    v_mov_b32 v2, 0x80000000
    v_mov_b32 v3, 0x80000000
    v_mov_b32 v4, 0x80000000
    v_mov_b32 v5, 0x80000000
    v_mov_b32 v6, 0x80000000
m_kernel_g2_sk_20:
    s_waitcnt lgkmcnt(0)
    v_mfma_f32_16x16x32_bf16 v[128:131], v[16:19], a[48:51], v[128:131]
    ds_read_b128 v[52:55], v9 offset:27648
    v_mfma_f32_16x16x32_bf16 v[164:167], v[16:19], a[52:55], v[164:167]
    ds_read_b128 v[56:59], v9 offset:28672
    v_mfma_f32_16x16x32_bf16 v[132:135], v[20:23], a[48:51], v[132:135]
    ds_read_b128 v[60:63], v9 offset:29696
    v_mfma_f32_16x16x32_bf16 v[168:171], v[20:23], a[52:55], v[168:171]
    ds_read_b128 v[64:67], v9 offset:30720
    v_mfma_f32_16x16x32_bf16 v[136:139], v[24:27], a[48:51], v[136:139]
    ds_read_b128 v[68:71], v9 offset:31744
    v_mfma_f32_16x16x32_bf16 v[172:175], v[24:27], a[52:55], v[172:175]
    ds_read_b128 v[72:75], v9 offset:32768
    v_mfma_f32_16x16x32_bf16 v[140:143], v[28:31], a[48:51], v[140:143]
    ds_read_b128 v[76:79], v9 offset:33792
    v_mfma_f32_16x16x32_bf16 v[176:179], v[28:31], a[52:55], v[176:179]
    ds_read_b128 v[80:83], v9 offset:34816
    v_mfma_f32_16x16x32_bf16 v[144:147], v[32:35], a[48:51], v[144:147]
    ds_read_b128 v[84:87], v9 offset:35840
    v_mfma_f32_16x16x32_bf16 v[180:183], v[32:35], a[52:55], v[180:183]
    s_add_u32 m0, s40, 0
    s_nop 0
    buffer_load_dwordx4 v4, s[8:11], s38 offen offset:0 sc1 lds
    v_mfma_f32_16x16x32_bf16 v[148:151], v[36:39], a[48:51], v[148:151]
    v_mfma_f32_16x16x32_bf16 v[184:187], v[36:39], a[52:55], v[184:187]
    buffer_load_dwordx4 a[0:3], v2, s[4:7], s39 offen offset:0 sc1
    v_mfma_f32_16x16x32_bf16 v[152:155], v[40:43], a[48:51], v[152:155]
    v_mfma_f32_16x16x32_bf16 v[188:191], v[40:43], a[52:55], v[188:191]
    buffer_load_dwordx4 v4, s[8:11], s38 offen offset:1024 sc1 lds
    v_mfma_f32_16x16x32_bf16 v[156:159], v[44:47], a[48:51], v[156:159]
    v_mfma_f32_16x16x32_bf16 v[192:195], v[44:47], a[52:55], v[192:195]
    buffer_load_dwordx4 a[4:7], v3, s[4:7], s39 offen offset:0 sc1
    v_mfma_f32_16x16x32_bf16 v[160:163], v[48:51], a[48:51], v[160:163]
    v_mfma_f32_16x16x32_bf16 v[196:199], v[48:51], a[52:55], v[196:199]
    buffer_load_dwordx4 v4, s[8:11], s38 offen offset:2048 sc1 lds
    s_waitcnt lgkmcnt(0)
    v_mfma_f32_16x16x32_bf16 v[128:131], v[52:55], a[56:59], v[128:131]
    ds_read_b128 v[16:19], v10 offset:0
    v_mfma_f32_16x16x32_bf16 v[164:167], v[52:55], a[60:63], v[164:167]
    ds_read_b128 v[20:23], v10 offset:1024
    v_mfma_f32_16x16x32_bf16 v[132:135], v[56:59], a[56:59], v[132:135]
    ds_read_b128 v[24:27], v10 offset:2048
    v_mfma_f32_16x16x32_bf16 v[168:171], v[56:59], a[60:63], v[168:171]
    ds_read_b128 v[28:31], v10 offset:3072
    v_mfma_f32_16x16x32_bf16 v[136:139], v[60:63], a[56:59], v[136:139]
    ds_read_b128 v[32:35], v10 offset:4096
    v_mfma_f32_16x16x32_bf16 v[172:175], v[60:63], a[60:63], v[172:175]
    ds_read_b128 v[36:39], v10 offset:5120
    v_mfma_f32_16x16x32_bf16 v[140:143], v[64:67], a[56:59], v[140:143]
    ds_read_b128 v[40:43], v10 offset:6144
    v_mfma_f32_16x16x32_bf16 v[176:179], v[64:67], a[60:63], v[176:179]
    ds_read_b128 v[44:47], v10 offset:7168
    v_mfma_f32_16x16x32_bf16 v[144:147], v[68:71], a[56:59], v[144:147]
    ds_read_b128 v[48:51], v10 offset:8192
    v_mfma_f32_16x16x32_bf16 v[180:183], v[68:71], a[60:63], v[180:183]
    buffer_load_dwordx4 a[8:11], v2, s[4:7], s39 offen offset:1024 sc1
    v_mfma_f32_16x16x32_bf16 v[148:151], v[72:75], a[56:59], v[148:151]
    v_mfma_f32_16x16x32_bf16 v[184:187], v[72:75], a[60:63], v[184:187]
    buffer_load_dwordx4 v4, s[8:11], s38 offen offset:3072 sc1 lds
    v_mfma_f32_16x16x32_bf16 v[152:155], v[76:79], a[56:59], v[152:155]
    v_mfma_f32_16x16x32_bf16 v[188:191], v[76:79], a[60:63], v[188:191]
    buffer_load_dwordx4 a[12:15], v3, s[4:7], s39 offen offset:1024 sc1
    v_mfma_f32_16x16x32_bf16 v[156:159], v[80:83], a[56:59], v[156:159]
    v_mfma_f32_16x16x32_bf16 v[192:195], v[80:83], a[60:63], v[192:195]
    s_add_u32 m0, s40, 4096
    s_nop 0
    buffer_load_dwordx4 v5, s[8:11], s38 offen offset:0 sc1 lds
    v_mfma_f32_16x16x32_bf16 v[160:163], v[84:87], a[56:59], v[160:163]
    v_mfma_f32_16x16x32_bf16 v[196:199], v[84:87], a[60:63], v[196:199]
    s_waitcnt lgkmcnt(0)
    v_mfma_f32_16x16x32_bf16 v[128:131], v[16:19], a[64:67], v[128:131]
    ds_read_b128 v[52:55], v10 offset:9216
    v_mfma_f32_16x16x32_bf16 v[164:167], v[16:19], a[68:71], v[164:167]
    ds_read_b128 v[56:59], v10 offset:10240
    v_mfma_f32_16x16x32_bf16 v[132:135], v[20:23], a[64:67], v[132:135]
    ds_read_b128 v[60:63], v10 offset:11264
    v_mfma_f32_16x16x32_bf16 v[168:171], v[20:23], a[68:71], v[168:171]
    ds_read_b128 v[64:67], v10 offset:12288
    v_mfma_f32_16x16x32_bf16 v[136:139], v[24:27], a[64:67], v[136:139]
    ds_read_b128 v[68:71], v10 offset:13312
    v_mfma_f32_16x16x32_bf16 v[172:175], v[24:27], a[68:71], v[172:175]
    ds_read_b128 v[72:75], v10 offset:14336
    v_mfma_f32_16x16x32_bf16 v[140:143], v[28:31], a[64:67], v[140:143]
    ds_read_b128 v[76:79], v10 offset:15360
    v_mfma_f32_16x16x32_bf16 v[176:179], v[28:31], a[68:71], v[176:179]
    ds_read_b128 v[80:83], v10 offset:16384
    v_mfma_f32_16x16x32_bf16 v[144:147], v[32:35], a[64:67], v[144:147]
    ds_read_b128 v[84:87], v10 offset:17408
    v_mfma_f32_16x16x32_bf16 v[180:183], v[32:35], a[68:71], v[180:183]
    buffer_load_dwordx4 a[16:19], v2, s[4:7], s39 offen offset:2048 sc1
    v_mfma_f32_16x16x32_bf16 v[148:151], v[36:39], a[64:67], v[148:151]
    v_mfma_f32_16x16x32_bf16 v[184:187], v[36:39], a[68:71], v[184:187]
    buffer_load_dwordx4 v5, s[8:11], s38 offen offset:1024 sc1 lds
    v_mfma_f32_16x16x32_bf16 v[152:155], v[40:43], a[64:67], v[152:155]
    v_mfma_f32_16x16x32_bf16 v[188:191], v[40:43], a[68:71], v[188:191]
    buffer_load_dwordx4 a[20:23], v3, s[4:7], s39 offen offset:2048 sc1
    v_mfma_f32_16x16x32_bf16 v[156:159], v[44:47], a[64:67], v[156:159]
    v_mfma_f32_16x16x32_bf16 v[192:195], v[44:47], a[68:71], v[192:195]
    buffer_load_dwordx4 v5, s[8:11], s38 offen offset:2048 sc1 lds
    v_mfma_f32_16x16x32_bf16 v[160:163], v[48:51], a[64:67], v[160:163]
    v_mfma_f32_16x16x32_bf16 v[196:199], v[48:51], a[68:71], v[196:199]
    s_waitcnt lgkmcnt(0)
    v_mfma_f32_16x16x32_bf16 v[128:131], v[52:55], a[72:75], v[128:131]
    ds_read_b128 v[16:19], v10 offset:18432
    v_mfma_f32_16x16x32_bf16 v[164:167], v[52:55], a[76:79], v[164:167]
    ds_read_b128 v[20:23], v10 offset:19456
    v_mfma_f32_16x16x32_bf16 v[132:135], v[56:59], a[72:75], v[132:135]
    ds_read_b128 v[24:27], v10 offset:20480
    v_mfma_f32_16x16x32_bf16 v[168:171], v[56:59], a[76:79], v[168:171]
    ds_read_b128 v[28:31], v10 offset:21504
    v_mfma_f32_16x16x32_bf16 v[136:139], v[60:63], a[72:75], v[136:139]
    ds_read_b128 v[32:35], v10 offset:22528
    v_mfma_f32_16x16x32_bf16 v[172:175], v[60:63], a[76:79], v[172:175]
    ds_read_b128 v[36:39], v10 offset:23552
    v_mfma_f32_16x16x32_bf16 v[140:143], v[64:67], a[72:75], v[140:143]
    ds_read_b128 v[40:43], v10 offset:24576
    v_mfma_f32_16x16x32_bf16 v[176:179], v[64:67], a[76:79], v[176:179]
    ds_read_b128 v[44:47], v10 offset:25600
    v_mfma_f32_16x16x32_bf16 v[144:147], v[68:71], a[72:75], v[144:147]
    ds_read_b128 v[48:51], v10 offset:26624
    v_mfma_f32_16x16x32_bf16 v[180:183], v[68:71], a[76:79], v[180:183]
    buffer_load_dwordx4 a[24:27], v2, s[4:7], s39 offen offset:3072 sc1
    v_mfma_f32_16x16x32_bf16 v[148:151], v[72:75], a[72:75], v[148:151]
    v_mfma_f32_16x16x32_bf16 v[184:187], v[72:75], a[76:79], v[184:187]
    buffer_load_dwordx4 v5, s[8:11], s38 offen offset:3072 sc1 lds
    v_mfma_f32_16x16x32_bf16 v[152:155], v[76:79], a[72:75], v[152:155]
    v_mfma_f32_16x16x32_bf16 v[188:191], v[76:79], a[76:79], v[188:191]
    buffer_load_dwordx4 a[28:31], v3, s[4:7], s39 offen offset:3072 sc1
    v_mfma_f32_16x16x32_bf16 v[156:159], v[80:83], a[72:75], v[156:159]
    v_mfma_f32_16x16x32_bf16 v[192:195], v[80:83], a[76:79], v[192:195]
    s_add_u32 m0, s40, 8192
    s_nop 0
    buffer_load_dwordx4 v6, s[8:11], s38 offen offset:0 sc1 lds
    s_add_u32 s38, s38, 36864
    s_add_u32 s39, s39, 4096
    v_mfma_f32_16x16x32_bf16 v[160:163], v[84:87], a[72:75], v[160:163]
    v_mfma_f32_16x16x32_bf16 v[196:199], v[84:87], a[76:79], v[196:199]
    s_waitcnt vmcnt(17)
    s_barrier
    s_waitcnt lgkmcnt(0)
    v_mfma_f32_16x16x32_bf16 v[128:131], v[16:19], a[80:83], v[128:131]
    ds_read_b128 v[52:55], v10 offset:27648
    v_mfma_f32_16x16x32_bf16 v[164:167], v[16:19], a[84:87], v[164:167]
    ds_read_b128 v[56:59], v10 offset:28672
    v_mfma_f32_16x16x32_bf16 v[132:135], v[20:23], a[80:83], v[132:135]
    ds_read_b128 v[60:63], v10 offset:29696
    v_mfma_f32_16x16x32_bf16 v[168:171], v[20:23], a[84:87], v[168:171]
    ds_read_b128 v[64:67], v10 offset:30720
    v_mfma_f32_16x16x32_bf16 v[136:139], v[24:27], a[80:83], v[136:139]
    ds_read_b128 v[68:71], v10 offset:31744
    v_mfma_f32_16x16x32_bf16 v[172:175], v[24:27], a[84:87], v[172:175]
    ds_read_b128 v[72:75], v10 offset:32768
    v_mfma_f32_16x16x32_bf16 v[140:143], v[28:31], a[80:83], v[140:143]
    ds_read_b128 v[76:79], v10 offset:33792
    v_mfma_f32_16x16x32_bf16 v[176:179], v[28:31], a[84:87], v[176:179]
    ds_read_b128 v[80:83], v10 offset:34816
    v_mfma_f32_16x16x32_bf16 v[144:147], v[32:35], a[80:83], v[144:147]
    ds_read_b128 v[84:87], v10 offset:35840
    v_mfma_f32_16x16x32_bf16 v[180:183], v[32:35], a[84:87], v[180:183]
    s_add_u32 m0, s41, 0
    s_nop 0
    buffer_load_dwordx4 v4, s[8:11], s38 offen offset:0 sc1 lds
    v_mfma_f32_16x16x32_bf16 v[148:151], v[36:39], a[80:83], v[148:151]
    v_mfma_f32_16x16x32_bf16 v[184:187], v[36:39], a[84:87], v[184:187]
    buffer_load_dwordx4 a[32:35], v2, s[4:7], s39 offen offset:0 sc1
    v_mfma_f32_16x16x32_bf16 v[152:155], v[40:43], a[80:83], v[152:155]
    v_mfma_f32_16x16x32_bf16 v[188:191], v[40:43], a[84:87], v[188:191]
    buffer_load_dwordx4 v4, s[8:11], s38 offen offset:1024 sc1 lds
    v_mfma_f32_16x16x32_bf16 v[156:159], v[44:47], a[80:83], v[156:159]
    v_mfma_f32_16x16x32_bf16 v[192:195], v[44:47], a[84:87], v[192:195]
    buffer_load_dwordx4 a[36:39], v3, s[4:7], s39 offen offset:0 sc1
    v_mfma_f32_16x16x32_bf16 v[160:163], v[48:51], a[80:83], v[160:163]
    v_mfma_f32_16x16x32_bf16 v[196:199], v[48:51], a[84:87], v[196:199]
    buffer_load_dwordx4 v4, s[8:11], s38 offen offset:2048 sc1 lds
    s_waitcnt lgkmcnt(0)
    v_mfma_f32_16x16x32_bf16 v[128:131], v[52:55], a[88:91], v[128:131]
    ds_read_b128 v[16:19], v11 offset:0
    v_mfma_f32_16x16x32_bf16 v[164:167], v[52:55], a[92:95], v[164:167]
    ds_read_b128 v[20:23], v11 offset:1024
    v_mfma_f32_16x16x32_bf16 v[132:135], v[56:59], a[88:91], v[132:135]
    ds_read_b128 v[24:27], v11 offset:2048
    v_mfma_f32_16x16x32_bf16 v[168:171], v[56:59], a[92:95], v[168:171]
    ds_read_b128 v[28:31], v11 offset:3072
    v_mfma_f32_16x16x32_bf16 v[136:139], v[60:63], a[88:91], v[136:139]
    ds_read_b128 v[32:35], v11 offset:4096
    v_mfma_f32_16x16x32_bf16 v[172:175], v[60:63], a[92:95], v[172:175]
    ds_read_b128 v[36:39], v11 offset:5120
    v_mfma_f32_16x16x32_bf16 v[140:143], v[64:67], a[88:91], v[140:143]
    ds_read_b128 v[40:43], v11 offset:6144
    v_mfma_f32_16x16x32_bf16 v[176:179], v[64:67], a[92:95], v[176:179]
    ds_read_b128 v[44:47], v11 offset:7168
    v_mfma_f32_16x16x32_bf16 v[144:147], v[68:71], a[88:91], v[144:147]
    ds_read_b128 v[48:51], v11 offset:8192
    v_mfma_f32_16x16x32_bf16 v[180:183], v[68:71], a[92:95], v[180:183]
    buffer_load_dwordx4 a[40:43], v2, s[4:7], s39 offen offset:1024 sc1
    v_mfma_f32_16x16x32_bf16 v[148:151], v[72:75], a[88:91], v[148:151]
    v_mfma_f32_16x16x32_bf16 v[184:187], v[72:75], a[92:95], v[184:187]
    buffer_load_dwordx4 v4, s[8:11], s38 offen offset:3072 sc1 lds
    v_mfma_f32_16x16x32_bf16 v[152:155], v[76:79], a[88:91], v[152:155]
    v_mfma_f32_16x16x32_bf16 v[188:191], v[76:79], a[92:95], v[188:191]
    buffer_load_dwordx4 a[44:47], v3, s[4:7], s39 offen offset:1024 sc1
    v_mfma_f32_16x16x32_bf16 v[156:159], v[80:83], a[88:91], v[156:159]
    v_mfma_f32_16x16x32_bf16 v[192:195], v[80:83], a[92:95], v[192:195]
    s_add_u32 m0, s41, 4096
    s_nop 0
    buffer_load_dwordx4 v5, s[8:11], s38 offen offset:0 sc1 lds
    v_mfma_f32_16x16x32_bf16 v[160:163], v[84:87], a[88:91], v[160:163]
    v_mfma_f32_16x16x32_bf16 v[196:199], v[84:87], a[92:95], v[196:199]
    s_waitcnt lgkmcnt(0)
    v_mfma_f32_16x16x32_bf16 v[128:131], v[16:19], a[96:99], v[128:131]
    ds_read_b128 v[52:55], v11 offset:9216
    v_mfma_f32_16x16x32_bf16 v[164:167], v[16:19], a[100:103], v[164:167]
    ds_read_b128 v[56:59], v11 offset:10240
    v_mfma_f32_16x16x32_bf16 v[132:135], v[20:23], a[96:99], v[132:135]
    ds_read_b128 v[60:63], v11 offset:11264
    v_mfma_f32_16x16x32_bf16 v[168:171], v[20:23], a[100:103], v[168:171]
    ds_read_b128 v[64:67], v11 offset:12288
    v_mfma_f32_16x16x32_bf16 v[136:139], v[24:27], a[96:99], v[136:139]
    ds_read_b128 v[68:71], v11 offset:13312
    v_mfma_f32_16x16x32_bf16 v[172:175], v[24:27], a[100:103], v[172:175]
    ds_read_b128 v[72:75], v11 offset:14336
    v_mfma_f32_16x16x32_bf16 v[140:143], v[28:31], a[96:99], v[140:143]
    ds_read_b128 v[76:79], v11 offset:15360
    v_mfma_f32_16x16x32_bf16 v[176:179], v[28:31], a[100:103], v[176:179]
    ds_read_b128 v[80:83], v11 offset:16384
    v_mfma_f32_16x16x32_bf16 v[144:147], v[32:35], a[96:99], v[144:147]
    ds_read_b128 v[84:87], v11 offset:17408
    v_mfma_f32_16x16x32_bf16 v[180:183], v[32:35], a[100:103], v[180:183]
    buffer_load_dwordx4 a[48:51], v2, s[4:7], s39 offen offset:2048 sc1
    v_mfma_f32_16x16x32_bf16 v[148:151], v[36:39], a[96:99], v[148:151]
    v_mfma_f32_16x16x32_bf16 v[184:187], v[36:39], a[100:103], v[184:187]
    buffer_load_dwordx4 v5, s[8:11], s38 offen offset:1024 sc1 lds
    v_mfma_f32_16x16x32_bf16 v[152:155], v[40:43], a[96:99], v[152:155]
    v_mfma_f32_16x16x32_bf16 v[188:191], v[40:43], a[100:103], v[188:191]
    buffer_load_dwordx4 a[52:55], v3, s[4:7], s39 offen offset:2048 sc1
    v_mfma_f32_16x16x32_bf16 v[156:159], v[44:47], a[96:99], v[156:159]
    v_mfma_f32_16x16x32_bf16 v[192:195], v[44:47], a[100:103], v[192:195]
    buffer_load_dwordx4 v5, s[8:11], s38 offen offset:2048 sc1 lds
    v_mfma_f32_16x16x32_bf16 v[160:163], v[48:51], a[96:99], v[160:163]
    v_mfma_f32_16x16x32_bf16 v[196:199], v[48:51], a[100:103], v[196:199]
    s_waitcnt lgkmcnt(0)
    v_mfma_f32_16x16x32_bf16 v[128:131], v[52:55], a[104:107], v[128:131]
    ds_read_b128 v[16:19], v11 offset:18432
    v_mfma_f32_16x16x32_bf16 v[164:167], v[52:55], a[108:111], v[164:167]
    ds_read_b128 v[20:23], v11 offset:19456
    v_mfma_f32_16x16x32_bf16 v[132:135], v[56:59], a[104:107], v[132:135]
    ds_read_b128 v[24:27], v11 offset:20480
    v_mfma_f32_16x16x32_bf16 v[168:171], v[56:59], a[108:111], v[168:171]
    ds_read_b128 v[28:31], v11 offset:21504
    v_mfma_f32_16x16x32_bf16 v[136:139], v[60:63], a[104:107], v[136:139]
    ds_read_b128 v[32:35], v11 offset:22528
    v_mfma_f32_16x16x32_bf16 v[172:175], v[60:63], a[108:111], v[172:175]
    ds_read_b128 v[36:39], v11 offset:23552
    v_mfma_f32_16x16x32_bf16 v[140:143], v[64:67], a[104:107], v[140:143]
    ds_read_b128 v[40:43], v11 offset:24576
    v_mfma_f32_16x16x32_bf16 v[176:179], v[64:67], a[108:111], v[176:179]
    ds_read_b128 v[44:47], v11 offset:25600
    v_mfma_f32_16x16x32_bf16 v[144:147], v[68:71], a[104:107], v[144:147]
    ds_read_b128 v[48:51], v11 offset:26624
    v_mfma_f32_16x16x32_bf16 v[180:183], v[68:71], a[108:111], v[180:183]
    buffer_load_dwordx4 a[56:59], v2, s[4:7], s39 offen offset:3072 sc1
    v_mfma_f32_16x16x32_bf16 v[148:151], v[72:75], a[104:107], v[148:151]
    v_mfma_f32_16x16x32_bf16 v[184:187], v[72:75], a[108:111], v[184:187]
    buffer_load_dwordx4 v5, s[8:11], s38 offen offset:3072 sc1 lds
    v_mfma_f32_16x16x32_bf16 v[152:155], v[76:79], a[104:107], v[152:155]
    v_mfma_f32_16x16x32_bf16 v[188:191], v[76:79], a[108:111], v[188:191]
    buffer_load_dwordx4 a[60:63], v3, s[4:7], s39 offen offset:3072 sc1
    v_mfma_f32_16x16x32_bf16 v[156:159], v[80:83], a[104:107], v[156:159]
    v_mfma_f32_16x16x32_bf16 v[192:195], v[80:83], a[108:111], v[192:195]
    s_add_u32 m0, s41, 8192
    s_nop 0
    buffer_load_dwordx4 v6, s[8:11], s38 offen offset:0 sc1 lds
    s_add_u32 s38, s38, 36864
    s_add_u32 s39, s39, 4096
    v_mfma_f32_16x16x32_bf16 v[160:163], v[84:87], a[104:107], v[160:163]
    v_mfma_f32_16x16x32_bf16 v[196:199], v[84:87], a[108:111], v[196:199]
    s_waitcnt vmcnt(17)
    s_barrier
    s_waitcnt lgkmcnt(0)
    v_mfma_f32_16x16x32_bf16 v[128:131], v[16:19], a[112:115], v[128:131]
    ds_read_b128 v[52:55], v11 offset:27648
    v_mfma_f32_16x16x32_bf16 v[164:167], v[16:19], a[116:119], v[164:167]
    ds_read_b128 v[56:59], v11 offset:28672
    v_mfma_f32_16x16x32_bf16 v[132:135], v[20:23], a[112:115], v[132:135]
    ds_read_b128 v[60:63], v11 offset:29696
    v_mfma_f32_16x16x32_bf16 v[168:171], v[20:23], a[116:119], v[168:171]
    ds_read_b128 v[64:67], v11 offset:30720
    v_mfma_f32_16x16x32_bf16 v[136:139], v[24:27], a[112:115], v[136:139]
    ds_read_b128 v[68:71], v11 offset:31744
    v_mfma_f32_16x16x32_bf16 v[172:175], v[24:27], a[116:119], v[172:175]
    ds_read_b128 v[72:75], v11 offset:32768
    v_mfma_f32_16x16x32_bf16 v[140:143], v[28:31], a[112:115], v[140:143]
    ds_read_b128 v[76:79], v11 offset:33792
    v_mfma_f32_16x16x32_bf16 v[176:179], v[28:31], a[116:119], v[176:179]
    ds_read_b128 v[80:83], v11 offset:34816
    v_mfma_f32_16x16x32_bf16 v[144:147], v[32:35], a[112:115], v[144:147]
    ds_read_b128 v[84:87], v11 offset:35840
    v_mfma_f32_16x16x32_bf16 v[180:183], v[32:35], a[116:119], v[180:183]
    s_add_u32 m0, s42, 0
    s_nop 0
    buffer_load_dwordx4 v4, s[8:11], s38 offen offset:0 sc1 lds
    v_mfma_f32_16x16x32_bf16 v[148:151], v[36:39], a[112:115], v[148:151]
    v_mfma_f32_16x16x32_bf16 v[184:187], v[36:39], a[116:119], v[184:187]
    buffer_load_dwordx4 a[64:67], v2, s[4:7], s39 offen offset:0 sc1
    v_mfma_f32_16x16x32_bf16 v[152:155], v[40:43], a[112:115], v[152:155]
    v_mfma_f32_16x16x32_bf16 v[188:191], v[40:43], a[116:119], v[188:191]
    buffer_load_dwordx4 v4, s[8:11], s38 offen offset:1024 sc1 lds
    v_mfma_f32_16x16x32_bf16 v[156:159], v[44:47], a[112:115], v[156:159]
    v_mfma_f32_16x16x32_bf16 v[192:195], v[44:47], a[116:119], v[192:195]
    buffer_load_dwordx4 a[68:71], v3, s[4:7], s39 offen offset:0 sc1
    v_mfma_f32_16x16x32_bf16 v[160:163], v[48:51], a[112:115], v[160:163]
    v_mfma_f32_16x16x32_bf16 v[196:199], v[48:51], a[116:119], v[196:199]
    buffer_load_dwordx4 v4, s[8:11], s38 offen offset:2048 sc1 lds
    s_waitcnt lgkmcnt(0)
    v_mfma_f32_16x16x32_bf16 v[128:131], v[52:55], a[120:123], v[128:131]
    ds_read_b128 v[16:19], v8 offset:0
    v_mfma_f32_16x16x32_bf16 v[164:167], v[52:55], a[124:127], v[164:167]
    ds_read_b128 v[20:23], v8 offset:1024
    v_mfma_f32_16x16x32_bf16 v[132:135], v[56:59], a[120:123], v[132:135]
    ds_read_b128 v[24:27], v8 offset:2048
    v_mfma_f32_16x16x32_bf16 v[168:171], v[56:59], a[124:127], v[168:171]
    ds_read_b128 v[28:31], v8 offset:3072
    v_mfma_f32_16x16x32_bf16 v[136:139], v[60:63], a[120:123], v[136:139]
    ds_read_b128 v[32:35], v8 offset:4096
    v_mfma_f32_16x16x32_bf16 v[172:175], v[60:63], a[124:127], v[172:175]
    ds_read_b128 v[36:39], v8 offset:5120
    v_mfma_f32_16x16x32_bf16 v[140:143], v[64:67], a[120:123], v[140:143]
    ds_read_b128 v[40:43], v8 offset:6144
    v_mfma_f32_16x16x32_bf16 v[176:179], v[64:67], a[124:127], v[176:179]
    ds_read_b128 v[44:47], v8 offset:7168
    v_mfma_f32_16x16x32_bf16 v[144:147], v[68:71], a[120:123], v[144:147]
    ds_read_b128 v[48:51], v8 offset:8192
    v_mfma_f32_16x16x32_bf16 v[180:183], v[68:71], a[124:127], v[180:183]
    buffer_load_dwordx4 a[72:75], v2, s[4:7], s39 offen offset:1024 sc1
    v_mfma_f32_16x16x32_bf16 v[148:151], v[72:75], a[120:123], v[148:151]
    v_mfma_f32_16x16x32_bf16 v[184:187], v[72:75], a[124:127], v[184:187]
    buffer_load_dwordx4 v4, s[8:11], s38 offen offset:3072 sc1 lds
    v_mfma_f32_16x16x32_bf16 v[152:155], v[76:79], a[120:123], v[152:155]
    v_mfma_f32_16x16x32_bf16 v[188:191], v[76:79], a[124:127], v[188:191]
    buffer_load_dwordx4 a[76:79], v3, s[4:7], s39 offen offset:1024 sc1
    v_mfma_f32_16x16x32_bf16 v[156:159], v[80:83], a[120:123], v[156:159]
    v_mfma_f32_16x16x32_bf16 v[192:195], v[80:83], a[124:127], v[192:195]
    s_add_u32 m0, s42, 4096
    s_nop 0
    buffer_load_dwordx4 v5, s[8:11], s38 offen offset:0 sc1 lds
    v_mfma_f32_16x16x32_bf16 v[160:163], v[84:87], a[120:123], v[160:163]
    v_mfma_f32_16x16x32_bf16 v[196:199], v[84:87], a[124:127], v[196:199]
    s_add_u32 s37, s37, 1
    s_cmp_lt_u32 s37, 4
    s_cbranch_scc1 m_kernel_g2_loop
    s_waitcnt vmcnt(0)
    s_barrier
    s_mov_b32 s73, s71
    s_getpc_b64 s[30:31]
m_kernel_pc_22:
    s_add_u32 s30, s30, m_kernel_rp_21-m_kernel_pc_22
    s_addc_u32 s31, s31, 0
m_kernel_subP:
    s_add_u32 s4, s32, 39845888
    s_addc_u32 s5, s33, 0
    s_and_b32 s5, s5, 0xffff
    s_mov_b32 s6, 6193152
    s_mov_b32 s7, 0x00020000
    s_add_u32 s8, s32, 4194304
    s_addc_u32 s9, s33, 0
    s_and_b32 s9, s9, 0xffff
    s_mov_b32 s10, 2359296
    s_mov_b32 s11, 0x00020000
    v_lshlrev_b32 v252, 4, v15
    s_mul_i32 s44, s73, 10752
    s_lshl_b32 s45, s36, 2
    s_add_u32 s44, s44, s45
    s_lshl_b32 s45, s36, 1
    s_add_u32 s45, s45, 0
    s_mul_i32 s46, s45, 320
    s_lshl_b32 s48, s36, 2
    s_add_u32 s48, s48, 0
    s_cmp_ge_u32 s45, 5
    s_subb_u32 s48, s48, 0
    s_add_u32 s46, s46, s48
    s_lshl_b32 s46, s46, 4
    s_add_u32 s48, s44, 0
    s_add_u32 m0, s46, 110592
    s_add_u32 s49, s48, 0
    buffer_load_dwordx4 v252, s[4:7], s49 offen lds
    s_add_u32 m0, s46, 111616
    s_add_u32 s49, s48, 1024
    buffer_load_dwordx4 v252, s[4:7], s49 offen lds
    s_add_u32 m0, s46, 112640
    s_add_u32 s49, s48, 2048
    buffer_load_dwordx4 v252, s[4:7], s49 offen lds
    s_add_u32 m0, s46, 113664
    s_add_u32 s49, s48, 3072
    buffer_load_dwordx4 v252, s[4:7], s49 offen lds
    s_add_u32 m0, s46, 114688
    s_add_u32 s49, s48, 4096
    buffer_load_dwordx4 v252, s[4:7], s49 offen lds
    s_lshl_b32 s45, s36, 1
    s_add_u32 s45, s45, 1
    s_mul_i32 s46, s45, 320
    s_lshl_b32 s48, s36, 2
    s_add_u32 s48, s48, 1
    s_cmp_ge_u32 s45, 5
    s_subb_u32 s48, s48, 0
    s_add_u32 s46, s46, s48
    s_lshl_b32 s46, s46, 4
    s_add_u32 s48, s44, 2
    s_add_u32 m0, s46, 110592
    s_add_u32 s49, s48, 0
    buffer_load_dwordx4 v252, s[4:7], s49 offen lds
    s_add_u32 m0, s46, 111616
    s_add_u32 s49, s48, 1024
    buffer_load_dwordx4 v252, s[4:7], s49 offen lds
    s_add_u32 m0, s46, 112640
    s_add_u32 s49, s48, 2048
    buffer_load_dwordx4 v252, s[4:7], s49 offen lds
    s_add_u32 m0, s46, 113664
    s_add_u32 s49, s48, 3072
    buffer_load_dwordx4 v252, s[4:7], s49 offen lds
    s_add_u32 m0, s46, 114688
    s_add_u32 s49, s48, 4096
    buffer_load_dwordx4 v252, s[4:7], s49 offen lds
    s_lshl_b32 s46, s73, 12
    s_lshl_b32 s44, s36, 7
    s_add_u32 s44, s44, 0
    v_add_u32 v252, s44, v15
    v_mul_u32_u24 v253, 6554, v252
    v_lshrrev_b32 v253, 16, v253
    v_mul_u32_u24 v250, 10, v253
    v_sub_u32 v250, v252, v250
    v_subrev_u32 v253, 15, v253
    v_cmp_gt_u32 vcc, 32, v253
    v_cmp_gt_u32 s[52:53], 8, v250
    v_lshlrev_b32 v253, 7, v253
    v_lshl_add_u32 v253, v250, 4, v253
    s_and_b64 vcc, vcc, s[52:53]
    v_mov_b32 v250, 0x80000000
    s_nop 1
    v_cndmask_b32 v253, v250, v253, vcc
    s_lshl_b32 s45, s36, 11
    s_nop 0
    s_add_u32 m0, s45, 151808
    s_nop 0
    buffer_load_dwordx4 v253, s[8:11], s46 offen lds

    s_lshl_b32 s44, s36, 7
    s_add_u32 s44, s44, 64
    v_add_u32 v252, s44, v15
    v_mul_u32_u24 v253, 6554, v252
    v_lshrrev_b32 v253, 16, v253
    v_mul_u32_u24 v250, 10, v253
    v_sub_u32 v250, v252, v250
    v_subrev_u32 v253, 15, v253
    v_cmp_gt_u32 vcc, 32, v253
    v_cmp_gt_u32 s[52:53], 8, v250
    v_lshlrev_b32 v253, 7, v253
    v_lshl_add_u32 v253, v250, 4, v253
    s_and_b64 vcc, vcc, s[52:53]
    v_mov_b32 v250, 0x80000000
    s_nop 1
    v_cndmask_b32 v253, v250, v253, vcc
    s_lshl_b32 s45, s36, 11
    s_nop 0
    s_add_u32 m0, s45, 152832
    s_nop 0
    buffer_load_dwordx4 v253, s[8:11], s46 offen lds

    s_mov_b32 s12, s88
    s_and_b32 s13, s89, 0xffff
    s_mov_b32 s14, 1152
    s_mov_b32 s15, 0x00020000
    s_lshl_b32 s44, s73, 1
    v_mov_b32 v252, s44
    buffer_load_ushort v248, v252, s[12:15], 0 offen
    s_setpc_b64 s[30:31]
m_kernel_rp_21:
    v_accvgpr_read_b32 v88, a128
    v_accvgpr_read_b32 v89, a129
    v_accvgpr_read_b32 v90, a130
    v_accvgpr_read_b32 v91, a131
    v_accvgpr_read_b32 v92, a132
    v_accvgpr_read_b32 v93, a133
    v_accvgpr_read_b32 v94, a134
    v_accvgpr_read_b32 v95, a135
    v_accvgpr_read_b32 v96, a136
    v_accvgpr_read_b32 v97, a137
    v_accvgpr_read_b32 v98, a138
    v_accvgpr_read_b32 v99, a139
    v_accvgpr_read_b32 v100, a140
    v_accvgpr_read_b32 v101, a141
    v_accvgpr_read_b32 v102, a142
    v_accvgpr_read_b32 v103, a143
    v_accvgpr_read_b32 v104, a144
    v_accvgpr_read_b32 v105, a145
    v_accvgpr_read_b32 v106, a146
    v_accvgpr_read_b32 v107, a147
    v_accvgpr_read_b32 v108, a148
    v_accvgpr_read_b32 v109, a149
    v_accvgpr_read_b32 v110, a150
    v_accvgpr_read_b32 v111, a151
    v_accvgpr_read_b32 v112, a152
    v_accvgpr_read_b32 v113, a153
    v_accvgpr_read_b32 v114, a154
    v_accvgpr_read_b32 v115, a155
    v_accvgpr_read_b32 v116, a156
    v_accvgpr_read_b32 v117, a157
    v_accvgpr_read_b32 v118, a158
    v_accvgpr_read_b32 v119, a159
    v_accvgpr_read_b32 v120, a160
    v_accvgpr_read_b32 v121, a161
    v_accvgpr_read_b32 v122, a162
    v_accvgpr_read_b32 v123, a163
    v_lshlrev_b32 v200, 16, v124
    v_lshlrev_b32 v201, 16, v124
    v_lshlrev_b32 v202, 16, v125
    v_lshlrev_b32 v203, 16, v125
    s_lshl_b32 s66, s34, 3
    s_lshl_b32 s67, s36, 1
    s_add_u32 s66, s66, s67
    s_mul_i32 s66, s66, 72
    s_lshr_b32 s67, s35, 1
    s_mul_i32 s67, s67, 9
    s_add_u32 s66, s66, s67
    s_and_b32 s95, s35, 1
    s_mul_i32 s90, s95, 5
    s_add_u32 s90, s90, s66
    s_lshl_b32 s90, s90, 10
    s_add_u32 s91, s66, 4
    s_lshl_b32 s91, s91, 10
    s_lshl_b32 s94, s95, 3
    s_add_u32 s91, s91, s94
    s_add_u32 s92, s90, 73728
    s_add_u32 s93, s91, 73728
    v_lshlrev_b32 v1, 4, v15

    v_lshlrev_b32 v204, 16, v88
    v_and_b32 v205, 0xffff0000, v88
    v_lshlrev_b32 v206, 16, v89
    v_and_b32 v207, 0xffff0000, v89
    v_pk_add_f32 v[128:129], v[128:129], v[200:201]
    v_pk_add_f32 v[130:131], v[130:131], v[200:201]
    v_pk_mul_f32 v[128:129], v[128:129], v[204:205]
    v_pk_mul_f32 v[130:131], v[130:131], v[206:207]
    v_cvt_pk_bf16_f32 v88, v128, v129
    v_cvt_pk_bf16_f32 v89, v130, v131
    v_lshlrev_b32 v208, 16, v90
    v_and_b32 v209, 0xffff0000, v90
    v_lshlrev_b32 v210, 16, v91
    v_and_b32 v211, 0xffff0000, v91
    v_pk_add_f32 v[132:133], v[132:133], v[200:201]
    v_pk_add_f32 v[134:135], v[134:135], v[200:201]
    v_pk_mul_f32 v[132:133], v[132:133], v[208:209]
    v_pk_mul_f32 v[134:135], v[134:135], v[210:211]
    v_cvt_pk_bf16_f32 v90, v132, v133
    v_cvt_pk_bf16_f32 v91, v134, v135
    v_lshlrev_b32 v204, 16, v92
    v_and_b32 v205, 0xffff0000, v92
    v_lshlrev_b32 v206, 16, v93
    v_and_b32 v207, 0xffff0000, v93
    v_pk_add_f32 v[136:137], v[136:137], v[200:201]
    v_pk_add_f32 v[138:139], v[138:139], v[200:201]
    v_pk_mul_f32 v[136:137], v[136:137], v[204:205]
    v_pk_mul_f32 v[138:139], v[138:139], v[206:207]
    v_cvt_pk_bf16_f32 v92, v136, v137
    v_cvt_pk_bf16_f32 v93, v138, v139
    v_lshlrev_b32 v208, 16, v94
    v_and_b32 v209, 0xffff0000, v94
    v_lshlrev_b32 v210, 16, v95
    v_and_b32 v211, 0xffff0000, v95
    v_pk_add_f32 v[140:141], v[140:141], v[200:201]
    v_pk_add_f32 v[142:143], v[142:143], v[200:201]
    v_pk_mul_f32 v[140:141], v[140:141], v[208:209]
    v_pk_mul_f32 v[142:143], v[142:143], v[210:211]
    v_cvt_pk_bf16_f32 v94, v140, v141
    v_cvt_pk_bf16_f32 v95, v142, v143
    v_lshlrev_b32 v204, 16, v96
    v_and_b32 v205, 0xffff0000, v96
    v_lshlrev_b32 v206, 16, v97
    v_and_b32 v207, 0xffff0000, v97
    v_pk_add_f32 v[144:145], v[144:145], v[200:201]
    v_pk_add_f32 v[146:147], v[146:147], v[200:201]
    v_pk_mul_f32 v[144:145], v[144:145], v[204:205]
    v_pk_mul_f32 v[146:147], v[146:147], v[206:207]
    v_cvt_pk_bf16_f32 v96, v144, v145
    v_cvt_pk_bf16_f32 v97, v146, v147
    v_lshlrev_b32 v208, 16, v98
    v_and_b32 v209, 0xffff0000, v98
    v_lshlrev_b32 v210, 16, v99
    v_and_b32 v211, 0xffff0000, v99
    v_pk_add_f32 v[148:149], v[148:149], v[200:201]
    v_pk_add_f32 v[150:151], v[150:151], v[200:201]
    v_pk_mul_f32 v[148:149], v[148:149], v[208:209]
    v_pk_mul_f32 v[150:151], v[150:151], v[210:211]
    v_cvt_pk_bf16_f32 v98, v148, v149
    v_cvt_pk_bf16_f32 v99, v150, v151
    v_lshlrev_b32 v204, 16, v100
    v_and_b32 v205, 0xffff0000, v100
    v_lshlrev_b32 v206, 16, v101
    v_and_b32 v207, 0xffff0000, v101
    v_pk_add_f32 v[152:153], v[152:153], v[200:201]
    v_pk_add_f32 v[154:155], v[154:155], v[200:201]
    v_pk_mul_f32 v[152:153], v[152:153], v[204:205]
    v_pk_mul_f32 v[154:155], v[154:155], v[206:207]
    v_cvt_pk_bf16_f32 v100, v152, v153
    v_cvt_pk_bf16_f32 v101, v154, v155
    v_lshlrev_b32 v208, 16, v102
    v_and_b32 v209, 0xffff0000, v102
    v_lshlrev_b32 v210, 16, v103
    v_and_b32 v211, 0xffff0000, v103
    v_pk_add_f32 v[156:157], v[156:157], v[200:201]
    v_pk_add_f32 v[158:159], v[158:159], v[200:201]
    v_pk_mul_f32 v[156:157], v[156:157], v[208:209]
    v_pk_mul_f32 v[158:159], v[158:159], v[210:211]
    v_cvt_pk_bf16_f32 v102, v156, v157
    v_cvt_pk_bf16_f32 v103, v158, v159
    v_lshlrev_b32 v204, 16, v104
    v_and_b32 v205, 0xffff0000, v104
    v_lshlrev_b32 v206, 16, v105
    v_and_b32 v207, 0xffff0000, v105
    v_pk_add_f32 v[160:161], v[160:161], v[200:201]
    v_pk_add_f32 v[162:163], v[162:163], v[200:201]
    v_pk_mul_f32 v[160:161], v[160:161], v[204:205]
    v_pk_mul_f32 v[162:163], v[162:163], v[206:207]
    v_cvt_pk_bf16_f32 v104, v160, v161
    v_cvt_pk_bf16_f32 v105, v162, v163
    v_lshlrev_b32 v208, 16, v106
    v_and_b32 v209, 0xffff0000, v106
    v_lshlrev_b32 v210, 16, v107
    v_and_b32 v211, 0xffff0000, v107
    v_pk_add_f32 v[164:165], v[164:165], v[202:203]
    v_pk_add_f32 v[166:167], v[166:167], v[202:203]
    v_pk_mul_f32 v[164:165], v[164:165], v[208:209]
    v_pk_mul_f32 v[166:167], v[166:167], v[210:211]
    v_cvt_pk_bf16_f32 v106, v164, v165
    v_cvt_pk_bf16_f32 v107, v166, v167
    v_lshlrev_b32 v204, 16, v108
    v_and_b32 v205, 0xffff0000, v108
    v_lshlrev_b32 v206, 16, v109
    v_and_b32 v207, 0xffff0000, v109
    v_pk_add_f32 v[168:169], v[168:169], v[202:203]
    v_pk_add_f32 v[170:171], v[170:171], v[202:203]
    v_pk_mul_f32 v[168:169], v[168:169], v[204:205]
    v_pk_mul_f32 v[170:171], v[170:171], v[206:207]
    v_cvt_pk_bf16_f32 v108, v168, v169
    v_cvt_pk_bf16_f32 v109, v170, v171
    v_lshlrev_b32 v208, 16, v110
    v_and_b32 v209, 0xffff0000, v110
    v_lshlrev_b32 v210, 16, v111
    v_and_b32 v211, 0xffff0000, v111
    v_pk_add_f32 v[172:173], v[172:173], v[202:203]
    v_pk_add_f32 v[174:175], v[174:175], v[202:203]
    v_pk_mul_f32 v[172:173], v[172:173], v[208:209]
    v_pk_mul_f32 v[174:175], v[174:175], v[210:211]
    v_cvt_pk_bf16_f32 v110, v172, v173
    v_cvt_pk_bf16_f32 v111, v174, v175
    v_lshlrev_b32 v204, 16, v112
    v_and_b32 v205, 0xffff0000, v112
    v_lshlrev_b32 v206, 16, v113
    v_and_b32 v207, 0xffff0000, v113
    v_pk_add_f32 v[176:177], v[176:177], v[202:203]
    v_pk_add_f32 v[178:179], v[178:179], v[202:203]
    v_pk_mul_f32 v[176:177], v[176:177], v[204:205]
    v_pk_mul_f32 v[178:179], v[178:179], v[206:207]
    v_cvt_pk_bf16_f32 v112, v176, v177
    v_cvt_pk_bf16_f32 v113, v178, v179
    v_lshlrev_b32 v208, 16, v114
    v_and_b32 v209, 0xffff0000, v114
    v_lshlrev_b32 v210, 16, v115
    v_and_b32 v211, 0xffff0000, v115
    v_pk_add_f32 v[180:181], v[180:181], v[202:203]
    v_pk_add_f32 v[182:183], v[182:183], v[202:203]
    v_pk_mul_f32 v[180:181], v[180:181], v[208:209]
    v_pk_mul_f32 v[182:183], v[182:183], v[210:211]
    v_cvt_pk_bf16_f32 v114, v180, v181
    v_cvt_pk_bf16_f32 v115, v182, v183
    v_lshlrev_b32 v204, 16, v116
    v_and_b32 v205, 0xffff0000, v116
    v_lshlrev_b32 v206, 16, v117
    v_and_b32 v207, 0xffff0000, v117
    v_pk_add_f32 v[184:185], v[184:185], v[202:203]
    v_pk_add_f32 v[186:187], v[186:187], v[202:203]
    v_pk_mul_f32 v[184:185], v[184:185], v[204:205]
    v_pk_mul_f32 v[186:187], v[186:187], v[206:207]
    v_cvt_pk_bf16_f32 v116, v184, v185
    v_cvt_pk_bf16_f32 v117, v186, v187
    v_lshlrev_b32 v208, 16, v118
    v_and_b32 v209, 0xffff0000, v118
    v_lshlrev_b32 v210, 16, v119
    v_and_b32 v211, 0xffff0000, v119
    v_pk_add_f32 v[188:189], v[188:189], v[202:203]
    v_pk_add_f32 v[190:191], v[190:191], v[202:203]
    v_pk_mul_f32 v[188:189], v[188:189], v[208:209]
    v_pk_mul_f32 v[190:191], v[190:191], v[210:211]
    v_cvt_pk_bf16_f32 v118, v188, v189
    v_cvt_pk_bf16_f32 v119, v190, v191
    v_lshlrev_b32 v204, 16, v120
    v_and_b32 v205, 0xffff0000, v120
    v_lshlrev_b32 v206, 16, v121
    v_and_b32 v207, 0xffff0000, v121
    v_pk_add_f32 v[192:193], v[192:193], v[202:203]
    v_pk_add_f32 v[194:195], v[194:195], v[202:203]
    v_pk_mul_f32 v[192:193], v[192:193], v[204:205]
    v_pk_mul_f32 v[194:195], v[194:195], v[206:207]
    v_cvt_pk_bf16_f32 v120, v192, v193
    v_cvt_pk_bf16_f32 v121, v194, v195
    v_lshlrev_b32 v208, 16, v122
    v_and_b32 v209, 0xffff0000, v122
    v_lshlrev_b32 v210, 16, v123
    v_and_b32 v211, 0xffff0000, v123
    v_pk_add_f32 v[196:197], v[196:197], v[202:203]
    v_pk_add_f32 v[198:199], v[198:199], v[202:203]
    v_pk_mul_f32 v[196:197], v[196:197], v[208:209]
    v_pk_mul_f32 v[198:199], v[198:199], v[210:211]
    v_cvt_pk_bf16_f32 v122, v196, v197
    v_cvt_pk_bf16_f32 v123, v198, v199
    v_bfe_u32 v2, v15, 4, 1
    v_mul_u32_u24 v2, 73728, v2
    v_lshrrev_b32 v3, 5, v15
    v_lshlrev_b32 v3, 8, v3
    v_add_u32 v2, v2, v3
    v_and_b32 v3, 15, v15
    v_lshlrev_b32 v3, 4, v3
    v_add_u32 v2, v2, v3
    s_add_u32 s91, s66, 4
    s_lshl_b32 s91, s91, 10
    s_lshl_b32 s94, s95, 9
    s_add_u32 s91, s91, s94

    s_cmp_eq_u32 s95, 1
    s_cbranch_scc1 m_kernel_g2_odd_23
    buffer_store_dwordx4 v[88:91], v1, s[16:19], s90 offen offset:0 sc1
    buffer_store_dwordx4 v[92:95], v1, s[16:19], s90 offen offset:1024 sc1
    buffer_store_dwordx4 v[96:99], v1, s[16:19], s90 offen offset:2048 sc1
    buffer_store_dwordx4 v[100:103], v1, s[16:19], s90 offen offset:3072 sc1
    buffer_store_dwordx4 v[106:109], v1, s[16:19], s92 offen offset:0 sc1
    buffer_store_dwordx4 v[110:113], v1, s[16:19], s92 offen offset:1024 sc1
    buffer_store_dwordx4 v[114:117], v1, s[16:19], s92 offen offset:2048 sc1
    buffer_store_dwordx4 v[118:121], v1, s[16:19], s92 offen offset:3072 sc1
    v_mov_b32 v4, v104
    v_mov_b32 v5, v105
    v_mov_b32 v6, v122
    v_mov_b32 v7, v123
    s_nop 1
    v_permlane16_swap_b32 v4, v6
    v_permlane16_swap_b32 v5, v7
    s_nop 0
    buffer_store_dwordx4 v[4:7], v2, s[16:19], s91 offen sc1
    s_branch m_kernel_g2_sd_24
m_kernel_g2_odd_23:
    buffer_store_dwordx4 v[90:93], v1, s[16:19], s90 offen offset:0 sc1
    buffer_store_dwordx4 v[94:97], v1, s[16:19], s90 offen offset:1024 sc1
    buffer_store_dwordx4 v[98:101], v1, s[16:19], s90 offen offset:2048 sc1
    buffer_store_dwordx4 v[102:105], v1, s[16:19], s90 offen offset:3072 sc1
    buffer_store_dwordx4 v[108:111], v1, s[16:19], s92 offen offset:0 sc1
    buffer_store_dwordx4 v[112:115], v1, s[16:19], s92 offen offset:1024 sc1
    buffer_store_dwordx4 v[116:119], v1, s[16:19], s92 offen offset:2048 sc1
    buffer_store_dwordx4 v[120:123], v1, s[16:19], s92 offen offset:3072 sc1
    v_mov_b32 v4, v88
    v_mov_b32 v5, v89
    v_mov_b32 v6, v106
    v_mov_b32 v7, v107
    s_nop 1
    v_permlane16_swap_b32 v4, v6
    v_permlane16_swap_b32 v5, v7
    s_nop 0
    buffer_store_dwordx4 v[4:7], v2, s[16:19], s91 offen sc1
m_kernel_g2_sd_24:
    s_add_u32 s44, s34, 32
    s_lshl_b32 s44, s44, 6
    s_add_u32 s44, s44, s35
    s_lshl_b32 s44, s44, 7
    s_mov_b32 s61, s44
    s_mov_b32 s62, -1
    s_mov_b32 s60, 1
    s_waitcnt vmcnt(9)
    s_getpc_b64 s[28:29]
m_kernel_pc_25:
    s_sub_u32 s28, s28, m_kernel_pc_25-m_kernel_subC
    s_subb_u32 s29, s29, 0
    s_swappc_b64 s[30:31], s[28:29]
    s_getpc_b64 s[28:29]
m_kernel_pc_26:
    s_sub_u32 s28, s28, m_kernel_pc_26-m_kernel_subF
    s_subb_u32 s29, s29, 0
    s_swappc_b64 s[30:31], s[28:29]
    s_lshr_b32 s44, s2, 3
    s_cmp_ge_u32 s44, 24
    s_cbranch_scc1 m_kernel_x_27
    s_and_b32 s44, s2, 7
    s_lshr_b32 s45, s2, 3
    s_lshl_b32 s34, s44, 2
    s_and_b32 s46, s45, 3
    s_add_u32 s34, s34, s46
    s_lshr_b32 s35, s45, 2
    v_lshlrev_b32 v1, 4, v15
    s_lshl_b32 s44, s34, 2
    s_add_u32 s58, s44, s36
    s_mul_i32 s44, s58, 73728
    v_add_u32 v8, s44, v1

    s_mul_i32 s44, s35, 442368
    s_add_u32 s44, s44, 69206016
    s_add_u32 s4, s32, s44
    s_addc_u32 s5, s33, 0
    s_and_b32 s5, s5, 0xffff
    s_mov_b32 s6, 442368
    s_mov_b32 s7, 0x00020000
    s_add_u32 s8, s32, 29360128
    s_addc_u32 s9, s33, 0
    s_and_b32 s9, s9, 0xffff
    s_mov_b32 s10, 9437184
    s_mov_b32 s11, 0x00020000
    s_lshl_b32 s40, s36, 10
    v_add_u32 v2, s40, v1
    v_add_u32 v3, s40, v1
    v_add_u32 v3, 4096, v3
    v_add_u32 v4, s40, v1
    v_add_u32 v4, 8192, v4
    v_add_u32 v5, s40, v1
    v_add_u32 v5, 12288, v5
    v_add_u32 v6, s40, v1
    v_add_u32 v6, 16384, v6
    v_add_u32 v7, s40, v1
    v_add_u32 v7, 20480, v7
    v_add_u32 v9, 0, v1
    v_add_u32 v10, 24576, v1
    v_add_u32 v11, 49152, v1
    v_add_u32 v12, 73728, v1
    v_add_u32 v13, 98304, v1
    v_add_u32 v14, 122880, v1
    s_barrier
    s_mov_b32 s38, 0
    s_add_u32 m0, s40, 0
    s_nop 0
    buffer_load_dwordx4 v2, s[4:7], s38 offen lds
    s_add_u32 m0, s40, 4096
    s_nop 0
    buffer_load_dwordx4 v3, s[4:7], s38 offen lds
    s_add_u32 m0, s40, 8192
    s_nop 0
    buffer_load_dwordx4 v4, s[4:7], s38 offen lds
    s_add_u32 m0, s40, 12288
    s_nop 0
    buffer_load_dwordx4 v5, s[4:7], s38 offen lds
    s_add_u32 m0, s40, 16384
    s_nop 0
    buffer_load_dwordx4 v6, s[4:7], s38 offen lds
    s_add_u32 m0, s40, 20480
    s_nop 0
    buffer_load_dwordx4 v7, s[4:7], s38 offen lds
    s_mov_b32 s38, 24576
    s_add_u32 m0, s40, 24576
    s_nop 0
    buffer_load_dwordx4 v2, s[4:7], s38 offen lds
    s_add_u32 m0, s40, 28672
    s_nop 0
    buffer_load_dwordx4 v3, s[4:7], s38 offen lds
    s_add_u32 m0, s40, 32768
    s_nop 0
    buffer_load_dwordx4 v4, s[4:7], s38 offen lds
    s_add_u32 m0, s40, 36864
    s_nop 0
    buffer_load_dwordx4 v5, s[4:7], s38 offen lds
    s_add_u32 m0, s40, 40960
    s_nop 0
    buffer_load_dwordx4 v6, s[4:7], s38 offen lds
    s_add_u32 m0, s40, 45056
    s_nop 0
    buffer_load_dwordx4 v7, s[4:7], s38 offen lds
    s_mov_b32 s12, s76
    s_and_b32 s13, s77, 0xffff
    s_mov_b32 s14, 2359296
    s_mov_b32 s15, 0x00020000
    s_add_u32 s16, s32, 46137344
    s_addc_u32 s17, s33, 0
    s_and_b32 s17, s17, 0xffff
    s_mov_b32 s18, 2359296
    s_mov_b32 s19, 0x00020000
    s_mov_b32 s20, s84
    s_and_b32 s21, s85, 0xffff
    s_mov_b32 s22, 2359296
    s_mov_b32 s23, 0x00020000
    v_mov_b32 v16, 0
    v_mov_b32 v17, 0
    v_mov_b32 v18, 0
    v_mov_b32 v19, 0
    v_mov_b32 v20, 0
    v_mov_b32 v21, 0
    v_mov_b32 v22, 0
    v_mov_b32 v23, 0
    v_mov_b32 v24, 0
    v_mov_b32 v25, 0
    v_mov_b32 v26, 0
    v_mov_b32 v27, 0
    v_mov_b32 v28, 0
    v_mov_b32 v29, 0
    v_mov_b32 v30, 0
    v_mov_b32 v31, 0
    v_mov_b32 v32, 0
    v_mov_b32 v33, 0
    v_mov_b32 v34, 0
    v_mov_b32 v35, 0
    v_mov_b32 v36, 0
    v_mov_b32 v37, 0
    v_mov_b32 v38, 0
    v_mov_b32 v39, 0
    s_lshr_b32 s59, s34, 1
    s_cmp_eq_u32 s36, 0
    s_cbranch_scc0 m_kernel_g3_wf_29
    s_add_u32 s24, s32, 49283072
    s_addc_u32 s25, s33, 0
    s_and_b32 s25, s25, 0xffff
    s_mov_b32 s26, 524288
    s_mov_b32 s27, 0x00020000
    s_add_u32 s44, s59, 32
    s_lshl_b32 s44, s44, 6
    s_add_u32 s44, s44, 0
    s_lshl_b32 s44, s44, 7
    v_lshlrev_b32 v250, 7, v15
    v_add_u32 v250, s44, v250
    s_mov_b32 s46, 0xffff
    s_mov_b32 s47, 0x0
m_kernel_g3_pl_30:
    buffer_load_dword v251, v250, s[24:27], 0 offen sc1
    s_waitcnt vmcnt(0)
    v_cmp_eq_u32 s[48:49], 1, v251
    s_and_b64 s[48:49], s[48:49], s[46:47]
    s_cmp_eq_u64 s[48:49], s[46:47]
    s_cbranch_scc1 m_kernel_g3_wf_29
    s_sleep 2
    s_branch m_kernel_g3_pl_30
m_kernel_g3_wf_29:
    s_waitcnt vmcnt(0)
    s_barrier
    s_cmp_eq_u32 s36, 0
    s_cbranch_scc0 m_kernel_sg_31
    s_add_u32 s24, s32, 49283072
    s_addc_u32 s25, s33, 0
    s_and_b32 s25, s25, 0xffff
    s_mov_b32 s26, 524288
    s_mov_b32 s27, 0x00020000
    v_mov_b32 v251, 1
    s_mov_b64 exec, 1
    s_mul_i32 s45, s72, 1366
    s_lshr_b32 s45, s45, 16
    s_mul_i32 s46, s45, 48
    s_sub_u32 s46, s72, s46
    s_add_u32 s44, s45, 48
    s_lshl_b32 s44, s44, 6
    s_add_u32 s44, s44, s46
    s_lshl_b32 s44, s44, 7
    v_mov_b32 v250, s44
    buffer_store_dword v251, v250, s[24:27], 0 offen sc1
    s_mov_b64 exec, -1
m_kernel_sg_31:
    s_mov_b32 s39, 0
    buffer_load_dwordx4 a[0:3], v8, s[8:11], s39 offen offset:0 sc1
    buffer_load_dwordx4 a[4:7], v8, s[8:11], s39 offen offset:1024 sc1
    buffer_load_dwordx4 a[8:11], v8, s[8:11], s39 offen offset:2048 sc1
    buffer_load_dwordx4 a[12:15], v8, s[8:11], s39 offen offset:3072 sc1
    s_mov_b32 s39, 4096
    buffer_load_dwordx4 a[16:19], v8, s[8:11], s39 offen offset:0 sc1
    buffer_load_dwordx4 a[20:23], v8, s[8:11], s39 offen offset:1024 sc1
    buffer_load_dwordx4 a[24:27], v8, s[8:11], s39 offen offset:2048 sc1
    buffer_load_dwordx4 a[28:31], v8, s[8:11], s39 offen offset:3072 sc1
    s_mov_b32 s38, 49152
    s_add_u32 m0, s40, 49152
    s_nop 0
    buffer_load_dwordx4 v2, s[4:7], s38 offen lds
    s_add_u32 m0, s40, 53248
    s_nop 0
    buffer_load_dwordx4 v3, s[4:7], s38 offen lds
    s_add_u32 m0, s40, 57344
    s_nop 0
    buffer_load_dwordx4 v4, s[4:7], s38 offen lds
    s_add_u32 m0, s40, 61440
    s_nop 0
    buffer_load_dwordx4 v5, s[4:7], s38 offen lds
    s_add_u32 m0, s40, 65536
    s_nop 0
    buffer_load_dwordx4 v6, s[4:7], s38 offen lds
    s_add_u32 m0, s40, 69632
    s_nop 0
    buffer_load_dwordx4 v7, s[4:7], s38 offen lds
    s_mov_b32 s39, 8192
    buffer_load_dwordx4 a[32:35], v8, s[8:11], s39 offen offset:0 sc1
    buffer_load_dwordx4 a[36:39], v8, s[8:11], s39 offen offset:1024 sc1
    buffer_load_dwordx4 a[40:43], v8, s[8:11], s39 offen offset:2048 sc1
    buffer_load_dwordx4 a[44:47], v8, s[8:11], s39 offen offset:3072 sc1
    s_mov_b32 s38, 73728
    s_add_u32 m0, s40, 73728
    s_nop 0
    buffer_load_dwordx4 v2, s[4:7], s38 offen lds
    s_add_u32 m0, s40, 77824
    s_nop 0
    buffer_load_dwordx4 v3, s[4:7], s38 offen lds
    s_add_u32 m0, s40, 81920
    s_nop 0
    buffer_load_dwordx4 v4, s[4:7], s38 offen lds
    s_add_u32 m0, s40, 86016
    s_nop 0
    buffer_load_dwordx4 v5, s[4:7], s38 offen lds
    s_add_u32 m0, s40, 90112
    s_nop 0
    buffer_load_dwordx4 v6, s[4:7], s38 offen lds
    s_add_u32 m0, s40, 94208
    s_nop 0
    buffer_load_dwordx4 v7, s[4:7], s38 offen lds
    s_mov_b32 s39, 12288
    buffer_load_dwordx4 a[48:51], v8, s[8:11], s39 offen offset:0 sc1
    buffer_load_dwordx4 a[52:55], v8, s[8:11], s39 offen offset:1024 sc1
    buffer_load_dwordx4 a[56:59], v8, s[8:11], s39 offen offset:2048 sc1
    buffer_load_dwordx4 a[60:63], v8, s[8:11], s39 offen offset:3072 sc1
    s_mov_b32 s38, 98304
    s_add_u32 m0, s40, 98304
    s_nop 0
    buffer_load_dwordx4 v2, s[4:7], s38 offen lds
    s_add_u32 m0, s40, 102400
    s_nop 0
    buffer_load_dwordx4 v3, s[4:7], s38 offen lds
    s_add_u32 m0, s40, 106496
    s_nop 0
    buffer_load_dwordx4 v4, s[4:7], s38 offen lds
    s_mov_b32 s39, 16384
    buffer_load_dwordx4 a[64:67], v8, s[8:11], s39 offen offset:0 sc1
    buffer_load_dwordx4 a[68:71], v8, s[8:11], s39 offen offset:1024 sc1
    s_mov_b32 s38, 98304
    s_mov_b32 s39, 16384
    s_waitcnt vmcnt(25)
    s_barrier
    ds_read_b128 a[96:99], v9 offset:0
    ds_read_b128 a[100:103], v9 offset:1024
    ds_read_b128 a[104:107], v9 offset:2048
    ds_read_b128 a[108:111], v9 offset:3072
    ds_read_b128 a[112:115], v9 offset:4096
    ds_read_b128 a[116:119], v9 offset:5120
    s_mov_b32 s37, 0
m_kernel_g3_g_loop:
    s_waitcnt lgkmcnt(0)
    v_mfma_f32_16x16x32_bf16 v[16:19], a[96:99], a[0:3], v[16:19]
    ds_read_b128 a[120:123], v9 offset:6144
    ds_read_b128 a[124:127], v9 offset:7168
    v_mfma_f32_16x16x32_bf16 v[20:23], a[100:103], a[0:3], v[20:23]
    ds_read_b128 a[128:131], v9 offset:8192
    ds_read_b128 a[132:135], v9 offset:9216
    v_mfma_f32_16x16x32_bf16 v[24:27], a[104:107], a[0:3], v[24:27]
    ds_read_b128 a[136:139], v9 offset:10240
    ds_read_b128 a[140:143], v9 offset:11264
    v_mfma_f32_16x16x32_bf16 v[28:31], a[108:111], a[0:3], v[28:31]
    buffer_load_dwordx4 a[72:75], v8, s[8:11], s39 offen offset:2048 sc1
    v_mfma_f32_16x16x32_bf16 v[32:35], a[112:115], a[0:3], v[32:35]
    s_add_u32 m0, s40, 110592
    s_nop 0
    buffer_load_dwordx4 v5, s[4:7], s38 offen lds
    v_mfma_f32_16x16x32_bf16 v[36:39], a[116:119], a[0:3], v[36:39]
    s_waitcnt lgkmcnt(0)
    v_mfma_f32_16x16x32_bf16 v[16:19], a[120:123], a[4:7], v[16:19]
    ds_read_b128 a[96:99], v9 offset:12288
    ds_read_b128 a[100:103], v9 offset:13312
    v_mfma_f32_16x16x32_bf16 v[20:23], a[124:127], a[4:7], v[20:23]
    ds_read_b128 a[104:107], v9 offset:14336
    ds_read_b128 a[108:111], v9 offset:15360
    v_mfma_f32_16x16x32_bf16 v[24:27], a[128:131], a[4:7], v[24:27]
    ds_read_b128 a[112:115], v9 offset:16384
    ds_read_b128 a[116:119], v9 offset:17408
    v_mfma_f32_16x16x32_bf16 v[28:31], a[132:135], a[4:7], v[28:31]
    buffer_load_dwordx4 a[76:79], v8, s[8:11], s39 offen offset:3072 sc1
    v_mfma_f32_16x16x32_bf16 v[32:35], a[136:139], a[4:7], v[32:35]
    s_add_u32 m0, s40, 114688
    s_nop 0
    buffer_load_dwordx4 v6, s[4:7], s38 offen lds
    v_mfma_f32_16x16x32_bf16 v[36:39], a[140:143], a[4:7], v[36:39]
    s_add_u32 m0, s40, 118784
    s_nop 0
    buffer_load_dwordx4 v7, s[4:7], s38 offen lds
    s_add_u32 s38, s38, 24576
    s_add_u32 s39, s39, 4096
    s_waitcnt vmcnt(30)
    s_barrier
    s_waitcnt lgkmcnt(0)
    v_mfma_f32_16x16x32_bf16 v[16:19], a[96:99], a[8:11], v[16:19]
    ds_read_b128 a[120:123], v9 offset:18432
    ds_read_b128 a[124:127], v9 offset:19456
    v_mfma_f32_16x16x32_bf16 v[20:23], a[100:103], a[8:11], v[20:23]
    ds_read_b128 a[128:131], v9 offset:20480
    ds_read_b128 a[132:135], v9 offset:21504
    v_mfma_f32_16x16x32_bf16 v[24:27], a[104:107], a[8:11], v[24:27]
    ds_read_b128 a[136:139], v9 offset:22528
    ds_read_b128 a[140:143], v9 offset:23552
    v_mfma_f32_16x16x32_bf16 v[28:31], a[108:111], a[8:11], v[28:31]
    s_add_u32 m0, s40, 122880
    s_nop 0
    buffer_load_dwordx4 v2, s[4:7], s38 offen lds
    v_mfma_f32_16x16x32_bf16 v[32:35], a[112:115], a[8:11], v[32:35]
    buffer_load_dwordx4 a[80:83], v8, s[8:11], s39 offen offset:0 sc1
    v_mfma_f32_16x16x32_bf16 v[36:39], a[116:119], a[8:11], v[36:39]
    s_waitcnt lgkmcnt(0)
    v_mfma_f32_16x16x32_bf16 v[16:19], a[120:123], a[12:15], v[16:19]
    ds_read_b128 a[96:99], v10 offset:0
    ds_read_b128 a[100:103], v10 offset:1024
    v_mfma_f32_16x16x32_bf16 v[20:23], a[124:127], a[12:15], v[20:23]
    ds_read_b128 a[104:107], v10 offset:2048
    ds_read_b128 a[108:111], v10 offset:3072
    v_mfma_f32_16x16x32_bf16 v[24:27], a[128:131], a[12:15], v[24:27]
    ds_read_b128 a[112:115], v10 offset:4096
    ds_read_b128 a[116:119], v10 offset:5120
    v_mfma_f32_16x16x32_bf16 v[28:31], a[132:135], a[12:15], v[28:31]
    s_add_u32 m0, s40, 126976
    s_nop 0
    buffer_load_dwordx4 v3, s[4:7], s38 offen lds
    v_mfma_f32_16x16x32_bf16 v[32:35], a[136:139], a[12:15], v[32:35]
    buffer_load_dwordx4 a[84:87], v8, s[8:11], s39 offen offset:1024 sc1
    v_mfma_f32_16x16x32_bf16 v[36:39], a[140:143], a[12:15], v[36:39]
    s_add_u32 m0, s40, 131072
    s_nop 0
    buffer_load_dwordx4 v4, s[4:7], s38 offen lds
    s_waitcnt lgkmcnt(0)
    v_mfma_f32_16x16x32_bf16 v[16:19], a[96:99], a[16:19], v[16:19]
    ds_read_b128 a[120:123], v10 offset:6144
    ds_read_b128 a[124:127], v10 offset:7168
    v_mfma_f32_16x16x32_bf16 v[20:23], a[100:103], a[16:19], v[20:23]
    ds_read_b128 a[128:131], v10 offset:8192
    ds_read_b128 a[132:135], v10 offset:9216
    v_mfma_f32_16x16x32_bf16 v[24:27], a[104:107], a[16:19], v[24:27]
    ds_read_b128 a[136:139], v10 offset:10240
    ds_read_b128 a[140:143], v10 offset:11264
    v_mfma_f32_16x16x32_bf16 v[28:31], a[108:111], a[16:19], v[28:31]
    buffer_load_dwordx4 a[88:91], v8, s[8:11], s39 offen offset:2048 sc1
    v_mfma_f32_16x16x32_bf16 v[32:35], a[112:115], a[16:19], v[32:35]
    s_add_u32 m0, s40, 135168
    s_nop 0
    buffer_load_dwordx4 v5, s[4:7], s38 offen lds
    v_mfma_f32_16x16x32_bf16 v[36:39], a[116:119], a[16:19], v[36:39]
    s_waitcnt lgkmcnt(0)
    v_mfma_f32_16x16x32_bf16 v[16:19], a[120:123], a[20:23], v[16:19]
    ds_read_b128 a[96:99], v10 offset:12288
    ds_read_b128 a[100:103], v10 offset:13312
    v_mfma_f32_16x16x32_bf16 v[20:23], a[124:127], a[20:23], v[20:23]
    ds_read_b128 a[104:107], v10 offset:14336
    ds_read_b128 a[108:111], v10 offset:15360
    v_mfma_f32_16x16x32_bf16 v[24:27], a[128:131], a[20:23], v[24:27]
    ds_read_b128 a[112:115], v10 offset:16384
    ds_read_b128 a[116:119], v10 offset:17408
    v_mfma_f32_16x16x32_bf16 v[28:31], a[132:135], a[20:23], v[28:31]
    buffer_load_dwordx4 a[92:95], v8, s[8:11], s39 offen offset:3072 sc1
    v_mfma_f32_16x16x32_bf16 v[32:35], a[136:139], a[20:23], v[32:35]
    s_add_u32 m0, s40, 139264
    s_nop 0
    buffer_load_dwordx4 v6, s[4:7], s38 offen lds
    v_mfma_f32_16x16x32_bf16 v[36:39], a[140:143], a[20:23], v[36:39]
    s_add_u32 m0, s40, 143360
    s_nop 0
    buffer_load_dwordx4 v7, s[4:7], s38 offen lds
    s_add_u32 s38, s38, 24576
    s_add_u32 s39, s39, 4096
    s_waitcnt vmcnt(30)
    s_barrier
    s_cmp_eq_u32 s37, 2
    s_cbranch_scc0 m_kernel_g3_g_sk_32
    v_mov_b32 v2, 0x80000000
    v_mov_b32 v3, 0x80000000
    v_mov_b32 v4, 0x80000000
    v_mov_b32 v5, 0x80000000
    v_mov_b32 v6, 0x80000000
    v_mov_b32 v7, 0x80000000
    v_mov_b32 v8, 0x80000000
    v_and_b32 v1, 15, v15
    s_lshl_b32 s44, s58, 4
    v_add_u32 v1, s44, v1
    v_mul_u32_u24 v1, 1152, v1
    v_lshrrev_b32 v40, 4, v15
    v_lshlrev_b32 v40, 3, v40
    v_add_u32 v1, v1, v40
    s_mul_i32 s44, s35, 192
    v_add_u32 v1, s44, v1

    buffer_load_dwordx2 v[52:53], v1, s[12:15], 0 offen offset:0
    buffer_load_dwordx2 v[54:55], v1, s[12:15], 0 offen offset:32
    buffer_load_dwordx2 v[56:57], v1, s[12:15], 0 offen offset:64
    buffer_load_dwordx2 v[58:59], v1, s[12:15], 0 offen offset:96
    buffer_load_dwordx2 v[60:61], v1, s[12:15], 0 offen offset:128
    buffer_load_dwordx2 v[62:63], v1, s[12:15], 0 offen offset:160
m_kernel_g3_g_sk_32:
    s_waitcnt lgkmcnt(0)
    v_mfma_f32_16x16x32_bf16 v[16:19], a[96:99], a[24:27], v[16:19]
    ds_read_b128 a[120:123], v10 offset:18432
    ds_read_b128 a[124:127], v10 offset:19456
    v_mfma_f32_16x16x32_bf16 v[20:23], a[100:103], a[24:27], v[20:23]
    ds_read_b128 a[128:131], v10 offset:20480
    ds_read_b128 a[132:135], v10 offset:21504
    v_mfma_f32_16x16x32_bf16 v[24:27], a[104:107], a[24:27], v[24:27]
    ds_read_b128 a[136:139], v10 offset:22528
    ds_read_b128 a[140:143], v10 offset:23552
    v_mfma_f32_16x16x32_bf16 v[28:31], a[108:111], a[24:27], v[28:31]
    s_add_u32 m0, s40, 0
    s_nop 0
    buffer_load_dwordx4 v2, s[4:7], s38 offen lds
    v_mfma_f32_16x16x32_bf16 v[32:35], a[112:115], a[24:27], v[32:35]
    buffer_load_dwordx4 a[0:3], v8, s[8:11], s39 offen offset:0 sc1
    v_mfma_f32_16x16x32_bf16 v[36:39], a[116:119], a[24:27], v[36:39]
    s_waitcnt lgkmcnt(0)
    v_mfma_f32_16x16x32_bf16 v[16:19], a[120:123], a[28:31], v[16:19]
    ds_read_b128 a[96:99], v11 offset:0
    ds_read_b128 a[100:103], v11 offset:1024
    v_mfma_f32_16x16x32_bf16 v[20:23], a[124:127], a[28:31], v[20:23]
    ds_read_b128 a[104:107], v11 offset:2048
    ds_read_b128 a[108:111], v11 offset:3072
    v_mfma_f32_16x16x32_bf16 v[24:27], a[128:131], a[28:31], v[24:27]
    ds_read_b128 a[112:115], v11 offset:4096
    ds_read_b128 a[116:119], v11 offset:5120
    v_mfma_f32_16x16x32_bf16 v[28:31], a[132:135], a[28:31], v[28:31]
    s_add_u32 m0, s40, 4096
    s_nop 0
    buffer_load_dwordx4 v3, s[4:7], s38 offen lds
    v_mfma_f32_16x16x32_bf16 v[32:35], a[136:139], a[28:31], v[32:35]
    buffer_load_dwordx4 a[4:7], v8, s[8:11], s39 offen offset:1024 sc1
    v_mfma_f32_16x16x32_bf16 v[36:39], a[140:143], a[28:31], v[36:39]
    s_add_u32 m0, s40, 8192
    s_nop 0
    buffer_load_dwordx4 v4, s[4:7], s38 offen lds
    s_waitcnt lgkmcnt(0)
    v_mfma_f32_16x16x32_bf16 v[16:19], a[96:99], a[32:35], v[16:19]
    ds_read_b128 a[120:123], v11 offset:6144
    ds_read_b128 a[124:127], v11 offset:7168
    v_mfma_f32_16x16x32_bf16 v[20:23], a[100:103], a[32:35], v[20:23]
    ds_read_b128 a[128:131], v11 offset:8192
    ds_read_b128 a[132:135], v11 offset:9216
    v_mfma_f32_16x16x32_bf16 v[24:27], a[104:107], a[32:35], v[24:27]
    ds_read_b128 a[136:139], v11 offset:10240
    ds_read_b128 a[140:143], v11 offset:11264
    v_mfma_f32_16x16x32_bf16 v[28:31], a[108:111], a[32:35], v[28:31]
    buffer_load_dwordx4 a[8:11], v8, s[8:11], s39 offen offset:2048 sc1
    v_mfma_f32_16x16x32_bf16 v[32:35], a[112:115], a[32:35], v[32:35]
    s_add_u32 m0, s40, 12288
    s_nop 0
    buffer_load_dwordx4 v5, s[4:7], s38 offen lds
    v_mfma_f32_16x16x32_bf16 v[36:39], a[116:119], a[32:35], v[36:39]
    s_waitcnt lgkmcnt(0)
    v_mfma_f32_16x16x32_bf16 v[16:19], a[120:123], a[36:39], v[16:19]
    ds_read_b128 a[96:99], v11 offset:12288
    ds_read_b128 a[100:103], v11 offset:13312
    v_mfma_f32_16x16x32_bf16 v[20:23], a[124:127], a[36:39], v[20:23]
    ds_read_b128 a[104:107], v11 offset:14336
    ds_read_b128 a[108:111], v11 offset:15360
    v_mfma_f32_16x16x32_bf16 v[24:27], a[128:131], a[36:39], v[24:27]
    ds_read_b128 a[112:115], v11 offset:16384
    ds_read_b128 a[116:119], v11 offset:17408
    v_mfma_f32_16x16x32_bf16 v[28:31], a[132:135], a[36:39], v[28:31]
    buffer_load_dwordx4 a[12:15], v8, s[8:11], s39 offen offset:3072 sc1
    v_mfma_f32_16x16x32_bf16 v[32:35], a[136:139], a[36:39], v[32:35]
    s_add_u32 m0, s40, 16384
    s_nop 0
    buffer_load_dwordx4 v6, s[4:7], s38 offen lds
    v_mfma_f32_16x16x32_bf16 v[36:39], a[140:143], a[36:39], v[36:39]
    s_add_u32 m0, s40, 20480
    s_nop 0
    buffer_load_dwordx4 v7, s[4:7], s38 offen lds
    s_add_u32 s38, s38, 24576
    s_add_u32 s39, s39, 4096
    s_waitcnt vmcnt(30)
    s_barrier
    s_waitcnt lgkmcnt(0)
    v_mfma_f32_16x16x32_bf16 v[16:19], a[96:99], a[40:43], v[16:19]
    ds_read_b128 a[120:123], v11 offset:18432
    ds_read_b128 a[124:127], v11 offset:19456
    v_mfma_f32_16x16x32_bf16 v[20:23], a[100:103], a[40:43], v[20:23]
    ds_read_b128 a[128:131], v11 offset:20480
    ds_read_b128 a[132:135], v11 offset:21504
    v_mfma_f32_16x16x32_bf16 v[24:27], a[104:107], a[40:43], v[24:27]
    ds_read_b128 a[136:139], v11 offset:22528
    ds_read_b128 a[140:143], v11 offset:23552
    v_mfma_f32_16x16x32_bf16 v[28:31], a[108:111], a[40:43], v[28:31]
    s_add_u32 m0, s40, 24576
    s_nop 0
    buffer_load_dwordx4 v2, s[4:7], s38 offen lds
    v_mfma_f32_16x16x32_bf16 v[32:35], a[112:115], a[40:43], v[32:35]
    buffer_load_dwordx4 a[16:19], v8, s[8:11], s39 offen offset:0 sc1
    v_mfma_f32_16x16x32_bf16 v[36:39], a[116:119], a[40:43], v[36:39]
    s_waitcnt lgkmcnt(0)
    v_mfma_f32_16x16x32_bf16 v[16:19], a[120:123], a[44:47], v[16:19]
    ds_read_b128 a[96:99], v12 offset:0
    ds_read_b128 a[100:103], v12 offset:1024
    v_mfma_f32_16x16x32_bf16 v[20:23], a[124:127], a[44:47], v[20:23]
    ds_read_b128 a[104:107], v12 offset:2048
    ds_read_b128 a[108:111], v12 offset:3072
    v_mfma_f32_16x16x32_bf16 v[24:27], a[128:131], a[44:47], v[24:27]
    ds_read_b128 a[112:115], v12 offset:4096
    ds_read_b128 a[116:119], v12 offset:5120
    v_mfma_f32_16x16x32_bf16 v[28:31], a[132:135], a[44:47], v[28:31]
    s_add_u32 m0, s40, 28672
    s_nop 0
    buffer_load_dwordx4 v3, s[4:7], s38 offen lds
    v_mfma_f32_16x16x32_bf16 v[32:35], a[136:139], a[44:47], v[32:35]
    buffer_load_dwordx4 a[20:23], v8, s[8:11], s39 offen offset:1024 sc1
    v_mfma_f32_16x16x32_bf16 v[36:39], a[140:143], a[44:47], v[36:39]
    s_add_u32 m0, s40, 32768
    s_nop 0
    buffer_load_dwordx4 v4, s[4:7], s38 offen lds
    s_waitcnt lgkmcnt(0)
    v_mfma_f32_16x16x32_bf16 v[16:19], a[96:99], a[48:51], v[16:19]
    ds_read_b128 a[120:123], v12 offset:6144
    ds_read_b128 a[124:127], v12 offset:7168
    v_mfma_f32_16x16x32_bf16 v[20:23], a[100:103], a[48:51], v[20:23]
    ds_read_b128 a[128:131], v12 offset:8192
    ds_read_b128 a[132:135], v12 offset:9216
    v_mfma_f32_16x16x32_bf16 v[24:27], a[104:107], a[48:51], v[24:27]
    ds_read_b128 a[136:139], v12 offset:10240
    ds_read_b128 a[140:143], v12 offset:11264
    v_mfma_f32_16x16x32_bf16 v[28:31], a[108:111], a[48:51], v[28:31]
    buffer_load_dwordx4 a[24:27], v8, s[8:11], s39 offen offset:2048 sc1
    v_mfma_f32_16x16x32_bf16 v[32:35], a[112:115], a[48:51], v[32:35]
    s_add_u32 m0, s40, 36864
    s_nop 0
    buffer_load_dwordx4 v5, s[4:7], s38 offen lds
    v_mfma_f32_16x16x32_bf16 v[36:39], a[116:119], a[48:51], v[36:39]
    s_waitcnt lgkmcnt(0)
    v_mfma_f32_16x16x32_bf16 v[16:19], a[120:123], a[52:55], v[16:19]
    ds_read_b128 a[96:99], v12 offset:12288
    ds_read_b128 a[100:103], v12 offset:13312
    v_mfma_f32_16x16x32_bf16 v[20:23], a[124:127], a[52:55], v[20:23]
    ds_read_b128 a[104:107], v12 offset:14336
    ds_read_b128 a[108:111], v12 offset:15360
    v_mfma_f32_16x16x32_bf16 v[24:27], a[128:131], a[52:55], v[24:27]
    ds_read_b128 a[112:115], v12 offset:16384
    ds_read_b128 a[116:119], v12 offset:17408
    v_mfma_f32_16x16x32_bf16 v[28:31], a[132:135], a[52:55], v[28:31]
    buffer_load_dwordx4 a[28:31], v8, s[8:11], s39 offen offset:3072 sc1
    v_mfma_f32_16x16x32_bf16 v[32:35], a[136:139], a[52:55], v[32:35]
    s_add_u32 m0, s40, 40960
    s_nop 0
    buffer_load_dwordx4 v6, s[4:7], s38 offen lds
    v_mfma_f32_16x16x32_bf16 v[36:39], a[140:143], a[52:55], v[36:39]
    s_add_u32 m0, s40, 45056
    s_nop 0
    buffer_load_dwordx4 v7, s[4:7], s38 offen lds
    s_add_u32 s38, s38, 24576
    s_add_u32 s39, s39, 4096
    s_waitcnt vmcnt(30)
    s_barrier
    s_waitcnt lgkmcnt(0)
    v_mfma_f32_16x16x32_bf16 v[16:19], a[96:99], a[56:59], v[16:19]
    ds_read_b128 a[120:123], v12 offset:18432
    ds_read_b128 a[124:127], v12 offset:19456
    v_mfma_f32_16x16x32_bf16 v[20:23], a[100:103], a[56:59], v[20:23]
    ds_read_b128 a[128:131], v12 offset:20480
    ds_read_b128 a[132:135], v12 offset:21504
    v_mfma_f32_16x16x32_bf16 v[24:27], a[104:107], a[56:59], v[24:27]
    ds_read_b128 a[136:139], v12 offset:22528
    ds_read_b128 a[140:143], v12 offset:23552
    v_mfma_f32_16x16x32_bf16 v[28:31], a[108:111], a[56:59], v[28:31]
    s_add_u32 m0, s40, 49152
    s_nop 0
    buffer_load_dwordx4 v2, s[4:7], s38 offen lds
    v_mfma_f32_16x16x32_bf16 v[32:35], a[112:115], a[56:59], v[32:35]
    buffer_load_dwordx4 a[32:35], v8, s[8:11], s39 offen offset:0 sc1
    v_mfma_f32_16x16x32_bf16 v[36:39], a[116:119], a[56:59], v[36:39]
    s_waitcnt lgkmcnt(0)
    v_mfma_f32_16x16x32_bf16 v[16:19], a[120:123], a[60:63], v[16:19]
    ds_read_b128 a[96:99], v13 offset:0
    ds_read_b128 a[100:103], v13 offset:1024
    v_mfma_f32_16x16x32_bf16 v[20:23], a[124:127], a[60:63], v[20:23]
    ds_read_b128 a[104:107], v13 offset:2048
    ds_read_b128 a[108:111], v13 offset:3072
    v_mfma_f32_16x16x32_bf16 v[24:27], a[128:131], a[60:63], v[24:27]
    ds_read_b128 a[112:115], v13 offset:4096
    ds_read_b128 a[116:119], v13 offset:5120
    v_mfma_f32_16x16x32_bf16 v[28:31], a[132:135], a[60:63], v[28:31]
    s_add_u32 m0, s40, 53248
    s_nop 0
    buffer_load_dwordx4 v3, s[4:7], s38 offen lds
    v_mfma_f32_16x16x32_bf16 v[32:35], a[136:139], a[60:63], v[32:35]
    buffer_load_dwordx4 a[36:39], v8, s[8:11], s39 offen offset:1024 sc1
    v_mfma_f32_16x16x32_bf16 v[36:39], a[140:143], a[60:63], v[36:39]
    s_add_u32 m0, s40, 57344
    s_nop 0
    buffer_load_dwordx4 v4, s[4:7], s38 offen lds
    s_waitcnt lgkmcnt(0)
    v_mfma_f32_16x16x32_bf16 v[16:19], a[96:99], a[64:67], v[16:19]
    ds_read_b128 a[120:123], v13 offset:6144
    ds_read_b128 a[124:127], v13 offset:7168
    v_mfma_f32_16x16x32_bf16 v[20:23], a[100:103], a[64:67], v[20:23]
    ds_read_b128 a[128:131], v13 offset:8192
    ds_read_b128 a[132:135], v13 offset:9216
    v_mfma_f32_16x16x32_bf16 v[24:27], a[104:107], a[64:67], v[24:27]
    ds_read_b128 a[136:139], v13 offset:10240
    ds_read_b128 a[140:143], v13 offset:11264
    v_mfma_f32_16x16x32_bf16 v[28:31], a[108:111], a[64:67], v[28:31]
    buffer_load_dwordx4 a[40:43], v8, s[8:11], s39 offen offset:2048 sc1
    v_mfma_f32_16x16x32_bf16 v[32:35], a[112:115], a[64:67], v[32:35]
    s_add_u32 m0, s40, 61440
    s_nop 0
    buffer_load_dwordx4 v5, s[4:7], s38 offen lds
    v_mfma_f32_16x16x32_bf16 v[36:39], a[116:119], a[64:67], v[36:39]
    s_waitcnt lgkmcnt(0)
    v_mfma_f32_16x16x32_bf16 v[16:19], a[120:123], a[68:71], v[16:19]
    ds_read_b128 a[96:99], v13 offset:12288
    ds_read_b128 a[100:103], v13 offset:13312
    v_mfma_f32_16x16x32_bf16 v[20:23], a[124:127], a[68:71], v[20:23]
    ds_read_b128 a[104:107], v13 offset:14336
    ds_read_b128 a[108:111], v13 offset:15360
    v_mfma_f32_16x16x32_bf16 v[24:27], a[128:131], a[68:71], v[24:27]
    ds_read_b128 a[112:115], v13 offset:16384
    ds_read_b128 a[116:119], v13 offset:17408
    v_mfma_f32_16x16x32_bf16 v[28:31], a[132:135], a[68:71], v[28:31]
    buffer_load_dwordx4 a[44:47], v8, s[8:11], s39 offen offset:3072 sc1
    v_mfma_f32_16x16x32_bf16 v[32:35], a[136:139], a[68:71], v[32:35]
    s_add_u32 m0, s40, 65536
    s_nop 0
    buffer_load_dwordx4 v6, s[4:7], s38 offen lds
    v_mfma_f32_16x16x32_bf16 v[36:39], a[140:143], a[68:71], v[36:39]
    s_add_u32 m0, s40, 69632
    s_nop 0
    buffer_load_dwordx4 v7, s[4:7], s38 offen lds
    s_add_u32 s38, s38, 24576
    s_add_u32 s39, s39, 4096
    s_waitcnt vmcnt(30)
    s_barrier
    s_cmp_eq_u32 s37, 2
    s_cbranch_scc0 m_kernel_g3_g_lk_33
    s_add_u32 s24, s32, 49283072
    s_addc_u32 s25, s33, 0
    s_and_b32 s25, s25, 0xffff
    s_mov_b32 s26, 524288
    s_mov_b32 s27, 0x00020000
    s_add_u32 s44, s35, 48
    s_lshl_b32 s44, s44, 6
    s_add_u32 s44, s44, 0
    s_lshl_b32 s44, s44, 7
    v_lshlrev_b32 v250, 7, v15
    v_add_u32 v250, s44, v250
    s_mov_b32 s46, 0xffffffff
    s_mov_b32 s47, 0xffff
m_kernel_g3_pl_35:
    buffer_load_dword v251, v250, s[24:27], 0 offen sc1
    s_waitcnt vmcnt(0)
    v_cmp_eq_u32 s[48:49], 1, v251
    s_and_b64 s[48:49], s[48:49], s[46:47]
    s_cmp_eq_u64 s[48:49], s[46:47]
    s_cbranch_scc1 m_kernel_g3_wf_34
    s_sleep 2
    s_branch m_kernel_g3_pl_35
m_kernel_g3_wf_34:
    v_lshrrev_b32 v42, 4, v15
    v_lshlrev_b32 v42, 14, v42
    v_and_b32 v43, 15, v15
    v_lshlrev_b32 v43, 2, v43
    v_add_u32 v42, v42, v43
    s_mul_i32 s44, s35, 393216
    s_lshl_b32 s45, s58, 6
    s_add_u32 s44, s44, s45

    s_add_u32 s45, s44, 0
    buffer_load_dword v64, v42, s[16:19], s45 offen sc1
    s_add_u32 s45, s44, 8192
    buffer_load_dword v65, v42, s[16:19], s45 offen sc1
    s_add_u32 s45, s44, 65536
    buffer_load_dword v66, v42, s[16:19], s45 offen sc1
    s_add_u32 s45, s44, 73728
    buffer_load_dword v67, v42, s[16:19], s45 offen sc1
    s_add_u32 s45, s44, 131072
    buffer_load_dword v68, v42, s[16:19], s45 offen sc1
    s_add_u32 s45, s44, 139264
    buffer_load_dword v69, v42, s[16:19], s45 offen sc1
    s_add_u32 s45, s44, 196608
    buffer_load_dword v70, v42, s[16:19], s45 offen sc1
    s_add_u32 s45, s44, 204800
    buffer_load_dword v71, v42, s[16:19], s45 offen sc1
    s_add_u32 s45, s44, 262144
    buffer_load_dword v72, v42, s[16:19], s45 offen sc1
    s_add_u32 s45, s44, 270336
    buffer_load_dword v73, v42, s[16:19], s45 offen sc1
    s_add_u32 s45, s44, 327680
    buffer_load_dword v74, v42, s[16:19], s45 offen sc1
    s_add_u32 s45, s44, 335872
    buffer_load_dword v75, v42, s[16:19], s45 offen sc1
m_kernel_g3_g_lk_33:
    s_waitcnt lgkmcnt(0)
    v_mfma_f32_16x16x32_bf16 v[16:19], a[96:99], a[72:75], v[16:19]
    ds_read_b128 a[120:123], v13 offset:18432
    ds_read_b128 a[124:127], v13 offset:19456
    v_mfma_f32_16x16x32_bf16 v[20:23], a[100:103], a[72:75], v[20:23]
    ds_read_b128 a[128:131], v13 offset:20480
    ds_read_b128 a[132:135], v13 offset:21504
    v_mfma_f32_16x16x32_bf16 v[24:27], a[104:107], a[72:75], v[24:27]
    ds_read_b128 a[136:139], v13 offset:22528
    ds_read_b128 a[140:143], v13 offset:23552
    v_mfma_f32_16x16x32_bf16 v[28:31], a[108:111], a[72:75], v[28:31]
    s_add_u32 m0, s40, 73728
    s_nop 0
    buffer_load_dwordx4 v2, s[4:7], s38 offen lds
    v_mfma_f32_16x16x32_bf16 v[32:35], a[112:115], a[72:75], v[32:35]
    buffer_load_dwordx4 a[48:51], v8, s[8:11], s39 offen offset:0 sc1
    v_mfma_f32_16x16x32_bf16 v[36:39], a[116:119], a[72:75], v[36:39]
    s_waitcnt lgkmcnt(0)
    v_mfma_f32_16x16x32_bf16 v[16:19], a[120:123], a[76:79], v[16:19]
    ds_read_b128 a[96:99], v14 offset:0
    ds_read_b128 a[100:103], v14 offset:1024
    v_mfma_f32_16x16x32_bf16 v[20:23], a[124:127], a[76:79], v[20:23]
    ds_read_b128 a[104:107], v14 offset:2048
    ds_read_b128 a[108:111], v14 offset:3072
    v_mfma_f32_16x16x32_bf16 v[24:27], a[128:131], a[76:79], v[24:27]
    ds_read_b128 a[112:115], v14 offset:4096
    ds_read_b128 a[116:119], v14 offset:5120
    v_mfma_f32_16x16x32_bf16 v[28:31], a[132:135], a[76:79], v[28:31]
    s_add_u32 m0, s40, 77824
    s_nop 0
    buffer_load_dwordx4 v3, s[4:7], s38 offen lds
    v_mfma_f32_16x16x32_bf16 v[32:35], a[136:139], a[76:79], v[32:35]
    buffer_load_dwordx4 a[52:55], v8, s[8:11], s39 offen offset:1024 sc1
    v_mfma_f32_16x16x32_bf16 v[36:39], a[140:143], a[76:79], v[36:39]
    s_add_u32 m0, s40, 81920
    s_nop 0
    buffer_load_dwordx4 v4, s[4:7], s38 offen lds
    s_waitcnt lgkmcnt(0)
    v_mfma_f32_16x16x32_bf16 v[16:19], a[96:99], a[80:83], v[16:19]
    ds_read_b128 a[120:123], v14 offset:6144
    ds_read_b128 a[124:127], v14 offset:7168
    v_mfma_f32_16x16x32_bf16 v[20:23], a[100:103], a[80:83], v[20:23]
    ds_read_b128 a[128:131], v14 offset:8192
    ds_read_b128 a[132:135], v14 offset:9216
    v_mfma_f32_16x16x32_bf16 v[24:27], a[104:107], a[80:83], v[24:27]
    ds_read_b128 a[136:139], v14 offset:10240
    ds_read_b128 a[140:143], v14 offset:11264
    v_mfma_f32_16x16x32_bf16 v[28:31], a[108:111], a[80:83], v[28:31]
    buffer_load_dwordx4 a[56:59], v8, s[8:11], s39 offen offset:2048 sc1
    v_mfma_f32_16x16x32_bf16 v[32:35], a[112:115], a[80:83], v[32:35]
    s_add_u32 m0, s40, 86016
    s_nop 0
    buffer_load_dwordx4 v5, s[4:7], s38 offen lds
    v_mfma_f32_16x16x32_bf16 v[36:39], a[116:119], a[80:83], v[36:39]
    s_waitcnt lgkmcnt(0)
    v_mfma_f32_16x16x32_bf16 v[16:19], a[120:123], a[84:87], v[16:19]
    ds_read_b128 a[96:99], v14 offset:12288
    ds_read_b128 a[100:103], v14 offset:13312
    v_mfma_f32_16x16x32_bf16 v[20:23], a[124:127], a[84:87], v[20:23]
    ds_read_b128 a[104:107], v14 offset:14336
    ds_read_b128 a[108:111], v14 offset:15360
    v_mfma_f32_16x16x32_bf16 v[24:27], a[128:131], a[84:87], v[24:27]
    ds_read_b128 a[112:115], v14 offset:16384
    ds_read_b128 a[116:119], v14 offset:17408
    v_mfma_f32_16x16x32_bf16 v[28:31], a[132:135], a[84:87], v[28:31]
    buffer_load_dwordx4 a[60:63], v8, s[8:11], s39 offen offset:3072 sc1
    v_mfma_f32_16x16x32_bf16 v[32:35], a[136:139], a[84:87], v[32:35]
    s_add_u32 m0, s40, 90112
    s_nop 0
    buffer_load_dwordx4 v6, s[4:7], s38 offen lds
    v_mfma_f32_16x16x32_bf16 v[36:39], a[140:143], a[84:87], v[36:39]
    s_add_u32 m0, s40, 94208
    s_nop 0
    buffer_load_dwordx4 v7, s[4:7], s38 offen lds
    s_add_u32 s38, s38, 24576
    s_add_u32 s39, s39, 4096
    s_waitcnt vmcnt(30)
    s_barrier
    s_waitcnt lgkmcnt(0)
    v_mfma_f32_16x16x32_bf16 v[16:19], a[96:99], a[88:91], v[16:19]
    ds_read_b128 a[120:123], v14 offset:18432
    ds_read_b128 a[124:127], v14 offset:19456
    v_mfma_f32_16x16x32_bf16 v[20:23], a[100:103], a[88:91], v[20:23]
    ds_read_b128 a[128:131], v14 offset:20480
    ds_read_b128 a[132:135], v14 offset:21504
    v_mfma_f32_16x16x32_bf16 v[24:27], a[104:107], a[88:91], v[24:27]
    ds_read_b128 a[136:139], v14 offset:22528
    ds_read_b128 a[140:143], v14 offset:23552
    v_mfma_f32_16x16x32_bf16 v[28:31], a[108:111], a[88:91], v[28:31]
    s_add_u32 m0, s40, 98304
    s_nop 0
    buffer_load_dwordx4 v2, s[4:7], s38 offen lds
    v_mfma_f32_16x16x32_bf16 v[32:35], a[112:115], a[88:91], v[32:35]
    buffer_load_dwordx4 a[64:67], v8, s[8:11], s39 offen offset:0 sc1
    v_mfma_f32_16x16x32_bf16 v[36:39], a[116:119], a[88:91], v[36:39]
    s_waitcnt lgkmcnt(0)
    v_mfma_f32_16x16x32_bf16 v[16:19], a[120:123], a[92:95], v[16:19]
    ds_read_b128 a[96:99], v9 offset:0
    ds_read_b128 a[100:103], v9 offset:1024
    v_mfma_f32_16x16x32_bf16 v[20:23], a[124:127], a[92:95], v[20:23]
    ds_read_b128 a[104:107], v9 offset:2048
    ds_read_b128 a[108:111], v9 offset:3072
    v_mfma_f32_16x16x32_bf16 v[24:27], a[128:131], a[92:95], v[24:27]
    ds_read_b128 a[112:115], v9 offset:4096
    ds_read_b128 a[116:119], v9 offset:5120
    v_mfma_f32_16x16x32_bf16 v[28:31], a[132:135], a[92:95], v[28:31]
    s_add_u32 m0, s40, 102400
    s_nop 0
    buffer_load_dwordx4 v3, s[4:7], s38 offen lds
    v_mfma_f32_16x16x32_bf16 v[32:35], a[136:139], a[92:95], v[32:35]
    buffer_load_dwordx4 a[68:71], v8, s[8:11], s39 offen offset:1024 sc1
    v_mfma_f32_16x16x32_bf16 v[36:39], a[140:143], a[92:95], v[36:39]
    s_add_u32 m0, s40, 106496
    s_nop 0
    buffer_load_dwordx4 v4, s[4:7], s38 offen lds
    s_add_u32 s37, s37, 1
    s_cmp_lt_u32 s37, 3
    s_cbranch_scc1 m_kernel_g3_g_loop
    v_mov_b32 v76, 0xbfb8aa3b
    v_mov_b32 v77, 0xbfb8aa3b
    v_mov_b32 v78, 1.0
    v_mov_b32 v79, 1.0
    v_pk_mul_f32 v[80:81], v[16:17], v[76:77]
    v_pk_mul_f32 v[82:83], v[18:19], v[76:77]
    v_exp_f32 v80, v80
    v_exp_f32 v81, v81
    v_exp_f32 v82, v82
    v_exp_f32 v83, v83
    v_pk_add_f32 v[80:81], v[80:81], v[78:79]
    v_pk_add_f32 v[82:83], v[82:83], v[78:79]
    v_rcp_f32 v80, v80
    v_rcp_f32 v81, v81
    v_rcp_f32 v82, v82
    v_rcp_f32 v83, v83
    s_nop 0
    v_pk_mul_f32 v[16:17], v[16:17], v[80:81]
    v_pk_mul_f32 v[18:19], v[18:19], v[82:83]
    v_pk_mul_f32 v[84:85], v[20:21], v[76:77]
    v_pk_mul_f32 v[86:87], v[22:23], v[76:77]
    v_exp_f32 v84, v84
    v_exp_f32 v85, v85
    v_exp_f32 v86, v86
    v_exp_f32 v87, v87
    v_pk_add_f32 v[84:85], v[84:85], v[78:79]
    v_pk_add_f32 v[86:87], v[86:87], v[78:79]
    v_rcp_f32 v84, v84
    v_rcp_f32 v85, v85
    v_rcp_f32 v86, v86
    v_rcp_f32 v87, v87
    s_nop 0
    v_pk_mul_f32 v[20:21], v[20:21], v[84:85]
    v_pk_mul_f32 v[22:23], v[22:23], v[86:87]
    v_pk_mul_f32 v[80:81], v[24:25], v[76:77]
    v_pk_mul_f32 v[82:83], v[26:27], v[76:77]
    v_exp_f32 v80, v80
    v_exp_f32 v81, v81
    v_exp_f32 v82, v82
    v_exp_f32 v83, v83
    v_pk_add_f32 v[80:81], v[80:81], v[78:79]
    v_pk_add_f32 v[82:83], v[82:83], v[78:79]
    v_rcp_f32 v80, v80
    v_rcp_f32 v81, v81
    v_rcp_f32 v82, v82
    v_rcp_f32 v83, v83
    s_nop 0
    v_pk_mul_f32 v[24:25], v[24:25], v[80:81]
    v_pk_mul_f32 v[26:27], v[26:27], v[82:83]
    v_pk_mul_f32 v[84:85], v[28:29], v[76:77]
    v_pk_mul_f32 v[86:87], v[30:31], v[76:77]
    v_exp_f32 v84, v84
    v_exp_f32 v85, v85
    v_exp_f32 v86, v86
    v_exp_f32 v87, v87
    v_pk_add_f32 v[84:85], v[84:85], v[78:79]
    v_pk_add_f32 v[86:87], v[86:87], v[78:79]
    v_rcp_f32 v84, v84
    v_rcp_f32 v85, v85
    v_rcp_f32 v86, v86
    v_rcp_f32 v87, v87
    s_nop 0
    v_pk_mul_f32 v[28:29], v[28:29], v[84:85]
    v_pk_mul_f32 v[30:31], v[30:31], v[86:87]
    v_pk_mul_f32 v[80:81], v[32:33], v[76:77]
    v_pk_mul_f32 v[82:83], v[34:35], v[76:77]
    v_exp_f32 v80, v80
    v_exp_f32 v81, v81
    v_exp_f32 v82, v82
    v_exp_f32 v83, v83
    v_pk_add_f32 v[80:81], v[80:81], v[78:79]
    v_pk_add_f32 v[82:83], v[82:83], v[78:79]
    v_rcp_f32 v80, v80
    v_rcp_f32 v81, v81
    v_rcp_f32 v82, v82
    v_rcp_f32 v83, v83
    s_nop 0
    v_pk_mul_f32 v[32:33], v[32:33], v[80:81]
    v_pk_mul_f32 v[34:35], v[34:35], v[82:83]
    v_pk_mul_f32 v[84:85], v[36:37], v[76:77]
    v_pk_mul_f32 v[86:87], v[38:39], v[76:77]
    v_exp_f32 v84, v84
    v_exp_f32 v85, v85
    v_exp_f32 v86, v86
    v_exp_f32 v87, v87
    v_pk_add_f32 v[84:85], v[84:85], v[78:79]
    v_pk_add_f32 v[86:87], v[86:87], v[78:79]
    v_rcp_f32 v84, v84
    v_rcp_f32 v85, v85
    v_rcp_f32 v86, v86
    v_rcp_f32 v87, v87
    s_nop 0
    v_pk_mul_f32 v[36:37], v[36:37], v[84:85]
    v_pk_mul_f32 v[38:39], v[38:39], v[86:87]
    s_waitcnt vmcnt(0)
    v_lshlrev_b32 v92, 16, v64
    v_and_b32 v93, 0xffff0000, v64
    v_lshlrev_b32 v94, 16, v65
    v_and_b32 v95, 0xffff0000, v65
    v_lshlrev_b32 v88, 16, v52
    v_and_b32 v89, 0xffff0000, v52
    v_lshlrev_b32 v90, 16, v53
    v_and_b32 v91, 0xffff0000, v53
    v_pk_fma_f32 v[16:17], v[16:17], v[92:93], v[88:89]
    v_pk_fma_f32 v[18:19], v[18:19], v[94:95], v[90:91]
    v_cvt_pk_bf16_f32 v104, v16, v17
    v_cvt_pk_bf16_f32 v105, v18, v19
    v_lshlrev_b32 v100, 16, v66
    v_and_b32 v101, 0xffff0000, v66
    v_lshlrev_b32 v102, 16, v67
    v_and_b32 v103, 0xffff0000, v67
    v_lshlrev_b32 v96, 16, v54
    v_and_b32 v97, 0xffff0000, v54
    v_lshlrev_b32 v98, 16, v55
    v_and_b32 v99, 0xffff0000, v55
    v_pk_fma_f32 v[20:21], v[20:21], v[100:101], v[96:97]
    v_pk_fma_f32 v[22:23], v[22:23], v[102:103], v[98:99]
    v_cvt_pk_bf16_f32 v106, v20, v21
    v_cvt_pk_bf16_f32 v107, v22, v23
    v_lshlrev_b32 v92, 16, v68
    v_and_b32 v93, 0xffff0000, v68
    v_lshlrev_b32 v94, 16, v69
    v_and_b32 v95, 0xffff0000, v69
    v_lshlrev_b32 v88, 16, v56
    v_and_b32 v89, 0xffff0000, v56
    v_lshlrev_b32 v90, 16, v57
    v_and_b32 v91, 0xffff0000, v57
    v_pk_fma_f32 v[24:25], v[24:25], v[92:93], v[88:89]
    v_pk_fma_f32 v[26:27], v[26:27], v[94:95], v[90:91]
    v_cvt_pk_bf16_f32 v108, v24, v25
    v_cvt_pk_bf16_f32 v109, v26, v27
    v_lshlrev_b32 v100, 16, v70
    v_and_b32 v101, 0xffff0000, v70
    v_lshlrev_b32 v102, 16, v71
    v_and_b32 v103, 0xffff0000, v71
    v_lshlrev_b32 v96, 16, v58
    v_and_b32 v97, 0xffff0000, v58
    v_lshlrev_b32 v98, 16, v59
    v_and_b32 v99, 0xffff0000, v59
    v_pk_fma_f32 v[28:29], v[28:29], v[100:101], v[96:97]
    v_pk_fma_f32 v[30:31], v[30:31], v[102:103], v[98:99]
    v_cvt_pk_bf16_f32 v110, v28, v29
    v_cvt_pk_bf16_f32 v111, v30, v31
    v_lshlrev_b32 v92, 16, v72
    v_and_b32 v93, 0xffff0000, v72
    v_lshlrev_b32 v94, 16, v73
    v_and_b32 v95, 0xffff0000, v73
    v_lshlrev_b32 v88, 16, v60
    v_and_b32 v89, 0xffff0000, v60
    v_lshlrev_b32 v90, 16, v61
    v_and_b32 v91, 0xffff0000, v61
    v_pk_fma_f32 v[32:33], v[32:33], v[92:93], v[88:89]
    v_pk_fma_f32 v[34:35], v[34:35], v[94:95], v[90:91]
    v_cvt_pk_bf16_f32 v112, v32, v33
    v_cvt_pk_bf16_f32 v113, v34, v35
    v_lshlrev_b32 v100, 16, v74
    v_and_b32 v101, 0xffff0000, v74
    v_lshlrev_b32 v102, 16, v75
    v_and_b32 v103, 0xffff0000, v75
    v_lshlrev_b32 v96, 16, v62
    v_and_b32 v97, 0xffff0000, v62
    v_lshlrev_b32 v98, 16, v63
    v_and_b32 v99, 0xffff0000, v63
    v_pk_fma_f32 v[36:37], v[36:37], v[100:101], v[96:97]
    v_pk_fma_f32 v[38:39], v[38:39], v[102:103], v[98:99]
    v_cvt_pk_bf16_f32 v114, v36, v37
    v_cvt_pk_bf16_f32 v115, v38, v39
    v_and_b32 v1, 15, v15
    s_lshl_b32 s44, s58, 4
    v_add_u32 v1, s44, v1
    v_mul_u32_u24 v1, 1152, v1
    v_bfe_u32 v12, v15, 4, 1
    v_lshlrev_b32 v12, 5, v12
    v_add_u32 v1, v1, v12
    v_lshrrev_b32 v12, 5, v15
    v_lshlrev_b32 v12, 4, v12
    v_add_u32 v1, v1, v12
    s_mul_i32 s44, s35, 192
    v_add_u32 v1, s44, v1

    v_permlane16_swap_b32 v104, v106
    v_permlane16_swap_b32 v105, v107
    v_permlane16_swap_b32 v108, v110
    v_permlane16_swap_b32 v109, v111
    v_permlane16_swap_b32 v112, v114
    v_permlane16_swap_b32 v113, v115
    s_nop 0
    buffer_store_dwordx4 v[104:107], v1, s[20:23], 0 offen offset:0
    buffer_store_dwordx4 v[108:111], v1, s[20:23], 0 offen offset:64
    buffer_store_dwordx4 v[112:115], v1, s[20:23], 0 offen offset:128
    s_branch m_kernel_fin_28
m_kernel_x_27:
    s_waitcnt vmcnt(0)
    s_barrier
    s_cmp_eq_u32 s36, 0
    s_cbranch_scc0 m_kernel_sg_36
    s_add_u32 s24, s32, 49283072
    s_addc_u32 s25, s33, 0
    s_and_b32 s25, s25, 0xffff
    s_mov_b32 s26, 524288
    s_mov_b32 s27, 0x00020000
    v_mov_b32 v251, 1
    s_mov_b64 exec, 1
    s_mul_i32 s45, s72, 1366
    s_lshr_b32 s45, s45, 16
    s_mul_i32 s46, s45, 48
    s_sub_u32 s46, s72, s46
    s_add_u32 s44, s45, 48
    s_lshl_b32 s44, s44, 6
    s_add_u32 s44, s44, s46
    s_lshl_b32 s44, s44, 7
    v_mov_b32 v250, s44
    buffer_store_dword v251, v250, s[24:27], 0 offen sc1
    s_mov_b64 exec, -1
m_kernel_sg_36:
    s_sub_u32 s44, s2, 192
    s_cmp_ge_u32 s44, 32
    s_cbranch_scc1 m_kernel_fin_28
    s_add_u32 s72, s2, 64
    s_lshl_b32 s70, s72, 1
    s_add_u32 s71, s70, 1
    s_mov_b32 s73, s70
    s_getpc_b64 s[28:29]
m_kernel_pc_38:
    s_sub_u32 s28, s28, m_kernel_pc_38-m_kernel_subP
    s_subb_u32 s29, s29, 0
    s_swappc_b64 s[30:31], s[28:29]
    s_mov_b32 s61, -1
    s_mov_b32 s62, -1
    s_mov_b32 s60, 0
    s_waitcnt vmcnt(0)
    s_getpc_b64 s[28:29]
m_kernel_pc_39:
    s_sub_u32 s28, s28, m_kernel_pc_39-m_kernel_subC
    s_subb_u32 s29, s29, 0
    s_swappc_b64 s[30:31], s[28:29]
    s_getpc_b64 s[28:29]
m_kernel_pc_40:
    s_sub_u32 s28, s28, m_kernel_pc_40-m_kernel_subF
    s_subb_u32 s29, s29, 0
    s_swappc_b64 s[30:31], s[28:29]
    s_barrier
    s_mov_b32 s73, s71
    s_getpc_b64 s[28:29]
m_kernel_pc_41:
    s_sub_u32 s28, s28, m_kernel_pc_41-m_kernel_subP
    s_subb_u32 s29, s29, 0
    s_swappc_b64 s[30:31], s[28:29]
    s_mov_b32 s61, -1
    s_mov_b32 s62, -1
    s_mov_b32 s60, 1
    s_waitcnt vmcnt(0)
    s_getpc_b64 s[28:29]
m_kernel_pc_42:
    s_sub_u32 s28, s28, m_kernel_pc_42-m_kernel_subC
    s_subb_u32 s29, s29, 0
    s_swappc_b64 s[30:31], s[28:29]
    s_getpc_b64 s[28:29]
m_kernel_pc_43:
    s_sub_u32 s28, s28, m_kernel_pc_43-m_kernel_subF
    s_subb_u32 s29, s29, 0
    s_swappc_b64 s[30:31], s[28:29]
    s_waitcnt vmcnt(0)
    s_barrier
    s_cmp_eq_u32 s36, 0
    s_cbranch_scc0 m_kernel_sg_44
    s_add_u32 s24, s32, 49283072
    s_addc_u32 s25, s33, 0
    s_and_b32 s25, s25, 0xffff
    s_mov_b32 s26, 524288
    s_mov_b32 s27, 0x00020000
    v_mov_b32 v251, 1
    s_mov_b64 exec, 1
    s_mul_i32 s45, s72, 1366
    s_lshr_b32 s45, s45, 16
    s_mul_i32 s46, s45, 48
    s_sub_u32 s46, s72, s46
    s_add_u32 s44, s45, 48
    s_lshl_b32 s44, s44, 6
    s_add_u32 s44, s44, s46
    s_lshl_b32 s44, s44, 7
    v_mov_b32 v250, s44
    buffer_store_dword v251, v250, s[24:27], 0 offen sc1
    s_mov_b64 exec, -1
m_kernel_sg_44:
m_kernel_fin_28:
m_kernel_end:
    s_endpgm
.section .rodata,"a"
.p2align 6
.amdhsa_kernel l0_kernel
  .amdhsa_next_free_vgpr 124
  .amdhsa_next_free_sgpr 102
  .amdhsa_accum_offset 124
  .amdhsa_group_segment_fixed_size 0
  .amdhsa_kernarg_size 120
  .amdhsa_user_sgpr_count 2
  .amdhsa_user_sgpr_kernarg_segment_ptr 1
  .amdhsa_system_sgpr_workgroup_id_x 1
.end_amdhsa_kernel
.p2align 6
.amdhsa_kernel m_kernel
  .amdhsa_next_free_vgpr 512
  .amdhsa_next_free_sgpr 102
  .amdhsa_accum_offset 256
  .amdhsa_group_segment_fixed_size 0
  .amdhsa_kernarg_size 120
  .amdhsa_user_sgpr_count 2
  .amdhsa_user_sgpr_kernarg_segment_ptr 1
  .amdhsa_system_sgpr_workgroup_id_x 1
.end_amdhsa_kernel
```
